```python
import torch

def _softmax(x, axis=-1):
    return torch.softmax(x, dim=axis)
def _gelu(x):
    return torch.nn.functional.gelu(x, approximate="tanh")
def _silu(x):
    return torch.nn.functional.silu(x)
def _sigmoid(x):
    return torch.sigmoid(x)
def _layernorm(x, axis=-1, eps=1e-5):
    m = x.mean(dim=axis, keepdim=True)
    v = x.var(dim=axis, keepdim=True, unbiased=False)
    return (x - m) / torch.sqrt(v + eps)
def _scatter_add(tgt, idx, src, axis=0):
    return tgt.clone().index_add_(axis, idx, src)
def _segment_sum(src, seg, n):
    out = torch.zeros((n,) + src.shape[1:], dtype=src.dtype)
    return out.index_add_(0, seg, src)
def _pad(x, pw):
    flat = tuple(v for pair in reversed(pw) for v in pair)
    return torch.nn.functional.pad(x, flat)

kernel_name = 'sequential_preLN__sliding_local_dilated__geglu_ffn__prompt'

def setup_inputs():

    _w = (lambda a: (lambda t: t.to(torch.bfloat16) if t.is_floating_point() else t)(torch.as_tensor(a)))
    def _A_setup():
        B, S, D = 1, 2048, 512
        return {
            "x": _w((lambda *s: torch.randn(*s, dtype=torch.bfloat16) * 0.05)(B, S, D)),
            "wqkv": _w((lambda *s: torch.randn(*s, dtype=torch.bfloat16) * 0.05)(D, 3 * D)),
            "wo": _w((lambda *s: torch.randn(*s, dtype=torch.bfloat16) * 0.05)(D, D)),
        }
    _A_in = _A_setup()

    def _B_setup():
        B, S, D, F = 1, 2048, 512, 1376
        return {
            "x": _w((lambda *s: torch.randn(*s, dtype=torch.bfloat16) * 0.05)(B, S, D)),
            "w_gate": _w((lambda *s: torch.randn(*s, dtype=torch.bfloat16) * 0.05)(D, F)),
            "w_up": _w((lambda *s: torch.randn(*s, dtype=torch.bfloat16) * 0.05)(D, F)),
            "w_down": _w((lambda *s: torch.randn(*s, dtype=torch.bfloat16) * 0.05)(F, D)),
        }
    _B_in = _B_setup()

    return {
        "A_x": _A_in["x"],
        "A_wqkv": _A_in["wqkv"],
        "A_wo": _A_in["wo"],
        "B_x": _B_in["x"],
        "B_w_gate": _B_in["w_gate"],
        "B_w_up": _B_in["w_up"],
        "B_w_down": _B_in["w_down"],
    }

def reference(A_x, A_wqkv, A_wo, B_x, B_w_gate, B_w_up, B_w_down):
    def _A_ref(x, wqkv, wo):
        B, S, D = x.shape
        H = 32; Dh = D // H
        W, dil = 8, 2
        qkv = (lambda x, *d: x.permute(*d))((x @ wqkv).reshape(B, S, 3, H, Dh), 2, 0, 3, 1, 4)
        q, k, v = qkv[0], qkv[1], qkv[2]
        scale = Dh ** -0.5
        pos = torch.arange(S)
        off = torch.arange(W) * dil
        idx = pos[:, None] - off[None, :]
        mask = idx >= 0
        idx_c = torch.where(mask, idx, 0).reshape(-1)
        kg = k[:, :, idx_c, :].reshape(B, H, S, W, Dh)
        vg = v[:, :, idx_c, :].reshape(B, H, S, W, Dh)
        logits = torch.einsum("bhsd,bhswd->bhsw", q, kg) * scale
        logits = torch.where(mask[None, None, :, :], logits, -1e9)
        attn = _softmax(logits, axis=-1)
        o = torch.einsum("bhsw,bhswd->bhsd", attn, vg)
        return (lambda x, *d: x.permute(*d))(o, 0, 2, 1, 3).reshape(B, S, D) @ wo

    def _B_ref(x, w_gate, w_up, w_down):
        return (_gelu(x @ w_gate) * (x @ w_up)) @ w_down

    x = A_x
    h = x + _A_ref(_layernorm(x, axis=-1), A_wqkv, A_wo)
    h2 = h + _B_ref(_layernorm(h, axis=-1), B_w_gate, B_w_up, B_w_down)
    return h2
```

```asm
; @launch grid=(256,1,1) block=(256,1,1) lds=163840
.amdgcn_target "amdgcn-amd-amdhsa--gfx950"
.text
.globl sequential_preLN__sliding_local_dilated__geglu_ffn__prompt_kernel
.p2align 8
.type sequential_preLN__sliding_local_dilated__geglu_ffn__prompt_kernel,@function
sequential_preLN__sliding_local_dilated__geglu_ffn__prompt_kernel:
    s_load_dwordx2 s[24:25], s[0:1], 0
    s_load_dwordx2 s[28:29], s[0:1], 8
    s_load_dwordx2 s[32:33], s[0:1], 16
    s_load_dwordx2 s[48:49], s[0:1], 72
    s_load_dwordx8 s[12:19], s[0:1], 32
    s_load_dwordx2 s[20:21], s[0:1], 64
    s_cmp_ge_u32 s2, 256
    s_cbranch_scc1 L_main_end
    s_getpc_b64 s[52:53]
L_pc:
    v_and_b32 v1, 63, v0
    v_lshrrev_b32 v4, 6, v0
    s_lshr_b32 s67, s2, 3
    v_readfirstlane_b32 s60, v4
    v_lshl_add_u32 v4, s67, 2, v4
    v_mad_u32_u24 v4, v4, 3, v1
    v_lshlrev_b32 v4, 7, v4
    v_min_u32 v4, L_code_end-L_pc-4, v4
    v_add_co_u32 v2, vcc, s52, v4
    v_mov_b32 v3, s53
    s_and_b32 s62, s67, 15
    v_addc_co_u32 v3, vcc, 0, v3, vcc
    s_mov_b64 exec, 7
    global_load_dword v255, v[2:3], off
    s_mov_b64 exec, -1
    s_and_b32 s61, s67, 7
    s_and_b32 s68, s2, 7
    s_lshr_b32 s67, s67, 3
    s_lshl2_add_u32 s65, s68, s67
    s_lshl_b32 s76, s60, 11
    s_mul_i32 s77, s60, 3072
    s_add_u32 s83, s61, s2
    s_and_b32 s83, s83, 7
    s_lshl_b32 s83, s83, 7
    v_lshrrev_b32 v2, 3, v1
    v_and_b32 v3, 7, v1
    v_lshrrev_b32 v6, 4, v1
    v_xor_b32 v6, v6, v3
    v_lshlrev_b32_e64 v6, 4, v6
    s_lshl2_add_u32 s68, s65, s60
    v_lshl_add_u32 v5, s68, 4, v2
    v_lshl_add_u32 v8, v5, 10, v6
    v_add_u32 v9, 7168, v8
    v_xor_b32 v9, 64, v9
    s_and_b32 s68, s60, 1
    s_lshl_b32 s69, s68, 2
    v_and_or_b32 v4, v2, 2, s69
    v_xor_b32 v4, v4, v3
    v_lshlrev_b32_e64 v4, 4, v4
    v_lshl_add_u32 v5, s60, 3, v2
    v_lshl_add_u32 v11, v5, 10, v4
    v_lshl_add_u32 v10, v5, 11, v11
    s_mov_b32 s26, 2097152
    s_mov_b32 s27, 0x20000
    s_mov_b32 s30, 1572864
    s_mov_b32 s31, 0x20000
    s_mul_i32 s67, s61, 0x11111111
    s_add_u32 s84, s67, 0x76543210
    s_cmp_lg_u32 s68, 0
    s_cselect_b32 s81, -1, 0xffffff00
    s_lshl3_add_u32 s67, s65, s68
    s_sub_u32 s67, s67, 2
    s_lshl_b32 s69, s68, 6
    v_lshl_add_u32 v5, s67, 3, v2
    v_max_i32 v7, 0, v5
    v_lshl_add_u32 v7, v7, 10, v6
    v_xor_b32 v7, s69, v7
    s_lshl_b32 s66, s60, 10
    s_and_b32 s67, s60, 2
    s_lshl_b32 s67, s67, 1
    s_lshr_b32 s85, s84, s67
    s_mov_b32 s34, 524288
    s_mov_b32 s35, 0x20000
    v_lshlrev_b32 v17, 4, v1
    v_lshlrev_b32 v12, 7, v1
    v_lshlrev_b32 v16, 10, v1
    s_lshr_b32 s63, s62, 3
    s_lshr_b32 s64, s65, 257
    s_lshl_b32 s78, s61, 263
    s_mov_b32 s50, 17825792
    s_mov_b32 s51, 0x20000
    s_lshl_b32 s73, s64, 20
    s_add_u32 s71, s73, 139264
    s_lshl2_add_u32 s79, s62, s71
    v_mov_b32 v13, 0
    s_bfe_u32 s74, s84, 0x30000
    s_add_u32 m0, s76, 16384
    s_lshl_b32 s75, s74, 263
    s_waitcnt lgkmcnt(0)
    buffer_load_dwordx4 v8, s[24:27], s75 offen  lds
    s_mul_i32 s74, s74, 196608
    buffer_load_dwordx4 v9, s[24:27], s75 offen offset:1024  lds
    s_add_u32 m0, s77, 40960
    s_add_u32 s74, s74, s83
    buffer_load_dwordx4 v10, s[28:31], s74 offen offset:0 lds
    buffer_load_dwordx4 v10, s[28:31], s74 offen offset:1024 lds
    buffer_load_dwordx4 v10, s[28:31], s74 offen offset:2048 lds
    s_add_u32 m0, s66, 0
    s_bfe_u32 s80, s85, 0x30000
    s_lshl_b32 s80, s80, 263
    s_mov_b32 exec_lo, s81
    buffer_load_dwordx4 v7, s[24:27], s80 offen lds
    s_mov_b32 exec_lo, -1
    s_getreg_b32 s67, hwreg(HW_REG_XCC_ID, 0, 4)
    s_mul_i32 s68, s67, s67
    s_lshl_b32 s86, s2, 267
    s_cmp_eq_u32 s60, 0
    s_cselect_b64 exec, -1, 0
    buffer_load_dwordx4 v[18:21], v17, s[32:35], s86 offen
    buffer_load_dwordx4 v[22:25], v17, s[32:35], s86 offen offset:1024
    s_mov_b64 exec, -1
    s_lshl_b32 s68, s68, 13
    s_lshl_b32 s67, s67, 261
    s_add_u32 m0, s77, 53248
    s_add_u32 s74, s74, 98304
    buffer_load_dwordx4 v10, s[28:31], s74 offen offset:0 lds
    s_add_u32 s89, s67, s68
    s_add_u32 s89, s89, 1
    buffer_load_dwordx4 v10, s[28:31], s74 offen offset:1024 lds
    s_lshl_b32 s90, s64, 260
    v_mov_b32 v26, 0x3f803f80
    buffer_load_dwordx4 v10, s[28:31], s74 offen offset:2048 lds
    v_mov_b32 v27, 0x3f803f80
    v_mov_b32 v28, 0x3f803f80
    v_mov_b32 v29, 0x3f803f80
    s_lshl_b32 s67, s60, 268
    v_lshlrev_b32_e64 v4, 11, v2
    v_lshl_add_u32 v4, v3, 4, v4
    v_add_u32 v4, s67, v4
    s_mov_b64 exec, 0xffff
    ds_write_b128 v4, v[26:29] offset:0
    s_mov_b64 exec, -1
    v_mov_b32 v254, 163836
    s_mov_b32 s40, s16
    s_mov_b32 s41, s17
    s_mov_b32 s42, 1409024
    s_mov_b32 s43, 0x20000
    s_mov_b32 s44, s18
    s_mov_b32 s45, s19
    s_mov_b32 s46, 2097152
    s_mov_b32 s47, 0x20000
    s_cmp_lt_u32 s60, 2
    s_cselect_b32 s36, s12, s14
    s_cselect_b32 s37, s13, s15
    s_mov_b32 s38, 1409024
    s_mov_b32 s39, 0x20000
    s_mov_b32 s0, 0
    s_cmp_eq_u32 s60, 0
    s_cselect_b64 s[4:5], 1, 0
    s_cselect_b64 s[6:7], 0xffff, 0
    s_mov_b32 s8, 0x7654e210
    s_mov_b32 s9, 0xb3dcfa98
    s_lshl_b32 s62, s62, 258
    s_lshr_b64 s[8:9], s[8:9], s62
    s_and_b32 s62, s8, 15
    s_cmp_lt_u32 s62, 15
    s_cselect_b32 s8, s38, 0
    s_cmp_lt_u32 s62, 14
    s_cselect_b32 s9, s38, 0
    s_mov_b32 s1, 0x3b000000
    v_mov_b32 v30, 0x3727c5ac
    s_branch L_body
    .p2align 12
L_body:
    v_and_b32 v31, 15, v1
    v_lshrrev_b32 v32, 4, v1
    v_lshrrev_b32 v4, 1, v31
    v_xor_b32 v4, v4, v32
    v_lshlrev_b32 v4, 4, v4
    v_lshl_add_u32 v33, v31, 7, v4
    v_xor_b32 v34, 64, v33
    v_add_u32 v38, s67, v33
    v_add_u32 v39, s67, v34
    s_add_u32 s67, s76, 16384
    v_add_u32 v35, s67, v33
    v_add_u32 v36, s67, v34
    v_lshrrev_b32 v4, 1, v31
    v_lshrrev_b32 v5, 1, v32
    v_xor_b32 v4, v4, v5
    v_lshlrev_b32 v4, 4, v4
    v_and_b32 v5, 1, v32
    v_lshl_add_u32 v4, v5, 3, v4
    v_lshl_add_u32 v4, v31, 7, v4
    v_add_u32 v40, s67, v4
    v_xor_b32 v41, 32, v40
    v_xor_b32 v42, 64, v40
    v_xor_b32 v43, 96, v40
    v_and_b32 v4, 3, v2
    v_lshlrev_b32 v44, 5, v4
    v_bfe_u32 v4, v1, 2, 2
    v_and_b32 v5, 3, v1
    v_lshlrev_b32 v5, 3, v5
    v_lshl_add_u32 v45, v4, 7, v5
    s_lshl_b32 s67, s60, 5
    v_xor_b32 v4, s67, v44
    v_mul_u32_u24 v5, 3072, v32
    v_add3_u32 v37, v4, v5, v45
    v_add_u32 v37, 40960, v37
    s_mov_b32 s10, 0xaaaaaaaa
    s_mov_b32 s11, 0xaaaaaaaa
    s_mov_b32 s12, 0xcccccccc
    s_mov_b32 s13, 0xcccccccc
    s_mov_b32 s14, 0x00f0000f
    s_mov_b32 s15, 0xf0000f00
    s_mov_b32 s16, 0xfff0ffff
    s_mov_b32 s17, 0xf000ff00
    s_mov_b32 s18, 0xffc0fffc
    s_mov_b32 s19, 0xc000fc00
    v_lshlrev_b32 v46, 4, v31
    v_add_u32 v46, 159744, v46
    v_lshl_add_u32 v47, s60, 8, v46
    v_lshlrev_b32 v49, 5, v31
    v_add_u32 v49, 161024, v49
    v_lshl_add_u32 v48, s60, 3, v49
    v_lshlrev_b32 v50, 4, v31
    s_lshl_b32 s3, s89, 4
    s_lshl_b32 s23, s60, 9
    s_and_b32 s22, s60, 2
    s_lshl_b32 s22, s22, 5
    s_add_u32 s22, s22, s23
    s_add_u32 s22, s22, 161536
    s_add_u32 s23, s23, 786432
    v_and_b32_e64 v4, 1, v31
    v_lshl_add_u32 v4, v32, 2, v4
    v_lshlrev_b32 v4, 4, v4
    v_add_u32 v4, 159752, v4
    v_add_u32 v5, 256, v4
    s_mov_b64 exec, 0
    s_cmp_eq_u32 s60, 0
    s_cbranch_scc1 L_vis_v0_0
    s_cmp_eq_u32 s60, 1
    s_cbranch_scc1 L_vis_v0_1
    s_cmp_eq_u32 s60, 2
    s_cbranch_scc1 L_vis_v0_2
L_ret_v0:
    s_mov_b64 exec, -1
    s_and_b64 exec, s[6:7], 0x3f
    buffer_store_dword v13, v12, s[48:51], s79 offen
    s_mov_b64 exec, -1
    s_lshr_b32 s86, s2, 259
    s_lshl2_add_u32 s86, s86, s60
    s_mul_i32 s86, s86, 12288
    s_mov_b64 exec, 0xfff
    buffer_load_dword v13, v16, s[28:31], s86 offen offset:384 sc1
    s_mov_b64 exec, -1
    v_cndmask_b32 v51, v4, v5, s[16:17]
    v_cndmask_b32 v52, v4, v5, s[18:19]
    s_cmp_eq_u32 s65, 0
    s_cselect_b32 s67, 0xf149f2ca, 0
    v_mov_b32_e64 v4, s67
    v_mov_b32 v6, 0x0c0c0c0c
    v_cndmask_b32 v54, v4, 0, s[16:17]
    v_cndmask_b32 v55, v4, 0, s[18:19]
    v_mov_b32 v4, 0x0c0c0100
    v_mov_b32 v5, 0x01000c0c
    s_bfe_u32 s74, s84, 0x30004
    s_add_u32 m0, s76, 24576
    s_lshl_b32 s75, s74, 263
    buffer_load_dwordx4 v8, s[24:27], s75 offen  lds
    v_cndmask_b32 v4, v4, v5, s[10:11]
    v_cndmask_b32 v56, v4, v6, s[16:17]
    v_cndmask_b32 v58, v6, v4, s[16:17]
    v_mov_b32 v4, 0x0c0c0302
    v_mov_b32 v5, 0x03020c0c
    v_cndmask_b32 v4, v4, v5, s[10:11]
    v_cndmask_b32 v57, v4, v6, s[18:19]
    v_cndmask_b32 v59, v6, v4, s[18:19]
    v_add_u32 v53, 32768, v11
    s_and_b32 s72, s62, 1
    s_mul_i32 s74, s74, 196608
    buffer_load_dwordx4 v9, s[24:27], s75 offen offset:1024  lds
    s_mul_i32 s67, s62, 192
    s_lshl_b32 s52, s72, 6
    s_add_u32 s69, s67, s52
    s_add_u32 s70, s69, s52
    s_add_u32 s70, s70, 2752
    s_lshl_b32 s68, s52, 1
    s_sub_u32 s56, 2816, s68
    s_and_b32 s67, s60, 1
    s_and_b32 s68, s60, 2
    v_and_b32 v4, 1, v32
    s_add_u32 m0, s77, 65536
    s_add_u32 s74, s74, s83
    buffer_load_dwordx4 v10, s[28:31], s74 offen offset:0 lds
    v_lshlrev_b32 v4, 3, v4
    v_lshl_add_u32 v4, s67, 2, v4
    v_and_b32 v5, 2, v32
    v_and_b32 v6, 1, v2
    v_add3_u32 v4, v4, v5, v6
    v_mul_u32_u24 v4, 5504, v4
    v_and_b32 v6, 6, v2
    v_xor_b32 v6, v6, v3
    v_lshlrev_b32 v6, 4, v6
    v_xor_b32 v5, s52, v6
    buffer_load_dwordx4 v10, s[28:31], s74 offen offset:1024 lds
    v_add3_u32 v60, v4, v5, s69
    v_add_u32 v61, 88064, v60
    v_lshl_add_u32 v4, s67, 3, v2
    v_lshl_add_u32 v64, v4, 10, v6
    v_and_b32 v4, 1, v2
    v_lshlrev_b32 v4, 3, v4
    v_lshl_add_u32 v4, s67, 4, v4
    v_lshl_add_u32 v4, v32, 1, v4
    v_bfe_u32 v5, v1, 2, 1
    v_add_u32_e64 v4, v4, v5
    buffer_load_dwordx4 v10, s[28:31], s74 offen offset:2048 lds
    v_mul_u32_u24 v4, 5504, v4
    v_and_b32 v5, 2, v2
    v_and_b32 v6, 3, v1
    v_xor_b32 v5, v5, v6
    v_lshlrev_b32 v5, 4, v5
    v_add3_u32 v62, v4, v5, s70
    s_mul_i32 s53, s68, 81920
    s_add_u32 s53, s53, s78
    s_mul_i32 s54, s68, 49152
    s_add_u32 s54, s54, s78
    s_add_u32 m0, s66, 4096
    s_bfe_u32 s80, s85, 0x30008
    s_lshl_b32 s80, s80, 7
    s_mov_b32 exec_lo, s81
    buffer_load_dwordx4 v7, s[24:27], s80 offen lds
    s_mov_b32 exec_lo, -1
    s_add_u32 s54, s54, 32768
    s_mul_i32 s55, s68, 16384
    s_add_u32 s55, s55, s78
    s_add_u32 s55, s55, 65536
    s_lshl_b32 s87, s65, 16
    s_lshl_b32 s68, s83, 5
    s_add_u32 s87, s87, s68
    s_add_u32 s87, s87, s66
    v_lshlrev_b32_e64 v4, 7, v3
    v_lshl_add_u32 v15, v2, 15, v4
    s_add_u32 m0, s77, 77824
    s_add_u32 s74, s74, 98304
    buffer_load_dwordx4 v10, s[28:31], s74 offen offset:0 lds
    s_lshr_b32 s68, s60, 1
    s_lshl_b32 s69, s63, 1
    s_add_u32 s69, s69, s68
    s_lshl_b32 s69, s69, 15
    s_lshl_b32 s68, s61, 12
    s_add_u32 s69, s69, s68
    s_add_u32 s88, s69, s73
    s_lshl_b32 s67, s67, 11
    s_add_u32 s69, s69, s67
    v_add_u32 v14, s69, v12
    s_lshl_b32 s67, s62, 2
    s_add_u32 s67, s67, s60
    s_lshl_b32 s67, s67, 263
    s_add_u32 s68, s67, 131072
    v_writelane_b32 v14, s68, 16
    s_and_b32 s67, s67, 0x380
    s_add_u32 s68, s67, 139264
    v_writelane_b32 v14, s68, 17
    s_waitcnt vmcnt(14) lgkmcnt(0)
    s_barrier
    ds_read_b128 a[32:35], v35 offset:0
    ds_read_b64_tr_b16 a[0:1], v37 offset:0
    ds_read_b64_tr_b16 a[2:3], v37 offset:512
    ds_read_b128 a[12:15], v33 offset:0
    ds_read_b128 a[16:19], v33 offset:16384
    ds_read_b128 a[20:23], v33 offset:18432
    ds_read_b128 a[24:27], v33 offset:20480
    ds_read_b128 a[28:31], v33 offset:22528
    ds_read_b64_tr_b16 a[4:5], v37 offset:1024
    ds_read_b64_tr_b16 a[6:7], v37 offset:1536
    ds_read_b64_tr_b16 a[8:9], v37 offset:2048
    ds_read_b64_tr_b16 a[10:11], v37 offset:2560
    s_waitcnt lgkmcnt(11)
    v_mfma_f32_16x16x32_bf16 v[128:131], a[32:35], a[32:35], 0
    ds_read_b128 a[68:71], v36 offset:0
    ds_read_b128 a[48:51], v34 offset:0
    v_mfma_f32_16x16x32_bf16 v[132:135], v[26:29], a[32:35], 0
    ds_read_b128 a[52:55], v34 offset:16384
    ds_read_b128 a[56:59], v34 offset:18432
    s_waitcnt lgkmcnt(12)
    v_mfma_f32_16x16x32_bf16 v[68:71], a[0:3], a[12:15], 0
    ds_read_b128 a[60:63], v34 offset:20480
    ds_read_b128 a[64:67], v34 offset:22528
    s_waitcnt lgkmcnt(13)
    v_mfma_f32_16x16x32_bf16 v[72:75], a[0:3], a[16:19], 0
    ds_read_b64 v[144:145], v40
    buffer_load_dwordx4 v10, s[28:31], s74 offen offset:1024 lds
    s_waitcnt lgkmcnt(13)
    v_mfma_f32_16x16x32_bf16 v[76:79], a[0:3], a[20:23], 0
    ds_read_b64 v[146:147], v41
    s_waitcnt lgkmcnt(13)
    v_mfma_f32_16x16x32_bf16 v[80:83], a[0:3], a[24:27], 0
    ds_read_b64 v[148:149], v42
    buffer_load_dwordx4 v10, s[28:31], s74 offen offset:2048 lds
    s_waitcnt lgkmcnt(13)
    v_mfma_f32_16x16x32_bf16 v[84:87], a[0:3], a[28:31], 0
    s_bfe_u32 s74, s84, 0x30008
    ds_read_b64 v[150:151], v43
    s_waitcnt vmcnt(11)
    s_barrier
    s_waitcnt lgkmcnt(12)
    v_mfma_f32_16x16x32_bf16 v[88:91], a[4:7], a[12:15], 0
    s_add_u32 m0, s76, 32768
    ds_read_b64_tr_b16 a[36:37], v37 offset:12288
    v_mfma_f32_16x16x32_bf16 v[92:95], a[4:7], a[16:19], 0
    s_lshl_b32 s75, s74, 7
    ds_read_b64_tr_b16 a[38:39], v37 offset:12800
    v_mfma_f32_16x16x32_bf16 v[96:99], a[4:7], a[20:23], 0
    ds_read_b64_tr_b16 a[40:41], v37 offset:13312
    buffer_load_dwordx4 v8, s[24:27], s75 offen  lds
    v_mfma_f32_16x16x32_bf16 v[100:103], a[4:7], a[24:27], 0
    s_mul_i32 s74, s74, 196608
    ds_read_b64_tr_b16 a[42:43], v37 offset:13824
    v_mfma_f32_16x16x32_bf16 v[104:107], a[4:7], a[28:31], 0
    ds_read_b64_tr_b16 a[44:45], v37 offset:14336
    buffer_load_dwordx4 v9, s[24:27], s75 offen offset:1024  lds
    s_waitcnt lgkmcnt(14)
    v_mfma_f32_16x16x32_bf16 v[108:111], a[12:15], a[8:11], 0
    s_add_u32 m0, s77, 90112
    ds_read_b64_tr_b16 a[46:47], v37 offset:14848
    v_mfma_f32_16x16x32_bf16 v[112:115], a[16:19], a[8:11], 0
    s_add_u32 s74, s74, s83
    buffer_load_dwordx4 v10, s[28:31], s74 offen offset:0 lds
    v_mfma_f32_16x16x32_bf16 v[116:119], a[20:23], a[8:11], 0
    v_mfma_f32_16x16x32_bf16 v[120:123], a[24:27], a[8:11], 0
    buffer_load_dwordx4 v10, s[28:31], s74 offen offset:1024 lds
    v_mfma_f32_16x16x32_bf16 v[124:127], a[28:31], a[8:11], 0
    s_waitcnt lgkmcnt(0)
    buffer_load_dwordx4 v10, s[28:31], s74 offen offset:2048 lds
    v_mfma_f32_16x16x32_bf16 v[136:139], v[26:29], v[18:21], 0
    v_mfma_f32_16x16x32_bf16 v[140:143], v[26:29], v[22:25], 0
    s_add_u32 m0, s66, 8192
    s_bfe_u32 s80, s85, 0x30010
    s_lshl_b32 s80, s80, 7
    s_mov_b32 exec_lo, s81
    buffer_load_dwordx4 v7, s[24:27], s80 offen lds
    s_mov_b32 exec_lo, -1
    s_lshl2_add_u32 s67, s2, 786432
    v_add_f32_dpp v136, v136, v136 row_ror:8 row_mask:0xf bank_mask:0xf
    v_add_f32_dpp v140, v140, v140 row_ror:8 row_mask:0xf bank_mask:0xf
    s_nop 0
    v_add_f32_dpp v136, v136, v136 row_ror:4 row_mask:0xf bank_mask:0xf
    s_add_u32 m0, s77, 102400
    s_add_u32 s74, s74, 98304
    buffer_load_dwordx4 v10, s[28:31], s74 offen offset:0 lds
    v_add_f32_dpp v140, v140, v140 row_ror:4 row_mask:0xf bank_mask:0xf
    v_add_f32_dpp v136, v136, v136 row_ror:2 row_mask:0xf bank_mask:0xf
    s_nop 0
    v_add_f32_dpp v140, v140, v140 row_ror:2 row_mask:0xf bank_mask:0xf
    v_add_f32_dpp v136, v136, v136 row_ror:1 row_mask:0xf bank_mask:0xf
    buffer_load_dwordx4 v10, s[28:31], s74 offen offset:1024 lds
    v_add_f32_dpp v140, v140, v140 row_ror:1 row_mask:0xf bank_mask:0xf
    v_mul_f32 v136, 0xbb000000, v136
    v_mul_f32 v140, 0xbb000000, v140
    v_cvt_pk_bf16_f32 v137, v136, v140
    buffer_load_dwordx4 v10, s[28:31], s74 offen offset:2048 lds
    v_lshlrev_b32_e64 v138, 16, v137
    v_and_b32 v139, 0xffff0000, v137
    v_sub_f32 v136, v136, v138
    v_sub_f32 v140, v140, v139
    v_cvt_pk_bf16_f32 v136, v136, v140
    v_cndmask_b32 v136, v137, v136, s[10:11]
    s_and_b64 exec, s[6:7], 3
    buffer_store_dword v136, v16, s[48:51], s67 offen sc1
    s_mov_b64 exec, -1
    s_waitcnt vmcnt(10)
    s_barrier
    v_mfma_f32_16x16x32_bf16 v[128:131], a[68:71], a[68:71], v[128:131]
    s_bfe_u32 s74, s84, 0x3000c
    ds_read_b128 a[32:35], v35 offset:8192
    v_mfma_f32_16x16x32_bf16 v[132:135], v[26:29], a[68:71], v[132:135]
    s_add_u32 m0, s76, 16384
    ds_read_b64_tr_b16 a[0:1], v37 offset:24576
    v_mfma_f32_16x16x32_bf16 v[68:71], a[36:39], a[48:51], v[68:71]
    s_lshl_b32 s75, s74, 263
    ds_read_b128 a[12:15], v33 offset:2048
    v_mfma_f32_16x16x32_bf16 v[72:75], a[36:39], a[52:55], v[72:75]
    ds_read_b64_tr_b16 a[2:3], v37 offset:25088
    buffer_load_dwordx4 v8, s[24:27], s75 offen  lds
    v_mfma_f32_16x16x32_bf16 v[76:79], a[36:39], a[56:59], v[76:79]
    s_mul_i32 s74, s74, 196608
    ds_read_b128 a[16:19], v33 offset:24576
    v_mfma_f32_16x16x32_bf16 v[80:83], a[36:39], a[60:63], v[80:83]
    ds_read_b64_tr_b16 a[4:5], v37 offset:25600
    buffer_load_dwordx4 v9, s[24:27], s75 offen offset:1024  lds
    v_mfma_f32_16x16x32_bf16 v[84:87], a[36:39], a[64:67], v[84:87]
    s_add_u32 m0, s77, 40960
    ds_read_b128 a[20:23], v33 offset:26624
    v_mfma_f32_16x16x32_bf16 v[88:91], a[40:43], a[48:51], v[88:91]
    s_add_u32 s74, s74, s83
    ds_read_b64_tr_b16 a[6:7], v37 offset:26112
    v_mfma_f32_16x16x32_bf16 v[92:95], a[40:43], a[52:55], v[92:95]
    ds_read_b128 a[24:27], v33 offset:28672
    buffer_load_dwordx4 v10, s[28:31], s74 offen offset:0 lds
    v_mfma_f32_16x16x32_bf16 v[96:99], a[40:43], a[56:59], v[96:99]
    ds_read_b64_tr_b16 a[8:9], v37 offset:26624
    v_mfma_f32_16x16x32_bf16 v[100:103], a[40:43], a[60:63], v[100:103]
    ds_read_b128 a[28:31], v33 offset:30720
    buffer_load_dwordx4 v10, s[28:31], s74 offen offset:1024 lds
    v_mfma_f32_16x16x32_bf16 v[104:107], a[40:43], a[64:67], v[104:107]
    ds_read_b64_tr_b16 a[10:11], v37 offset:27136
    v_mfma_f32_16x16x32_bf16 v[108:111], a[48:51], a[44:47], v[108:111]
    buffer_load_dwordx4 v10, s[28:31], s74 offen offset:2048 lds
    s_add_u32 m0, s66, 12288
    v_mfma_f32_16x16x32_bf16 v[112:115], a[52:55], a[44:47], v[112:115]
    s_bfe_u32 s80, s85, 0x30018
    s_lshl_b32 s80, s80, 263
    v_mfma_f32_16x16x32_bf16 v[116:119], a[56:59], a[44:47], v[116:119]
    s_mov_b32 exec_lo, s81
    buffer_load_dwordx4 v7, s[24:27], s80 offen lds
    s_mov_b32 exec_lo, -1
    v_mfma_f32_16x16x32_bf16 v[120:123], a[60:63], a[44:47], v[120:123]
    s_add_u32 m0, s77, 53248
    s_add_u32 s74, s74, 98304
    v_mfma_f32_16x16x32_bf16 v[124:127], a[64:67], a[44:47], v[124:127]
    buffer_load_dwordx4 v10, s[28:31], s74 offen offset:0 lds
    s_waitcnt lgkmcnt(0)
    v_mfma_f32_16x16x32_bf16 v[128:131], a[32:35], a[32:35], v[128:131]
    ds_read_b128 a[68:71], v36 offset:8192
    v_mfma_f32_16x16x32_bf16 v[132:135], v[26:29], a[32:35], v[132:135]
    ds_read_b64_tr_b16 a[36:37], v37 offset:36864
    buffer_load_dwordx4 v10, s[28:31], s74 offen offset:1024 lds
    v_mfma_f32_16x16x32_bf16 v[68:71], a[0:3], a[12:15], v[68:71]
    ds_read_b128 a[48:51], v34 offset:2048
    v_mfma_f32_16x16x32_bf16 v[72:75], a[0:3], a[16:19], v[72:75]
    ds_read_b64_tr_b16 a[38:39], v37 offset:37376
    buffer_load_dwordx4 v10, s[28:31], s74 offen offset:2048 lds
    v_mfma_f32_16x16x32_bf16 v[76:79], a[0:3], a[20:23], v[76:79]
    ds_read_b128 a[52:55], v34 offset:24576
    v_mfma_f32_16x16x32_bf16 v[80:83], a[0:3], a[24:27], v[80:83]
    ds_read_b64_tr_b16 a[40:41], v37 offset:37888
    v_mfma_f32_16x16x32_bf16 v[84:87], a[0:3], a[28:31], v[84:87]
    ds_read_b128 a[56:59], v34 offset:26624
    v_mfma_f32_16x16x32_bf16 v[88:91], a[4:7], a[12:15], v[88:91]
    ds_read_b64_tr_b16 a[42:43], v37 offset:38400
    v_mfma_f32_16x16x32_bf16 v[92:95], a[4:7], a[16:19], v[92:95]
    ds_read_b128 a[60:63], v34 offset:28672
    v_mfma_f32_16x16x32_bf16 v[96:99], a[4:7], a[20:23], v[96:99]
    ds_read_b64_tr_b16 a[44:45], v37 offset:38912
    v_mfma_f32_16x16x32_bf16 v[100:103], a[4:7], a[24:27], v[100:103]
    ds_read_b128 a[64:67], v34 offset:30720
    v_mfma_f32_16x16x32_bf16 v[104:107], a[4:7], a[28:31], v[104:107]
    ds_read_b64_tr_b16 a[46:47], v37 offset:39424
    v_mfma_f32_16x16x32_bf16 v[108:111], a[12:15], a[8:11], v[108:111]
    v_mfma_f32_16x16x32_bf16 v[112:115], a[16:19], a[8:11], v[112:115]
    v_mfma_f32_16x16x32_bf16 v[116:119], a[20:23], a[8:11], v[116:119]
    v_mfma_f32_16x16x32_bf16 v[120:123], a[24:27], a[8:11], v[120:123]
    v_mfma_f32_16x16x32_bf16 v[124:127], a[28:31], a[8:11], v[124:127]
    s_waitcnt vmcnt(10) lgkmcnt(0)
    s_barrier
    v_mfma_f32_16x16x32_bf16 v[128:131], a[68:71], a[68:71], v[128:131]
    s_bfe_u32 s74, s84, 0x30010
    ds_read_b128 a[32:35], v35 offset:16384
    v_mfma_f32_16x16x32_bf16 v[132:135], v[26:29], a[68:71], v[132:135]
    s_add_u32 m0, s76, 24576
    ds_read_b64_tr_b16 a[0:1], v37 offset:49152
    v_mfma_f32_16x16x32_bf16 v[68:71], a[36:39], a[48:51], v[68:71]
    s_lshl_b32 s75, s74, 263
    ds_read_b128 a[12:15], v33 offset:4096
    v_mfma_f32_16x16x32_bf16 v[72:75], a[36:39], a[52:55], v[72:75]
    ds_read_b64_tr_b16 a[2:3], v37 offset:49664
    buffer_load_dwordx4 v8, s[24:27], s75 offen  lds
    v_mfma_f32_16x16x32_bf16 v[76:79], a[36:39], a[56:59], v[76:79]
    s_mul_i32 s74, s74, 196608
    ds_read_b128 a[16:19], v33 offset:32768
    v_mfma_f32_16x16x32_bf16 v[80:83], a[36:39], a[60:63], v[80:83]
    ds_read_b64_tr_b16 a[4:5], v37 offset:50176
    buffer_load_dwordx4 v9, s[24:27], s75 offen offset:1024  lds
    v_mfma_f32_16x16x32_bf16 v[84:87], a[36:39], a[64:67], v[84:87]
    s_add_u32 m0, s77, 65536
    ds_read_b128 a[20:23], v33 offset:34816
    v_mfma_f32_16x16x32_bf16 v[88:91], a[40:43], a[48:51], v[88:91]
    s_add_u32 s74, s74, s83
    ds_read_b64_tr_b16 a[6:7], v37 offset:50688
    v_mfma_f32_16x16x32_bf16 v[92:95], a[40:43], a[52:55], v[92:95]
    ds_read_b128 a[24:27], v33 offset:36864
    buffer_load_dwordx4 v10, s[28:31], s74 offen offset:0 lds
    v_mfma_f32_16x16x32_bf16 v[96:99], a[40:43], a[56:59], v[96:99]
    ds_read_b64_tr_b16 a[8:9], v37 offset:51200
    v_mfma_f32_16x16x32_bf16 v[100:103], a[40:43], a[60:63], v[100:103]
    ds_read_b128 a[28:31], v33 offset:38912
    buffer_load_dwordx4 v10, s[28:31], s74 offen offset:1024 lds
    v_mfma_f32_16x16x32_bf16 v[104:107], a[40:43], a[64:67], v[104:107]
    ds_read_b64_tr_b16 a[10:11], v37 offset:51712
    v_mfma_f32_16x16x32_bf16 v[108:111], a[48:51], a[44:47], v[108:111]
    buffer_load_dwordx4 v10, s[28:31], s74 offen offset:2048 lds
    s_add_u32 m0, s77, 77824
    v_mfma_f32_16x16x32_bf16 v[112:115], a[52:55], a[44:47], v[112:115]
    s_add_u32 s74, s74, 98304
    v_mfma_f32_16x16x32_bf16 v[116:119], a[56:59], a[44:47], v[116:119]
    buffer_load_dwordx4 v10, s[28:31], s74 offen offset:0 lds
    v_mfma_f32_16x16x32_bf16 v[120:123], a[60:63], a[44:47], v[120:123]
    v_mfma_f32_16x16x32_bf16 v[124:127], a[64:67], a[44:47], v[124:127]
    buffer_load_dwordx4 v10, s[28:31], s74 offen offset:1024 lds
    s_waitcnt lgkmcnt(0)
    v_mfma_f32_16x16x32_bf16 v[128:131], a[32:35], a[32:35], v[128:131]
    ds_read_b128 a[68:71], v36 offset:16384
    v_mfma_f32_16x16x32_bf16 v[132:135], v[26:29], a[32:35], v[132:135]
    ds_read_b64_tr_b16 a[36:37], v37 offset:61440
    v_mfma_f32_16x16x32_bf16 v[68:71], a[0:3], a[12:15], v[68:71]
    ds_read_b128 a[48:51], v34 offset:4096
    buffer_load_dwordx4 v10, s[28:31], s74 offen offset:2048 lds
    v_mfma_f32_16x16x32_bf16 v[72:75], a[0:3], a[16:19], v[72:75]
    ds_read_b64_tr_b16 a[38:39], v37 offset:61952
    v_mfma_f32_16x16x32_bf16 v[76:79], a[0:3], a[20:23], v[76:79]
    ds_read_b128 a[52:55], v34 offset:32768
    v_mfma_f32_16x16x32_bf16 v[80:83], a[0:3], a[24:27], v[80:83]
    ds_read_b64_tr_b16 a[40:41], v37 offset:62464
    v_mfma_f32_16x16x32_bf16 v[84:87], a[0:3], a[28:31], v[84:87]
    ds_read_b128 a[56:59], v34 offset:34816
    v_mfma_f32_16x16x32_bf16 v[88:91], a[4:7], a[12:15], v[88:91]
    ds_read_b64_tr_b16 a[42:43], v37 offset:62976
    v_mfma_f32_16x16x32_bf16 v[92:95], a[4:7], a[16:19], v[92:95]
    ds_read_b128 a[60:63], v34 offset:36864
    v_mfma_f32_16x16x32_bf16 v[96:99], a[4:7], a[20:23], v[96:99]
    ds_read_b64_tr_b16 a[44:45], v37 offset:63488
    v_mfma_f32_16x16x32_bf16 v[100:103], a[4:7], a[24:27], v[100:103]
    ds_read_b128 a[64:67], v34 offset:38912
    v_mfma_f32_16x16x32_bf16 v[104:107], a[4:7], a[28:31], v[104:107]
    ds_read_b64_tr_b16 a[46:47], v37 offset:64000
    v_mfma_f32_16x16x32_bf16 v[108:111], a[12:15], a[8:11], v[108:111]
    v_mfma_f32_16x16x32_bf16 v[112:115], a[16:19], a[8:11], v[112:115]
    v_mfma_f32_16x16x32_bf16 v[116:119], a[20:23], a[8:11], v[116:119]
    v_mfma_f32_16x16x32_bf16 v[120:123], a[24:27], a[8:11], v[120:123]
    v_mfma_f32_16x16x32_bf16 v[124:127], a[28:31], a[8:11], v[124:127]
    s_waitcnt vmcnt(8) lgkmcnt(0)
    s_barrier
    s_cmp_lg_u32 s60, 0
    s_cbranch_scc1 L_nocen
    s_atomic_add s89, s[20:21], s90
L_nocen:
    v_mfma_f32_16x16x32_bf16 v[128:131], a[68:71], a[68:71], v[128:131]
    s_bfe_u32 s74, s84, 0x30014
    ds_read_b128 a[32:35], v35 offset:0
    v_mfma_f32_16x16x32_bf16 v[132:135], v[26:29], a[68:71], v[132:135]
    s_add_u32 m0, s76, 32768
    ds_read_b64_tr_b16 a[0:1], v37 offset:0
    v_mfma_f32_16x16x32_bf16 v[68:71], a[36:39], a[48:51], v[68:71]
    s_lshl_b32 s75, s74, 263
    ds_read_b128 a[12:15], v33 offset:6144
    v_mfma_f32_16x16x32_bf16 v[72:75], a[36:39], a[52:55], v[72:75]
    ds_read_b64_tr_b16 a[2:3], v37 offset:512
    buffer_load_dwordx4 v8, s[24:27], s75 offen  lds
    v_mfma_f32_16x16x32_bf16 v[76:79], a[36:39], a[56:59], v[76:79]
    s_mul_i32 s74, s74, 196608
    ds_read_b128 a[16:19], v33 offset:16384
    v_mfma_f32_16x16x32_bf16 v[80:83], a[36:39], a[60:63], v[80:83]
    ds_read_b64_tr_b16 a[4:5], v37 offset:1024
    v_mfma_f32_16x16x32_bf16 v[84:87], a[36:39], a[64:67], v[84:87]
    ds_read_b128 a[20:23], v33 offset:18432
    buffer_load_dwordx4 v9, s[24:27], s75 offen offset:1024  lds
    v_mfma_f32_16x16x32_bf16 v[88:91], a[40:43], a[48:51], v[88:91]
    s_add_u32 m0, s77, 90112
    ds_read_b64_tr_b16 a[6:7], v37 offset:1536
    v_mfma_f32_16x16x32_bf16 v[92:95], a[40:43], a[52:55], v[92:95]
    s_add_u32 s74, s74, s83
    ds_read_b128 a[24:27], v33 offset:20480
    v_mfma_f32_16x16x32_bf16 v[96:99], a[40:43], a[56:59], v[96:99]
    ds_read_b64_tr_b16 a[8:9], v37 offset:2048
    buffer_load_dwordx4 v10, s[28:31], s74 offen offset:0 lds
    v_mfma_f32_16x16x32_bf16 v[100:103], a[40:43], a[60:63], v[100:103]
    ds_read_b128 a[28:31], v33 offset:22528
    v_mfma_f32_16x16x32_bf16 v[104:107], a[40:43], a[64:67], v[104:107]
    ds_read_b64_tr_b16 a[10:11], v37 offset:2560
    v_mfma_f32_16x16x32_bf16 v[108:111], a[48:51], a[44:47], v[108:111]
    buffer_load_dwordx4 v10, s[28:31], s74 offen offset:1024 lds
    v_mfma_f32_16x16x32_bf16 v[112:115], a[52:55], a[44:47], v[112:115]
    v_mfma_f32_16x16x32_bf16 v[116:119], a[56:59], a[44:47], v[116:119]
    v_mfma_f32_16x16x32_bf16 v[120:123], a[60:63], a[44:47], v[120:123]
    buffer_load_dwordx4 v10, s[28:31], s74 offen offset:2048 lds
    s_add_u32 m0, s77, 102400
    v_mfma_f32_16x16x32_bf16 v[124:127], a[64:67], a[44:47], v[124:127]
    s_add_u32 s74, s74, 98304
    ds_read_b32 v255, v254
    s_waitcnt lgkmcnt(1)
    v_mfma_f32_16x16x32_bf16 v[128:131], a[32:35], a[32:35], v[128:131]
    ds_read_b128 a[68:71], v36 offset:0
    ds_read_b64_tr_b16 a[36:37], v37 offset:12288
    v_mfma_f32_16x16x32_bf16 v[132:135], v[26:29], a[32:35], v[132:135]
    ds_read_b128 a[48:51], v34 offset:6144
    ds_read_b64_tr_b16 a[38:39], v37 offset:12800
    v_mfma_f32_16x16x32_bf16 v[68:71], a[0:3], a[12:15], v[68:71]
    ds_read_b128 a[52:55], v34 offset:16384
    ds_read_b64_tr_b16 a[40:41], v37 offset:13312
    v_mfma_f32_16x16x32_bf16 v[72:75], a[0:3], a[16:19], v[72:75]
    ds_read_b128 a[56:59], v34 offset:18432
    buffer_load_dwordx4 v10, s[28:31], s74 offen offset:0 lds
    v_mfma_f32_16x16x32_bf16 v[76:79], a[0:3], a[20:23], v[76:79]
    ds_read_b64_tr_b16 a[42:43], v37 offset:13824
    v_mfma_f32_16x16x32_bf16 v[80:83], a[0:3], a[24:27], v[80:83]
    ds_read_b128 a[60:63], v34 offset:20480
    v_mfma_f32_16x16x32_bf16 v[84:87], a[0:3], a[28:31], v[84:87]
    ds_read_b64_tr_b16 a[44:45], v37 offset:14336
    buffer_load_dwordx4 v10, s[28:31], s74 offen offset:1024 lds
    v_mfma_f32_16x16x32_bf16 v[88:91], a[4:7], a[12:15], v[88:91]
    ds_read_b128 a[64:67], v34 offset:22528
    v_mfma_f32_16x16x32_bf16 v[92:95], a[4:7], a[16:19], v[92:95]
    ds_read_b64_tr_b16 a[46:47], v37 offset:14848
    v_mfma_f32_16x16x32_bf16 v[96:99], a[4:7], a[20:23], v[96:99]
    ds_read_b128 a[72:75], v38 offset:0
    buffer_load_dwordx4 v10, s[28:31], s74 offen offset:2048 lds
    v_mfma_f32_16x16x32_bf16 v[100:103], a[4:7], a[24:27], v[100:103]
    s_lshr_b32 s86, s2, 3
    ds_read_b128 a[76:79], v39 offset:0
    v_mfma_f32_16x16x32_bf16 v[104:107], a[4:7], a[28:31], v[104:107]
    s_lshl2_add_u32 s86, s86, s60
    ds_read_b128 a[80:83], v38 offset:2048
    v_mfma_f32_16x16x32_bf16 v[108:111], a[12:15], a[8:11], v[108:111]
    s_mul_i32 s86, s86, 4096
    ds_read_b128 a[84:87], v39 offset:2048
    v_mfma_f32_16x16x32_bf16 v[112:115], a[16:19], a[8:11], v[112:115]
    s_mov_b64 exec, 0xf
    buffer_load_dword v13, v16, s[32:35], s86 offen offset:384 sc1
    s_mov_b64 exec, -1
    v_mfma_f32_16x16x32_bf16 v[116:119], a[20:23], a[8:11], v[116:119]
    v_mfma_f32_16x16x32_bf16 v[120:123], a[24:27], a[8:11], v[120:123]
    v_mfma_f32_16x16x32_bf16 v[124:127], a[28:31], a[8:11], v[124:127]
    ds_read_b32 v255, v254
    s_waitcnt vmcnt(9) lgkmcnt(1)
    s_barrier
    v_mfma_f32_16x16x32_bf16 v[136:139], a[72:75], a[72:75], 0
    s_bfe_u32 s74, s84, 0x30018
    ds_read_b128 a[32:35], v35 offset:8192
    v_mfma_f32_16x16x32_bf16 v[140:143], v[26:29], a[72:75], 0
    s_add_u32 m0, s76, 16384
    ds_read_b64_tr_b16 a[0:1], v37 offset:24576
    v_mfma_f32_16x16x32_bf16 v[136:139], a[76:79], a[76:79], v[136:139]
    s_lshl_b32 s75, s74, 263
    ds_read_b128 a[12:15], v33 offset:8192
    v_mfma_f32_16x16x32_bf16 v[140:143], v[26:29], a[76:79], v[140:143]
    ds_read_b64_tr_b16 a[2:3], v37 offset:25088
    buffer_load_dwordx4 v8, s[24:27], s75 offen  lds
    v_mfma_f32_16x16x32_bf16 v[136:139], a[80:83], a[80:83], v[136:139]
    s_mul_i32 s74, s74, 196608
    ds_read_b128 a[16:19], v33 offset:24576
    v_mfma_f32_16x16x32_bf16 v[140:143], v[26:29], a[80:83], v[140:143]
    ds_read_b64_tr_b16 a[4:5], v37 offset:25600
    v_mfma_f32_16x16x32_bf16 v[136:139], a[84:87], a[84:87], v[136:139]
    ds_read_b128 a[20:23], v33 offset:26624
    buffer_load_dwordx4 v9, s[24:27], s75 offen offset:1024  lds
    v_mfma_f32_16x16x32_bf16 v[140:143], v[26:29], a[84:87], v[140:143]
    s_add_u32 m0, s77, 40960
    ds_read_b64_tr_b16 a[6:7], v37 offset:26112
    v_mfma_f32_16x16x32_bf16 v[128:131], a[68:71], a[68:71], v[128:131]
    s_add_u32 s74, s74, s83
    ds_read_b128 a[24:27], v33 offset:28672
    v_mfma_f32_16x16x32_bf16 v[132:135], v[26:29], a[68:71], v[132:135]
    ds_read_b64_tr_b16 a[8:9], v37 offset:26624
    buffer_load_dwordx4 v10, s[28:31], s74 offen offset:0 lds
    v_mfma_f32_16x16x32_bf16 v[68:71], a[36:39], a[48:51], v[68:71]
    ds_read_b128 a[28:31], v33 offset:30720
    v_mfma_f32_16x16x32_bf16 v[72:75], a[36:39], a[52:55], v[72:75]
L_vis_v0_0:
    s_cbranch_execz L_ret_v0
    ds_read_b64_tr_b16 a[10:11], v37 offset:27136
    v_cndmask_b32 v136, v136, v137, s[10:11]
    v_mfma_f32_16x16x32_bf16 v[76:79], a[36:39], a[56:59], v[76:79]
    buffer_load_dwordx4 v10, s[28:31], s74 offen offset:1024 lds
    v_cndmask_b32 v138, v138, v139, s[10:11]
    v_mfma_f32_16x16x32_bf16 v[80:83], a[36:39], a[60:63], v[80:83]
    v_cndmask_b32 v141, v136, v138, s[12:13]
    s_mov_b64 exec, s[14:15]
    ds_write_b64 v48, v[140:141]
    s_mov_b64 exec, -1
    v_mfma_f32_16x16x32_bf16 v[84:87], a[36:39], a[64:67], v[84:87]
    v_mfma_f32_16x16x32_bf16 v[88:91], a[40:43], a[48:51], v[88:91]
    buffer_load_dwordx4 v10, s[28:31], s74 offen offset:2048 lds
    s_addk_i32 m0, 12288
    v_mfma_f32_16x16x32_bf16 v[92:95], a[40:43], a[52:55], v[92:95]
    s_add_u32 s74, s74, 98304
    v_mfma_f32_16x16x32_bf16 v[96:99], a[40:43], a[56:59], v[96:99]
    v_mfma_f32_16x16x32_bf16 v[100:103], a[40:43], a[60:63], v[100:103]
    buffer_load_dwordx4 v10, s[28:31], s74 offen offset:0 lds
    v_mfma_f32_16x16x32_bf16 v[104:107], a[40:43], a[64:67], v[104:107]
    v_mfma_f32_16x16x32_bf16 v[108:111], a[48:51], a[44:47], v[108:111]
    v_mfma_f32_16x16x32_bf16 v[112:115], a[52:55], a[44:47], v[112:115]
    buffer_load_dwordx4 v10, s[28:31], s74 offen offset:1024 lds
    v_mfma_f32_16x16x32_bf16 v[116:119], a[56:59], a[44:47], v[116:119]
    v_mfma_f32_16x16x32_bf16 v[120:123], a[60:63], a[44:47], v[120:123]
    v_mfma_f32_16x16x32_bf16 v[124:127], a[64:67], a[44:47], v[124:127]
    buffer_load_dwordx4 v10, s[28:31], s74 offen offset:2048 lds
    ds_read_b32 v255, v254
    s_waitcnt lgkmcnt(1)
    v_mfma_f32_16x16x32_bf16 v[128:131], a[32:35], a[32:35], v[128:131]
    ds_read_b128 a[68:71], v36 offset:8192
    v_mfma_f32_16x16x32_bf16 v[132:135], v[26:29], a[32:35], v[132:135]
    ds_read_b64_tr_b16 a[36:37], v37 offset:36864
    v_mfma_f32_16x16x32_bf16 v[68:71], a[0:3], a[12:15], v[68:71]
    ds_read_b128 a[48:51], v34 offset:8192
    v_mfma_f32_16x16x32_bf16 v[72:75], a[0:3], a[16:19], v[72:75]
    ds_read_b64_tr_b16 a[38:39], v37 offset:37376
    v_mfma_f32_16x16x32_bf16 v[76:79], a[0:3], a[20:23], v[76:79]
    ds_read_b128 a[52:55], v34 offset:24576
    v_mfma_f32_16x16x32_bf16 v[80:83], a[0:3], a[24:27], v[80:83]
    ds_read_b64_tr_b16 a[40:41], v37 offset:37888
    v_mfma_f32_16x16x32_bf16 v[84:87], a[0:3], a[28:31], v[84:87]
    ds_read_b128 a[56:59], v34 offset:26624
    v_mfma_f32_16x16x32_bf16 v[88:91], a[4:7], a[12:15], v[88:91]
    ds_read_b64_tr_b16 a[42:43], v37 offset:38400
    v_mfma_f32_16x16x32_bf16 v[92:95], a[4:7], a[16:19], v[92:95]
    ds_read_b128 a[60:63], v34 offset:28672
    v_mfma_f32_16x16x32_bf16 v[96:99], a[4:7], a[20:23], v[96:99]
    ds_read_b64_tr_b16 a[44:45], v37 offset:38912
    v_mfma_f32_16x16x32_bf16 v[100:103], a[4:7], a[24:27], v[100:103]
    ds_read_b128 a[64:67], v34 offset:30720
    v_mfma_f32_16x16x32_bf16 v[104:107], a[4:7], a[28:31], v[104:107]
    ds_read_b64_tr_b16 a[46:47], v37 offset:39424
    v_mfma_f32_16x16x32_bf16 v[108:111], a[12:15], a[8:11], v[108:111]
    v_mfma_f32_16x16x32_bf16 v[112:115], a[16:19], a[8:11], v[112:115]
    v_mfma_f32_16x16x32_bf16 v[116:119], a[20:23], a[8:11], v[116:119]
    v_mfma_f32_16x16x32_bf16 v[120:123], a[24:27], a[8:11], v[120:123]
    v_mfma_f32_16x16x32_bf16 v[124:127], a[28:31], a[8:11], v[124:127]
    ds_read_b32 v255, v254
    s_waitcnt vmcnt(9) lgkmcnt(1)
    s_barrier
    v_mfma_f32_16x16x32_bf16 v[128:131], a[68:71], a[68:71], v[128:131]
    s_bfe_u32 s74, s84, 0x3001c
    ds_read_b128 a[32:35], v35 offset:16384
    ds_read_b64_tr_b16 a[0:1], v37 offset:49152
    v_mfma_f32_16x16x32_bf16 v[132:135], v[26:29], a[68:71], v[132:135]
    s_add_u32 m0, s76, 24576
    ds_read_b128 a[12:15], v33 offset:10240
    v_mfma_f32_16x16x32_bf16 v[68:71], a[36:39], a[48:51], v[68:71]
    s_lshl_b32 s75, s74, 263
    ds_read_b64_tr_b16 a[2:3], v37 offset:49664
    v_mfma_f32_16x16x32_bf16 v[72:75], a[36:39], a[52:55], v[72:75]
    ds_read_b128 a[16:19], v33 offset:32768
    buffer_load_dwordx4 v8, s[24:27], s75 offen  lds
    v_mfma_f32_16x16x32_bf16 v[76:79], a[36:39], a[56:59], v[76:79]
    s_mul_i32 s74, s74, 196608
    ds_read_b64_tr_b16 a[4:5], v37 offset:50176
    v_mfma_f32_16x16x32_bf16 v[80:83], a[36:39], a[60:63], v[80:83]
    ds_read_b128 a[20:23], v33 offset:34816
    v_mfma_f32_16x16x32_bf16 v[84:87], a[36:39], a[64:67], v[84:87]
    ds_read_b64_tr_b16 a[6:7], v37 offset:50688
    buffer_load_dwordx4 v9, s[24:27], s75 offen offset:1024  lds
    v_mfma_f32_16x16x32_bf16 v[88:91], a[40:43], a[48:51], v[88:91]
    s_add_u32 m0, s77, 65536
    ds_read_b128 a[24:27], v33 offset:36864
    v_mfma_f32_16x16x32_bf16 v[92:95], a[40:43], a[52:55], v[92:95]
    s_add_u32 s74, s74, s83
    ds_read_b64_tr_b16 a[8:9], v37 offset:51200
    v_mfma_f32_16x16x32_bf16 v[96:99], a[40:43], a[56:59], v[96:99]
    ds_read_b128 a[28:31], v33 offset:38912
    buffer_load_dwordx4 v10, s[28:31], s74 offen offset:0 lds
    v_mfma_f32_16x16x32_bf16 v[100:103], a[40:43], a[60:63], v[100:103]
    ds_read_b64_tr_b16 a[10:11], v37 offset:51712
    v_mfma_f32_16x16x32_bf16 v[104:107], a[40:43], a[64:67], v[104:107]
    ds_read_b128 v[18:21], v49
    v_mfma_f32_16x16x32_bf16 v[108:111], a[48:51], a[44:47], v[108:111]
    ds_read_b128 v[22:25], v49 offset:16
    buffer_load_dwordx4 v10, s[28:31], s74 offen offset:1024 lds
    v_mfma_f32_16x16x32_bf16 v[112:115], a[52:55], a[44:47], v[112:115]
    v_mfma_f32_16x16x32_bf16 v[116:119], a[56:59], a[44:47], v[116:119]
    v_mfma_f32_16x16x32_bf16 v[120:123], a[60:63], a[44:47], v[120:123]
    buffer_load_dwordx4 v10, s[28:31], s74 offen offset:2048 lds
    s_add_u32 m0, s77, 77824
    v_mfma_f32_16x16x32_bf16 v[124:127], a[64:67], a[44:47], v[124:127]
    s_add_u32 s74, s74, 98304
    s_waitcnt lgkmcnt(0)
    v_mfma_f32_16x16x32_bf16 v[128:131], a[32:35], a[32:35], v[128:131]
    ds_read_b128 a[68:71], v36 offset:16384
    v_mfma_f32_16x16x32_bf16 v[132:135], v[26:29], a[32:35], v[132:135]
    ds_read_b64_tr_b16 a[36:37], v37 offset:61440
    buffer_load_dwordx4 v10, s[28:31], s74 offen offset:0 lds
    v_mfma_f32_16x16x32_bf16 v[68:71], a[0:3], a[12:15], v[68:71]
    ds_read_b128 a[48:51], v34 offset:10240
    v_mfma_f32_16x16x32_bf16 v[72:75], a[0:3], a[16:19], v[72:75]
    ds_read_b64_tr_b16 a[38:39], v37 offset:61952
    v_mfma_f32_16x16x32_bf16 v[76:79], a[0:3], a[20:23], v[76:79]
    ds_read_b128 a[52:55], v34 offset:32768
    buffer_load_dwordx4 v10, s[28:31], s74 offen offset:1024 lds
    v_mfma_f32_16x16x32_bf16 v[80:83], a[0:3], a[24:27], v[80:83]
    ds_read_b64_tr_b16 a[40:41], v37 offset:62464
    v_mfma_f32_16x16x32_bf16 v[84:87], a[0:3], a[28:31], v[84:87]
    ds_read_b128 a[56:59], v34 offset:34816
    v_mfma_f32_16x16x32_bf16 v[88:91], a[4:7], a[12:15], v[88:91]
    ds_read_b64_tr_b16 a[42:43], v37 offset:62976
    buffer_load_dwordx4 v10, s[28:31], s74 offen offset:2048 lds
    v_mfma_f32_16x16x32_bf16 v[92:95], a[4:7], a[16:19], v[92:95]
    ds_read_b128 a[60:63], v34 offset:36864
    v_mfma_f32_16x16x32_bf16 v[96:99], a[4:7], a[20:23], v[96:99]
    ds_read_b64_tr_b16 a[44:45], v37 offset:63488
    v_mfma_f32_16x16x32_bf16 v[100:103], a[4:7], a[24:27], v[100:103]
    ds_read_b128 a[64:67], v34 offset:38912
    s_mov_b64 exec, 0xffff
    buffer_load_dword v13, v15, s[44:47], s87 offen sc1
    s_mov_b64 exec, -1
    v_mfma_f32_16x16x32_bf16 v[104:107], a[4:7], a[28:31], v[104:107]
    s_and_b32 s86, s60, 1
    ds_read_b64_tr_b16 a[46:47], v37 offset:64000
    v_mfma_f32_16x16x32_bf16 v[108:111], a[12:15], a[8:11], v[108:111]
    s_lshl1_add_u32 s86, s2, s86
    s_mul_i32 s86, s86, 2816
    v_mfma_f32_16x16x32_bf16 v[112:115], a[16:19], a[8:11], v[112:115]
    s_mov_b64 exec, 0x3fffff
    buffer_load_dword v13, v12, s[36:39], s86 offen sc1
    s_mov_b64 exec, -1
    v_mfma_f32_16x16x32_bf16 v[116:119], a[20:23], a[8:11], v[116:119]
    v_add_f32_e64 v18, v18, v20
    v_add_f32_e64 v19, v19, v21
    v_mfma_f32_16x16x32_bf16 v[120:123], a[24:27], a[8:11], v[120:123]
    v_add_f32_e64 v22, v22, v24
    v_add_f32 v23, v23, v25
    v_mfma_f32_16x16x32_bf16 v[124:127], a[28:31], a[8:11], v[124:127]
    s_mov_b64 exec, 0x3ffff
    buffer_load_dword v13, v14, s[48:51], s73 offen sc1
    s_mov_b64 exec, -1
    s_waitcnt vmcnt(11) lgkmcnt(0)
    s_barrier
    v_mfma_f32_16x16x32_bf16 v[128:131], a[68:71], a[68:71], v[128:131]
    ds_read_b128 a[32:35], v35 offset:0
    v_mfma_f32_16x16x32_bf16 v[132:135], v[26:29], a[68:71], v[132:135]
    ds_read_b64_tr_b16 a[0:1], v37 offset:0
    v_mfma_f32_16x16x32_bf16 v[68:71], a[36:39], a[48:51], v[68:71]
    ds_read_b128 a[12:15], v33 offset:12288
    v_mfma_f32_16x16x32_bf16 v[72:75], a[36:39], a[52:55], v[72:75]
    ds_read_b64_tr_b16 a[2:3], v37 offset:512
    v_mfma_f32_16x16x32_bf16 v[76:79], a[36:39], a[56:59], v[76:79]
    ds_read_b128 a[16:19], v33 offset:16384
    v_mfma_f32_16x16x32_bf16 v[80:83], a[36:39], a[60:63], v[80:83]
    ds_read_b64_tr_b16 a[4:5], v37 offset:1024
    v_mfma_f32_16x16x32_bf16 v[84:87], a[36:39], a[64:67], v[84:87]
    ds_read_b128 a[20:23], v33 offset:18432
    v_mfma_f32_16x16x32_bf16 v[88:91], a[40:43], a[48:51], v[88:91]
    ds_read_b64_tr_b16 a[6:7], v37 offset:1536
    v_mfma_f32_16x16x32_bf16 v[92:95], a[40:43], a[52:55], v[92:95]
    ds_read_b128 a[24:27], v33 offset:20480
    v_mfma_f32_16x16x32_bf16 v[96:99], a[40:43], a[56:59], v[96:99]
    ds_read_b64_tr_b16 a[8:9], v37 offset:2048
    v_mfma_f32_16x16x32_bf16 v[100:103], a[40:43], a[60:63], v[100:103]
    ds_read_b128 a[28:31], v33 offset:22528
    v_mfma_f32_16x16x32_bf16 v[104:107], a[40:43], a[64:67], v[104:107]
    ds_read_b64_tr_b16 a[10:11], v37 offset:2560
    v_add_f32_e64 v18, v18, v22
    v_mfma_f32_16x16x32_bf16 v[108:111], a[48:51], a[44:47], v[108:111]
    v_add_f32_e64 v19, v19, v23
    v_mul_f32 v18, 0xbb000000, v18
    v_mfma_f32_16x16x32_bf16 v[112:115], a[52:55], a[44:47], v[112:115]
    v_fma_f32 v19, v19, s1, v30
    v_cvt_pk_bf16_f32 v153, v18, v18
    v_mfma_f32_16x16x32_bf16 v[116:119], a[56:59], a[44:47], v[116:119]
    v_fma_f32 v19, -v18, v18, v19
    v_max_f32_e64 v19, v19, v30
    v_mfma_f32_16x16x32_bf16 v[120:123], a[60:63], a[44:47], v[120:123]
    v_rsq_f32 v154, v19
    v_mfma_f32_16x16x32_bf16 v[124:127], a[64:67], a[44:47], v[124:127]
    v_and_b32 v152, 0xffff0000, v153
    v_mul_f32 v155, 0x3eb8aa3b, v154
    s_waitcnt lgkmcnt(0)
    v_mfma_f32_16x16x32_bf16 v[128:131], a[32:35], a[32:35], v[128:131]
    ds_read_b128 a[68:71], v36 offset:0
    v_mfma_f32_16x16x32_bf16 v[132:135], v[26:29], a[32:35], v[132:135]
    ds_read_b64_tr_b16 a[36:37], v37 offset:12288
    v_mfma_f32_16x16x32_bf16 v[68:71], a[0:3], a[12:15], v[68:71]
    ds_read_b128 a[48:51], v34 offset:12288
    v_mfma_f32_16x16x32_bf16 v[72:75], a[0:3], a[16:19], v[72:75]
    ds_read_b64_tr_b16 a[38:39], v37 offset:12800
    v_mfma_f32_16x16x32_bf16 v[76:79], a[0:3], a[20:23], v[76:79]
    ds_read_b128 a[52:55], v34 offset:16384
    v_mfma_f32_16x16x32_bf16 v[80:83], a[0:3], a[24:27], v[80:83]
    ds_read_b64_tr_b16 a[40:41], v37 offset:13312
    v_mfma_f32_16x16x32_bf16 v[84:87], a[0:3], a[28:31], v[84:87]
    ds_read_b128 a[56:59], v34 offset:18432
    v_mfma_f32_16x16x32_bf16 v[88:91], a[4:7], a[12:15], v[88:91]
    ds_read_b64_tr_b16 a[42:43], v37 offset:13824
    v_mfma_f32_16x16x32_bf16 v[92:95], a[4:7], a[16:19], v[92:95]
    ds_read_b128 a[60:63], v34 offset:20480
    v_mfma_f32_16x16x32_bf16 v[96:99], a[4:7], a[20:23], v[96:99]
    ds_read_b64_tr_b16 a[44:45], v37 offset:14336
    v_mfma_f32_16x16x32_bf16 v[100:103], a[4:7], a[24:27], v[100:103]
    ds_read_b128 a[64:67], v34 offset:22528
    v_mfma_f32_16x16x32_bf16 v[104:107], a[4:7], a[28:31], v[104:107]
    ds_read_b64_tr_b16 a[46:47], v37 offset:14848
    ds_write_b128 v46, v[152:155]
    v_mfma_f32_16x16x32_bf16 v[108:111], a[12:15], a[8:11], v[108:111]
    v_mfma_f32_16x16x32_bf16 v[112:115], a[16:19], a[8:11], v[112:115]
    v_mfma_f32_16x16x32_bf16 v[116:119], a[20:23], a[8:11], v[116:119]
    v_mfma_f32_16x16x32_bf16 v[120:123], a[24:27], a[8:11], v[120:123]
    v_mfma_f32_16x16x32_bf16 v[124:127], a[28:31], a[8:11], v[124:127]
    s_waitcnt vmcnt(3) lgkmcnt(0)
    s_barrier
    v_mfma_f32_16x16x32_bf16 v[128:131], a[68:71], a[68:71], v[128:131]
    s_add_u32 m0, s66, 114688
    ds_read_b128 a[32:35], v35 offset:8192
    v_mfma_f32_16x16x32_bf16 v[132:135], v[26:29], a[68:71], v[132:135]
    s_add_u32 s52, s78, 0
    ds_read_b64_tr_b16 a[0:1], v37 offset:24576
    v_mfma_f32_16x16x32_bf16 v[68:71], a[36:39], a[48:51], v[68:71]
    ds_read_b128 a[12:15], v33 offset:14336
    buffer_load_dwordx4 v11, s[32:35], s52 offen lds
    v_mfma_f32_16x16x32_bf16 v[72:75], a[36:39], a[52:55], v[72:75]
    s_addk_i32 m0, 4096
    ds_read_b64_tr_b16 a[2:3], v37 offset:25088
    v_mfma_f32_16x16x32_bf16 v[76:79], a[36:39], a[56:59], v[76:79]
    ds_read_b128 a[16:19], v33 offset:24576
    v_mfma_f32_16x16x32_bf16 v[80:83], a[36:39], a[60:63], v[80:83]
    ds_read_b64_tr_b16 a[4:5], v37 offset:25600
    buffer_load_dwordx4 v53, s[32:35], s52 offen lds
    v_mfma_f32_16x16x32_bf16 v[84:87], a[36:39], a[64:67], v[84:87]
    s_add_u32 m0, s66, 122880
    ds_read_b128 a[20:23], v33 offset:26624
    v_mfma_f32_16x16x32_bf16 v[88:91], a[40:43], a[48:51], v[88:91]
    s_add_u32 s52, s78, 65536
    ds_read_b64_tr_b16 a[6:7], v37 offset:26112
    v_mfma_f32_16x16x32_bf16 v[92:95], a[40:43], a[52:55], v[92:95]
    ds_read_b128 a[24:27], v33 offset:28672
    buffer_load_dwordx4 v11, s[32:35], s52 offen lds
    v_mfma_f32_16x16x32_bf16 v[96:99], a[40:43], a[56:59], v[96:99]
    s_addk_i32 m0, 4096
    ds_read_b64_tr_b16 a[8:9], v37 offset:26624
    v_mfma_f32_16x16x32_bf16 v[100:103], a[40:43], a[60:63], v[100:103]
    ds_read_b128 a[28:31], v33 offset:30720
    v_mfma_f32_16x16x32_bf16 v[104:107], a[40:43], a[64:67], v[104:107]
    ds_read_b64_tr_b16 a[10:11], v37 offset:27136
    buffer_load_dwordx4 v53, s[32:35], s52 offen lds
    v_mfma_f32_16x16x32_bf16 v[108:111], a[48:51], a[44:47], v[108:111]
    ds_read_b128 a[72:75], v36 offset:8192
    v_mfma_f32_16x16x32_bf16 v[112:115], a[52:55], a[44:47], v[112:115]
    v_mfma_f32_16x16x32_bf16 v[116:119], a[56:59], a[44:47], v[116:119]
    v_mfma_f32_16x16x32_bf16 v[120:123], a[60:63], a[44:47], v[120:123]
    v_mfma_f32_16x16x32_bf16 v[124:127], a[64:67], a[44:47], v[124:127]
    s_waitcnt lgkmcnt(0)
    v_mfma_f32_16x16x32_bf16 v[128:131], a[32:35], a[32:35], v[128:131]
    ds_read_b64_tr_b16 a[36:37], v37 offset:36864
    ds_read_b128 a[48:51], v34 offset:14336
    v_mfma_f32_16x16x32_bf16 v[132:135], v[26:29], a[32:35], v[132:135]
    ds_read_b64_tr_b16 a[38:39], v37 offset:37376
    ds_read_b128 a[52:55], v34 offset:24576
    v_mfma_f32_16x16x32_bf16 v[128:131], a[72:75], a[72:75], v[128:131]
    ds_read_b64_tr_b16 a[40:41], v37 offset:37888
    ds_read_b128 a[56:59], v34 offset:26624
    v_mfma_f32_16x16x32_bf16 v[132:135], v[26:29], a[72:75], v[132:135]
    ds_read_b64_tr_b16 a[42:43], v37 offset:38400
    v_mfma_f32_16x16x32_bf16 v[68:71], a[0:3], a[12:15], v[68:71]
    ds_read_b128 a[60:63], v34 offset:28672
    v_mfma_f32_16x16x32_bf16 v[72:75], a[0:3], a[16:19], v[72:75]
    ds_read_b64_tr_b16 a[44:45], v37 offset:38912
    v_mfma_f32_16x16x32_bf16 v[76:79], a[0:3], a[20:23], v[76:79]
    ds_read_b128 a[64:67], v34 offset:30720
    v_mfma_f32_16x16x32_bf16 v[80:83], a[0:3], a[24:27], v[80:83]
    ds_read_b64_tr_b16 a[46:47], v37 offset:39424
    v_mfma_f32_16x16x32_bf16 v[84:87], a[0:3], a[28:31], v[84:87]
    v_cndmask_b32 v128, v128, v129, s[10:11]
    v_cndmask_b32 v130, v130, v131, s[10:11]
    v_mfma_f32_16x16x32_bf16 v[88:91], a[4:7], a[12:15], v[88:91]
    v_cndmask_b32 v133, v128, v130, s[12:13]
    v_mul_f32 v132, 0xbb000000, v132
    v_mfma_f32_16x16x32_bf16 v[92:95], a[4:7], a[16:19], v[92:95]
    v_fma_f32 v133, v133, s1, v30
    v_cvt_pk_bf16_f32 v153, v132, v132
    v_mfma_f32_16x16x32_bf16 v[96:99], a[4:7], a[20:23], v[96:99]
    v_fma_f32 v133, -v132, v132, v133
    v_max_f32 v133, v133, v30
    v_mfma_f32_16x16x32_bf16 v[100:103], a[4:7], a[24:27], v[100:103]
    v_rsq_f32 v154, v133
    v_mfma_f32_16x16x32_bf16 v[104:107], a[4:7], a[28:31], v[104:107]
    v_and_b32 v152, 0xffff0000, v153
    v_mul_f32 v155, 0x3eb8aa3b, v154
    v_mfma_f32_16x16x32_bf16 v[108:111], a[12:15], a[8:11], v[108:111]
    s_mov_b64 exec, s[14:15]
    ds_write_b128 v47, v[152:155] offset:256
    s_mov_b64 exec, -1
    v_mfma_f32_16x16x32_bf16 v[112:115], a[16:19], a[8:11], v[112:115]
    v_mfma_f32_16x16x32_bf16 v[116:119], a[20:23], a[8:11], v[116:119]
    v_mfma_f32_16x16x32_bf16 v[120:123], a[24:27], a[8:11], v[120:123]
    v_mfma_f32_16x16x32_bf16 v[124:127], a[28:31], a[8:11], v[124:127]
    s_waitcnt lgkmcnt(0)
    s_barrier
    v_mfma_f32_16x16x32_bf16 v[88:91], a[40:43], a[48:51], v[88:91]
    ds_read_b128 v[18:21], v46 offset:0
    ds_read_b128 v[22:25], v46 offset:256
    v_mfma_f32_16x16x32_bf16 v[68:71], a[36:39], a[48:51], v[68:71]
    ds_read_b32 v2, v51 offset:0
    ds_read_b128 v[38:41], v46 offset:512
    v_mfma_f32_16x16x32_bf16 v[108:111], a[48:51], a[44:47], v[108:111]
    ds_read_b32 v42, v51 offset:256
    ds_read_b128 v[136:139], v46 offset:768
    v_mfma_f32_16x16x32_bf16 v[92:95], a[40:43], a[52:55], v[92:95]
    ds_read_b32 v156, v51 offset:512
    ds_read_b128 v[140:143], v46 offset:1024
    v_mfma_f32_16x16x32_bf16 v[96:99], a[40:43], a[56:59], v[96:99]
    ds_read_b32 v158, v51 offset:768
    ds_read_b32 v3, v52 offset:32
    v_mfma_f32_16x16x32_bf16 v[100:103], a[40:43], a[60:63], v[100:103]
    ds_read_b32 v43, v52 offset:288
    ds_read_b32 v157, v52 offset:544
    v_mfma_f32_16x16x32_bf16 v[104:107], a[40:43], a[64:67], v[104:107]
    ds_read_b32 v159, v52 offset:800
    v_mov_b32_e64 v168, 0
    v_mfma_f32_16x16x32_bf16 v[72:75], a[36:39], a[52:55], v[72:75]
    v_mov_b32_dpp v164, v88 row_newbcast:0 row_mask:0xf bank_mask:0xf
    v_mov_b32_dpp v165, v89 row_newbcast:0 row_mask:0xf bank_mask:0xf
    v_mfma_f32_16x16x32_bf16 v[76:79], a[36:39], a[56:59], v[76:79]
    v_mov_b32_dpp v166, v90 row_newbcast:0 row_mask:0xf bank_mask:0xf
    v_mov_b32_dpp v167, v91 row_newbcast:0 row_mask:0xf bank_mask:0xf
    v_mfma_f32_16x16x32_bf16 v[80:83], a[36:39], a[60:63], v[80:83]
    v_mov_b32_dpp v160, v68 row_newbcast:0 row_mask:0xf bank_mask:0xf
    v_mov_b32_dpp v161, v69 row_newbcast:0 row_mask:0xf bank_mask:0xf
    v_mfma_f32_16x16x32_bf16 v[84:87], a[36:39], a[64:67], v[84:87]
    v_mov_b32_dpp v162, v70 row_newbcast:0 row_mask:0xf bank_mask:0xf
    v_mov_b32_dpp v163, v71 row_newbcast:0 row_mask:0xf bank_mask:0xf
    v_mfma_f32_16x16x32_bf16 v[112:115], a[52:55], a[44:47], v[112:115]
    v_cvt_pk_bf16_f32 v4, v108, v108
    v_mov_b32 v169, 0
    v_mfma_f32_16x16x32_bf16 v[116:119], a[56:59], a[44:47], v[116:119]
    v_and_b32 v4, 0xffff0000, v4
    v_sub_f32 v5, v108, v4
    v_mfma_f32_16x16x32_bf16 v[120:123], a[60:63], a[44:47], v[120:123]
    s_mov_b64 exec, 0xffff
    v_cvt_pk_bf16_f32 v169, v4, v5
    s_mov_b64 exec, -1
    v_mfma_f32_16x16x32_bf16 v[124:127], a[64:67], a[44:47], v[124:127]
    s_waitcnt lgkmcnt(0)
    global_load_dword v7, v50, s[20:21] sc1
    v_pk_fma_f32 v[88:89], v[164:165], v[18:19], v[88:89] op_sel_hi:[1,0,1]
    v_pk_fma_f32 v[90:91], v[166:167], v[18:19], v[90:91] op_sel_hi:[1,0,1]
    v_pk_fma_f32 v[92:93], v[164:165], v[22:23], v[92:93] op_sel_hi:[1,0,1]
    v_pk_fma_f32 v[94:95], v[166:167], v[22:23], v[94:95] op_sel_hi:[1,0,1]
    v_pk_fma_f32 v[72:73], v[160:161], v[22:23], v[72:73] op_sel_hi:[1,0,1]
    v_pk_fma_f32 v[74:75], v[162:163], v[22:23], v[74:75] op_sel_hi:[1,0,1]
    v_pk_fma_f32 v[96:97], v[164:165], v[38:39], v[96:97] op_sel_hi:[1,0,1]
    v_pk_fma_f32 v[98:99], v[166:167], v[38:39], v[98:99] op_sel_hi:[1,0,1]
    s_add_u32 m0, s66, 131072
    s_add_u32 s52, s78, 131072
    buffer_load_dwordx4 v11, s[32:35], s52 offen lds
    v_pk_fma_f32 v[76:77], v[160:161], v[38:39], v[76:77] op_sel_hi:[1,0,1]
    v_pk_fma_f32 v[78:79], v[162:163], v[38:39], v[78:79] op_sel_hi:[1,0,1]
    v_pk_fma_f32 v[100:101], v[164:165], v[136:137], v[100:101] op_sel_hi:[1,0,1]
    v_pk_fma_f32 v[102:103], v[166:167], v[136:137], v[102:103] op_sel_hi:[1,0,1]
    v_pk_fma_f32 v[80:81], v[160:161], v[136:137], v[80:81] op_sel_hi:[1,0,1]
    v_pk_fma_f32 v[82:83], v[162:163], v[136:137], v[82:83] op_sel_hi:[1,0,1]
    v_pk_fma_f32 v[104:105], v[164:165], v[140:141], v[104:105] op_sel_hi:[1,0,1]
    v_pk_fma_f32 v[106:107], v[166:167], v[140:141], v[106:107] op_sel_hi:[1,0,1]
    v_pk_fma_f32 v[84:85], v[160:161], v[140:141], v[84:85] op_sel_hi:[1,0,1]
    v_pk_fma_f32 v[86:87], v[162:163], v[140:141], v[86:87] op_sel_hi:[1,0,1]
    v_pk_mul_f32 v[34:35], v[2:3], v[24:25] op_sel:[0,1] op_sel_hi:[1,1]
    v_pk_mul_f32 v[36:37], v[42:43], v[40:41] op_sel:[0,1] op_sel_hi:[1,1]
    v_pk_mul_f32 v[48:49], v[156:157], v[138:139] op_sel:[0,1] op_sel_hi:[1,1]
    v_pk_mul_f32 v[128:129], v[158:159], v[142:143] op_sel:[0,1] op_sel_hi:[1,1]
    s_addk_i32 m0, 4096
    s_nop 0
    buffer_load_dwordx4 v53, s[32:35], s52 offen lds
    v_mfma_f32_16x16x16_bf16 v[108:111], v[18:19], v[168:169], v[108:111]
    v_cvt_pk_bf16_f32 v170, v88, v89
    v_cvt_pk_bf16_f32 v171, v90, v91
    v_mfma_f32_16x16x16_bf16 v[112:115], v[22:23], v[168:169], v[112:115]
    v_cvt_pk_bf16_f32 v172, v92, v93
    v_cvt_pk_bf16_f32 v173, v94, v95
    v_mfma_f32_16x16x16_bf16 v[116:119], v[38:39], v[168:169], v[116:119]
    v_cvt_pk_bf16_f32 v182, v72, v73
    v_cvt_pk_bf16_f32 v183, v74, v75
    v_mfma_f32_16x16x16_bf16 v[120:123], v[136:137], v[168:169], v[120:123]
    s_add_u32 m0, s66, 139264
    s_add_u32 s52, s78, 196608
    buffer_load_dwordx4 v11, s[32:35], s52 offen lds
    v_cvt_pk_bf16_f32 v174, v96, v97
    v_cvt_pk_bf16_f32 v175, v98, v99
    v_mfma_f32_16x16x16_bf16 v[124:127], v[140:141], v[168:169], v[124:127]
    v_cvt_pk_bf16_f32 v184, v76, v77
    v_cvt_pk_bf16_f32 v185, v78, v79
    v_mfma_f32_16x16x16_bf16 v[88:91], v[170:171], v[182:183], 0
    v_cvt_pk_bf16_f32 v176, v100, v101
    v_cvt_pk_bf16_f32 v177, v102, v103
    v_mfma_f32_16x16x16_bf16 v[68:71], v[172:173], v[182:183], 0
    v_cvt_pk_bf16_f32 v186, v80, v81
    v_cvt_pk_bf16_f32 v187, v82, v83
    s_addk_i32 m0, 4096
    s_nop 0
    buffer_load_dwordx4 v53, s[32:35], s52 offen lds
    v_mfma_f32_16x16x16_bf16 v[92:95], v[172:173], v[184:185], 0
    v_cvt_pk_bf16_f32 v178, v104, v105
    v_cvt_pk_bf16_f32 v179, v106, v107
    v_mfma_f32_16x16x16_bf16 v[72:75], v[174:175], v[184:185], 0
    v_cvt_pk_bf16_f32 v188, v84, v85
    v_cvt_pk_bf16_f32 v189, v86, v87
    v_mfma_f32_16x16x16_bf16 v[96:99], v[174:175], v[186:187], 0
    v_mfma_f32_16x16x16_bf16 v[76:79], v[176:177], v[186:187], 0
    v_mfma_f32_16x16x16_bf16 v[100:103], v[176:177], v[188:189], 0
    s_add_u32 m0, s66, 147456
    s_add_u32 s52, s78, 262144
    buffer_load_dwordx4 v11, s[32:35], s52 offen lds
    v_mfma_f32_16x16x16_bf16 v[80:83], v[178:179], v[188:189], 0
    v_cndmask_b32 v88, v88, v89, s[10:11]
    v_cndmask_b32 v68, v68, v69, s[10:11]
    v_cndmask_b32 v130, v88, v68, s[16:17]
    v_cndmask_b32 v90, v90, v91, s[10:11]
    v_cndmask_b32 v70, v70, v71, s[10:11]
    v_cndmask_b32 v131, v90, v70, s[18:19]
    v_cndmask_b32 v92, v92, v93, s[10:11]
    v_cndmask_b32 v72, v72, v73, s[10:11]
    v_cndmask_b32 v152, v92, v72, s[16:17]
    v_cndmask_b32 v94, v94, v95, s[10:11]
    v_cndmask_b32 v74, v74, v75, s[10:11]
    v_cndmask_b32 v153, v94, v74, s[18:19]
    s_add_u32 m0, s66, 151552
    v_cndmask_b32 v96, v96, v97, s[10:11]
    buffer_load_dwordx4 v53, s[32:35], s52 offen lds
    v_cndmask_b32 v76, v76, v77, s[10:11]
    v_cndmask_b32 v154, v96, v76, s[16:17]
    v_cndmask_b32 v98, v98, v99, s[10:11]
    v_cndmask_b32 v78, v78, v79, s[10:11]
    v_cndmask_b32 v155, v98, v78, s[18:19]
    v_cndmask_b32 v100, v100, v101, s[10:11]
    v_cndmask_b32 v80, v80, v81, s[10:11]
    v_cndmask_b32 v200, v100, v80, s[16:17]
    v_cndmask_b32 v102, v102, v103, s[10:11]
    v_cndmask_b32 v82, v82, v83, s[10:11]
    v_cndmask_b32 v201, v102, v82, s[18:19]
    v_pk_fma_f32 v[130:131], v[130:131], v[34:35], v[54:55]
    v_pk_mul_f32 v[152:153], v[152:153], v[36:37]
    v_pk_mul_f32 v[154:155], v[154:155], v[48:49]
    s_add_u32 m0, s66, 155648
    s_add_u32 s52, s78, 327680
    buffer_load_dwordx4 v11, s[32:35], s52 offen lds
    v_pk_mul_f32 v[200:201], v[200:201], v[128:129]
    v_max_f32 v34, v130, v131
    v_max_f32 v48, v154, v155
    v_max_f32 v36, v152, v153
    v_max_f32 v128, v200, v201
    v_permlane32_swap_b32 v34, v48
    v_cvt_pk_bf16_f32 v190, v108, v109
    v_permlane32_swap_b32 v36, v128
    v_max_f32 v34, v34, v48
    v_max_f32 v36, v36, v128
    v_cvt_pk_bf16_f32 v191, v110, v111
    v_cvt_pk_bf16_f32 v192, v112, v113
    s_add_u32 m0, s66, 94208
    v_permlane16_swap_b32 v34, v36
    buffer_load_dwordx4 v53, s[32:35], s52 offen lds
    v_max_f32 v34, v34, v36
    v_mov_b32_e64 v36, v34
    v_cvt_pk_bf16_f32 v193, v114, v115
    v_cvt_pk_bf16_f32 v194, v116, v117
    v_permlane16_swap_b32 v34, v36
    v_mov_b32 v48, v34
    v_mov_b32_e64 v128, v36
    v_cvt_pk_bf16_f32 v195, v118, v119
    v_permlane32_swap_b32 v34, v48
    v_permlane32_swap_b32 v36, v128
    v_pk_add_f32 v[130:131], v[130:131], v[34:35] op_sel_hi:[1,0] neg_lo:[0,1] neg_hi:[0,1]
    s_add_u32 m0, s66, 98304
    s_add_u32 s52, s78, 393216
    buffer_load_dwordx4 v11, s[32:35], s52 offen lds
    v_pk_add_f32 v[152:153], v[152:153], v[36:37] op_sel_hi:[1,0] neg_lo:[0,1] neg_hi:[0,1]
    v_pk_add_f32 v[154:155], v[154:155], v[48:49] op_sel_hi:[1,0] neg_lo:[0,1] neg_hi:[0,1]
    v_pk_add_f32 v[200:201], v[200:201], v[128:129] op_sel_hi:[1,0] neg_lo:[0,1] neg_hi:[0,1]
    v_exp_f32 v130, v130
    v_exp_f32 v131, v131
    v_exp_f32 v152, v152
    v_exp_f32 v153, v153
    v_exp_f32 v154, v154
    v_exp_f32 v155, v155
    s_add_u32 m0, s66, 102400
    v_exp_f32 v200, v200
    buffer_load_dwordx4 v53, s[32:35], s52 offen lds
    v_exp_f32 v201, v201
    v_add_f32 v34, v130, v131
    v_add_f32 v48, v154, v155
    v_add_f32 v36, v152, v153
    v_add_f32 v128, v200, v201
    v_permlane32_swap_b32 v34, v48
    v_cvt_pk_bf16_f32 v196, v120, v121
    v_permlane32_swap_b32 v36, v128
    v_add_f32 v34, v34, v48
    v_add_f32 v36, v36, v128
    v_cvt_pk_bf16_f32 v197, v122, v123
    s_add_u32 m0, s66, 106496
    s_add_u32 s52, s78, 458752
    buffer_load_dwordx4 v11, s[32:35], s52 offen lds
    v_cvt_pk_bf16_f32 v198, v124, v125
    v_permlane16_swap_b32 v34, v36
    v_add_f32 v34, v34, v36
    v_rcp_f32_e64 v34, v34
    v_cvt_pk_bf16_f32 v199, v126, v127
    v_mov_b32_e64 v36, v34
    v_pk_mul_f32 v[2:3], v[130:131], v[2:3]
    v_pk_mul_f32 v[42:43], v[152:153], v[42:43]
    v_permlane16_swap_b32 v34, v36
    v_mov_b32 v48, v34
    v_mov_b32_e64 v128, v36
    s_add_u32 m0, s66, 110592
    v_pk_mul_f32 v[156:157], v[154:155], v[156:157]
    buffer_load_dwordx4 v53, s[32:35], s52 offen lds
    v_permlane32_swap_b32 v34, v48
    v_permlane32_swap_b32 v36, v128
    v_pk_mul_f32 v[158:159], v[200:201], v[158:159]
    v_pk_mul_f32 v[130:131], v[2:3], v[34:35] op_sel_hi:[1,0]
    v_pk_mul_f32 v[152:153], v[42:43], v[36:37] op_sel_hi:[1,0]
    v_pk_mul_f32 v[154:155], v[156:157], v[48:49] op_sel_hi:[1,0]
    v_pk_mul_f32 v[200:201], v[158:159], v[128:129] op_sel_hi:[1,0]
    v_cvt_pk_bf16_f32 v130, v130, v131
    v_cvt_pk_bf16_f32 v152, v152, v153
    v_cvt_pk_bf16_f32 v154, v154, v155
    v_cvt_pk_bf16_f32 v200, v200, v201
    v_perm_b32 v88, v130, v130, v56
    v_perm_b32 v89, v130, v130, v57
    v_perm_b32 v90, v130, v130, v58
    v_perm_b32 v91, v130, v130, v59
    v_perm_b32 v92, v152, v152, v56
    v_perm_b32 v93, v152, v152, v57
    v_mfma_f32_16x16x32_bf16 v[68:71], v[190:193], v[88:91], 0
L_vis_v0_1:
    s_cbranch_execz L_ret_v0
    v_perm_b32 v94, v152, v152, v58
    v_perm_b32 v95, v152, v152, v59
    v_perm_b32 v96, v154, v154, v56
    v_perm_b32 v97, v154, v154, v57
    v_mfma_f32_16x16x32_bf16 v[72:75], v[192:195], v[92:95], 0
    s_waitcnt vmcnt(12)
    v_and_b32 v8, 16, v7
    v_readlane_b32 s82, v7, s64
    v_cmp_eq_u32 vcc, 0, v8
    s_cmp_lg_u32 s3, s82
    s_cselect_b64 vcc, -1, vcc
    s_cbranch_vccnz L_notfast
L_mode_ok:
    s_mov_b32 m0, s22
    s_mov_b32 exec_hi, 0
    buffer_load_dwordx4 v17, s[48:51], s23 offen sc1 lds
    s_mov_b32 exec_hi, -1
    v_perm_b32 v98, v154, v154, v58
    v_perm_b32 v99, v154, v154, v59
    v_perm_b32 v100, v200, v200, v56
    v_perm_b32 v101, v200, v200, v57
    v_mfma_f32_16x16x32_bf16 v[76:79], v[194:197], v[96:99], 0
    v_perm_b32 v102, v200, v200, v58
    v_perm_b32 v103, v200, v200, v59
    v_cvt_pk_bf16_f32 v108, v68, v69
    v_cvt_pk_bf16_f32 v109, v70, v71
    v_mfma_f32_16x16x32_bf16 v[80:83], v[196:199], v[100:103], 0
    s_add_u32 s67, s87, 32768
    v_cvt_pk_bf16_f32 v110, v72, v73
    v_cvt_pk_bf16_f32 v111, v74, v75
    v_cvt_pk_bf16_f32 v112, v76, v77
    v_cvt_pk_bf16_f32 v113, v78, v79
    v_permlane16_swap_b32 v108, v110
    v_permlane16_swap_b32 v109, v111
    s_nop 0
    v_cvt_pk_bf16_f32 v114, v80, v81
    v_cvt_pk_bf16_f32 v115, v82, v83
    buffer_store_dwordx4 v[108:111], v17, s[44:47], s87 offen
    v_permlane16_swap_b32 v112, v114
    v_permlane16_swap_b32 v113, v115
    buffer_store_dwordx4 v[112:115], v17, s[44:47], s67 offen
    s_add_u32 m0, s66, 90112
    s_mov_b32 s38, s8
    buffer_load_dwordx4 v60, s[36:39], 0 offen lds
    v_lshl_add_u32 v4, v32, 10, v45
    v_add_u32 v4, 94208, v4
    v_xor_b32 v5, 0, v44
    v_add_u32 v7, v4, v5
    v_xor_b32 v5, 32, v44
    v_add_u32 v8, v4, v5
    v_xor_b32 v5, 64, v44
    v_add_u32 v9, v4, v5
    s_add_u32 m0, s66, 32768
    v_xor_b32 v5, 96, v44
    buffer_load_dwordx4 v61, s[36:39], 0 offen lds
    v_add_u32 v10, v4, v5
    s_lshl_b32 s67, s63, 5
    v_and_b32 v4, 7, v1
    v_lshl_add_u32 v18, v4, 2, s67
    v_mov_b32 v2, 1
    s_lshr_b32 s67, s60, 1
    s_lshl_b32 s67, s67, 10
    s_and_b32 s68, s60, 1
    s_addk_i32 m0, 4096
    s_nop 0
    buffer_load_dwordx4 v62, s[36:39], 0 offen lds
    s_lshl_b32 s68, s68, 8
    v_lshlrev_b32 v21, 4, v31
    v_and_b32 v4, 1, v32
    v_lshl_add_u32 v4, v4, 9, v21
    v_add_u32 v4, s68, v4
    v_lshrrev_b32 v5, 1, v32
    v_lshl_add_u32 v20, v5, 11, v4
    v_lshl_add_u32 v19, v5, 10, v4
    s_add_u32 m0, s66, 40960
    s_mov_b32 s17, 176128
    buffer_load_dwordx4 v60, s[36:39], s17 offen lds
    s_lshl_b32 s3, s65, 16
    s_lshl_b32 s69, s67, 5
    s_add_u32 s3, s3, s69
    v_lshlrev_b32 v34, 16, v144
    v_and_b32 v35, 0xffff0000, v144
    v_lshlrev_b32 v36, 16, v145
    v_and_b32 v37, 0xffff0000, v145
    v_lshlrev_b32 v38, 16, v146
    v_and_b32 v39, 0xffff0000, v146
    v_lshlrev_b32 v40, 16, v147
    v_and_b32 v41, 0xffff0000, v147
    v_lshlrev_b32 v46, 16, v148
    v_and_b32 v47, 0xffff0000, v148
    v_lshlrev_b32 v48, 16, v149
    v_and_b32 v49, 0xffff0000, v149
    v_lshlrev_b32 v54, 16, v150
    v_and_b32 v55, 0xffff0000, v150
    v_lshlrev_b32_e64 v56, 16, v151
    v_and_b32 v57, 0xffff0000, v151
    s_lshl_b32 s16, s63, 11
    s_add_u32 s16, s16, s67
    s_lshr_b32 s67, s68, 5
    s_add_u32 s16, s16, s67
    s_lshl2_add_u32 s88, s68, s88
    s_and_b32 s67, s61, 6
    s_lshl_b32 s67, s67, 7
    s_add_u32 s16, s16, s67
    s_and_b32 s67, s61, 1
    s_lshl2_add_u32 s16, s67, s16
    s_add_u32 s16, s16, s73
    s_add_u32 s16, s16, 131072
    v_and_b32 v4, 1, v31
    v_mul_u32_u24 v4, 1088, v4
    v_lshl_add_u32 v4, v32, 4, v4
    v_add_u32 v23, 161536, v4
    v_mov_b32 v133, 0
    s_waitcnt vmcnt(4)
    s_barrier
    s_mov_b64 exec, s[4:5]
    buffer_store_dword v2, off, s[48:51], s79
    s_mov_b64 exec, -1
    s_addk_i32 m0, 4096
    ds_read_b64_tr_b16 a[0:1], v7 offset:20480
    buffer_load_dwordx4 v61, s[36:39], s17 offen lds
    ds_read_b64_tr_b16 a[2:3], v7 offset:20992
    ds_read_b64_tr_b16 a[4:5], v8 offset:20480
    ds_read_b64_tr_b16 a[6:7], v8 offset:20992
    ds_read_b64_tr_b16 a[8:9], v9 offset:20480
    ds_read_b64_tr_b16 a[10:11], v9 offset:20992
    ds_read_b64_tr_b16 a[12:13], v10 offset:20480
    ds_read_b64_tr_b16 a[14:15], v10 offset:20992
    ds_read_b128 v[68:71], v23 offset:0
    s_add_u32 m0, s66, 49152
    ds_read_b64_tr_b16 a[16:17], v7 offset:24576
    buffer_load_dwordx4 v62, s[36:39], s17 offen lds
    ds_read_b64_tr_b16 a[18:19], v7 offset:25088
    ds_read_b64_tr_b16 a[20:21], v8 offset:24576
    ds_read_b64_tr_b16 a[22:23], v8 offset:25088
    ds_read_b64_tr_b16 a[24:25], v9 offset:24576
    ds_read_b64_tr_b16 a[26:27], v9 offset:25088
    ds_read_b64_tr_b16 a[28:29], v10 offset:24576
    ds_read_b64_tr_b16 a[30:31], v10 offset:25088
    ds_read_b128 v[72:75], v23 offset:64
    s_add_u32 m0, s66, 53248
    s_mov_b32 s18, 352256
    buffer_load_dwordx4 v60, s[36:39], s18 offen lds
    ds_read_b64_tr_b16 a[32:33], v7 offset:28672
    ds_read_b64_tr_b16 a[34:35], v7 offset:29184
    ds_read_b64_tr_b16 a[36:37], v8 offset:28672
    ds_read_b64_tr_b16 a[38:39], v8 offset:29184
    ds_read_b64_tr_b16 a[40:41], v9 offset:28672
    ds_read_b64_tr_b16 a[42:43], v9 offset:29184
    ds_read_b64_tr_b16 a[44:45], v10 offset:28672
    ds_read_b64_tr_b16 a[46:47], v10 offset:29184
    s_add_u32 m0, s66, 57344
    ds_read_b128 v[76:79], v23 offset:128
    buffer_load_dwordx4 v61, s[36:39], s18 offen lds
    ds_read_b64_tr_b16 a[48:49], v7 offset:32768
    ds_read_b64_tr_b16 a[50:51], v7 offset:33280
    ds_read_b64_tr_b16 a[52:53], v8 offset:32768
    ds_read_b64_tr_b16 a[54:55], v8 offset:33280
    ds_read_b64_tr_b16 a[56:57], v9 offset:32768
    ds_read_b64_tr_b16 a[58:59], v9 offset:33280
    ds_read_b64_tr_b16 a[60:61], v10 offset:32768
    ds_read_b64_tr_b16 a[62:63], v10 offset:33280
    ds_read_b128 v[80:83], v23 offset:192
    s_mov_b64 exec, 0
    s_cmp_eq_u32 s60, 0
    s_cbranch_scc1 L_vis_v1_0
    s_cmp_eq_u32 s60, 1
    s_cbranch_scc1 L_vis_v1_1
    s_cmp_eq_u32 s60, 2
    s_cbranch_scc1 L_vis_v1_2
    s_cmp_eq_u32 s60, 3
    s_nop 0
L_ret_v1:
    s_mov_b64 exec, -1
    s_mov_b64 exec, s[6:7]
    buffer_load_dword v3, v18, s[48:51], s71 offen offset:0 sc1
    s_mov_b64 exec, -1
    s_add_u32 m0, s66, 61440
    ds_read_b64_tr_b16 a[64:65], v7 offset:36864
    buffer_load_dwordx4 v62, s[36:39], s18 offen lds
    ds_read_b64_tr_b16 a[66:67], v7 offset:37376
    ds_read_b64_tr_b16 a[68:69], v8 offset:36864
    ds_read_b64_tr_b16 a[70:71], v8 offset:37376
    ds_read_b64_tr_b16 a[72:73], v9 offset:36864
    ds_read_b64_tr_b16 a[74:75], v9 offset:37376
    ds_read_b64_tr_b16 a[76:77], v10 offset:36864
    ds_read_b64_tr_b16 a[78:79], v10 offset:37376
    ds_read_b128 v[84:87], v23 offset:256
    s_add_u32 m0, s66, 16384
    s_mov_b32 s19, 528384
    buffer_load_dwordx4 v60, s[36:39], s19 offen lds
    ds_read_b64_tr_b16 a[80:81], v7 offset:40960
    ds_read_b64_tr_b16 a[82:83], v7 offset:41472
    ds_read_b64_tr_b16 a[84:85], v8 offset:40960
    ds_read_b64_tr_b16 a[86:87], v8 offset:41472
    ds_read_b64_tr_b16 a[88:89], v9 offset:40960
    ds_read_b64_tr_b16 a[90:91], v9 offset:41472
    ds_read_b64_tr_b16 a[92:93], v10 offset:40960
    ds_read_b64_tr_b16 a[94:95], v10 offset:41472
    s_add_u32 m0, s66, 20480
    ds_read_b128 v[88:91], v23 offset:320
    buffer_load_dwordx4 v61, s[36:39], s19 offen lds
    ds_read_b64_tr_b16 a[96:97], v7 offset:45056
    ds_read_b64_tr_b16 a[98:99], v7 offset:45568
    ds_read_b64_tr_b16 a[100:101], v8 offset:45056
    ds_read_b64_tr_b16 a[102:103], v8 offset:45568
    ds_read_b64_tr_b16 a[104:105], v9 offset:45056
    ds_read_b64_tr_b16 a[106:107], v9 offset:45568
    ds_read_b64_tr_b16 a[108:109], v10 offset:45056
    ds_read_b64_tr_b16 a[110:111], v10 offset:45568
    ds_read_b128 v[92:95], v23 offset:384
    s_waitcnt vmcnt(3)
    v_cmp_eq_u32 vcc, 0, v3
    s_nop 0
    s_and_b64 vcc, vcc, s[6:7]
    s_cbranch_vccnz L_late0
L_back0:
    s_barrier
    buffer_load_dwordx4 v[136:139], v19, s[44:47], s3 offen offset:0 sc1
    ds_read_b64_tr_b16 a[112:113], v7 offset:49152
    ds_read_b64_tr_b16 a[114:115], v7 offset:49664
    ds_read_b64_tr_b16 a[116:117], v8 offset:49152
    ds_read_b64_tr_b16 a[118:119], v8 offset:49664
    ds_read_b64_tr_b16 a[120:121], v9 offset:49152
    buffer_load_dwordx4 v[140:143], v19, s[44:47], s3 offen offset:2048 sc1
    ds_read_b64_tr_b16 a[122:123], v9 offset:49664
    ds_read_b64_tr_b16 a[124:125], v10 offset:49152
    ds_read_b64_tr_b16 a[126:127], v10 offset:49664
    ds_read_b128 v[96:99], v23 offset:448
    ds_read_b64_tr_b16 a[128:129], v7 offset:53248
    s_add_u32 s3, s3, 4096
    buffer_load_dwordx4 v[152:155], v19, s[44:47], s3 offen offset:0 sc1
    ds_read_b64_tr_b16 a[130:131], v7 offset:53760
    ds_read_b64_tr_b16 a[132:133], v8 offset:53248
    ds_read_b64_tr_b16 a[134:135], v8 offset:53760
    ds_read_b64_tr_b16 a[136:137], v9 offset:53248
    ds_read_b64_tr_b16 a[138:139], v9 offset:53760
    buffer_load_dwordx4 v[156:159], v19, s[44:47], s3 offen offset:2048 sc1
    ds_read_b64_tr_b16 a[140:141], v10 offset:53248
    ds_read_b64_tr_b16 a[142:143], v10 offset:53760
    ds_read_b128 v[100:103], v23 offset:512
    ds_read_b64_tr_b16 a[144:145], v7 offset:57344
    ds_read_b64_tr_b16 a[146:147], v7 offset:57856
    s_add_u32 s3, s3, 4096
    buffer_load_dwordx4 v[160:163], v19, s[44:47], s3 offen offset:0 sc1
    ds_read_b64_tr_b16 a[148:149], v8 offset:57344
    ds_read_b64_tr_b16 a[150:151], v8 offset:57856
    ds_read_b64_tr_b16 a[152:153], v9 offset:57344
    ds_read_b64_tr_b16 a[154:155], v9 offset:57856
    ds_read_b64_tr_b16 a[156:157], v10 offset:57344
    s_waitcnt vmcnt(4) lgkmcnt(14)
    v_mfma_f32_16x16x32_bf16 v[132:135], v[68:71], v[136:139], v[132:135]
    ds_read_b64_tr_b16 a[158:159], v10 offset:57856
    buffer_load_dwordx4 v[164:167], v19, s[44:47], s3 offen offset:2048 sc1
    v_mfma_f32_16x16x32_bf16 v[34:37], a[0:3], v[136:139], v[34:37]
    s_addk_i32 s3, 4096
    ds_read_b128 v[104:107], v23 offset:576
    v_mfma_f32_16x16x32_bf16 v[38:41], a[4:7], v[136:139], v[38:41]
    ds_read_b64_tr_b16 a[160:161], v7 offset:61440
    v_mfma_f32_16x16x32_bf16 v[46:49], a[8:11], v[136:139], v[46:49]
    ds_read_b64_tr_b16 a[162:163], v7 offset:61952
    v_mfma_f32_16x16x32_bf16 v[54:57], a[12:15], v[136:139], v[54:57]
    ds_read_b64_tr_b16 a[164:165], v8 offset:61440
    buffer_load_dwordx4 v[168:171], v19, s[44:47], s3 offen offset:0 sc1
    s_waitcnt vmcnt(5)
    v_mfma_f32_16x16x32_bf16 v[132:135], v[72:75], v[140:143], v[132:135]
    ds_read_b64_tr_b16 a[166:167], v8 offset:61952
    v_mfma_f32_16x16x32_bf16 v[34:37], a[16:19], v[140:143], v[34:37]
    ds_read_b64_tr_b16 a[168:169], v9 offset:61440
    v_mfma_f32_16x16x32_bf16 v[38:41], a[20:23], v[140:143], v[38:41]
    ds_read_b64_tr_b16 a[170:171], v9 offset:61952
    v_mfma_f32_16x16x32_bf16 v[46:49], a[24:27], v[140:143], v[46:49]
    ds_read_b64_tr_b16 a[172:173], v10 offset:61440
    buffer_load_dwordx4 v[172:175], v19, s[44:47], s3 offen offset:2048 sc1
    v_mfma_f32_16x16x32_bf16 v[54:57], a[28:31], v[140:143], v[54:57]
    s_addk_i32 s3, 4096
    ds_read_b64_tr_b16 a[174:175], v10 offset:61952
    s_waitcnt vmcnt(5)
    v_mfma_f32_16x16x32_bf16 v[132:135], v[76:79], v[152:155], v[132:135]
    ds_read_b128 v[108:111], v23 offset:640
    v_mfma_f32_16x16x32_bf16 v[34:37], a[32:35], v[152:155], v[34:37]
    ds_read_b64_tr_b16 a[176:177], v7 offset:0
    v_mfma_f32_16x16x32_bf16 v[38:41], a[36:39], v[152:155], v[38:41]
    ds_read_b64_tr_b16 a[178:179], v7 offset:512
    buffer_load_dwordx4 v[176:179], v19, s[44:47], s3 offen offset:0 sc1
    v_mfma_f32_16x16x32_bf16 v[46:49], a[40:43], v[152:155], v[46:49]
    ds_read_b64_tr_b16 a[180:181], v8 offset:0
    v_mfma_f32_16x16x32_bf16 v[54:57], a[44:47], v[152:155], v[54:57]
    ds_read_b64_tr_b16 a[182:183], v8 offset:512
    s_waitcnt vmcnt(5)
    v_mfma_f32_16x16x32_bf16 v[132:135], v[80:83], v[156:159], v[132:135]
    ds_read_b64_tr_b16 a[184:185], v9 offset:0
    v_mfma_f32_16x16x32_bf16 v[34:37], a[48:51], v[156:159], v[34:37]
    ds_read_b64_tr_b16 a[186:187], v9 offset:512
    buffer_load_dwordx4 v[180:183], v19, s[44:47], s3 offen offset:2048 sc1
    v_mfma_f32_16x16x32_bf16 v[38:41], a[52:55], v[156:159], v[38:41]
    s_addk_i32 s3, 4096
    ds_read_b64_tr_b16 a[188:189], v10 offset:0
    v_mfma_f32_16x16x32_bf16 v[46:49], a[56:59], v[156:159], v[46:49]
    ds_read_b64_tr_b16 a[190:191], v10 offset:512
    v_mfma_f32_16x16x32_bf16 v[54:57], a[60:63], v[156:159], v[54:57]
    ds_read_b128 v[112:115], v23 offset:704
    s_waitcnt vmcnt(5)
    v_mfma_f32_16x16x32_bf16 v[132:135], v[84:87], v[160:163], v[132:135]
    ds_read_b64_tr_b16 a[192:193], v7 offset:4096
    buffer_load_dwordx4 v[184:187], v19, s[44:47], s3 offen offset:0 sc1
    v_mfma_f32_16x16x32_bf16 v[34:37], a[64:67], v[160:163], v[34:37]
    ds_read_b64_tr_b16 a[194:195], v7 offset:4608
    v_mfma_f32_16x16x32_bf16 v[38:41], a[68:71], v[160:163], v[38:41]
    ds_read_b64_tr_b16 a[196:197], v8 offset:4096
    v_mfma_f32_16x16x32_bf16 v[46:49], a[72:75], v[160:163], v[46:49]
    ds_read_b64_tr_b16 a[198:199], v8 offset:4608
    v_mfma_f32_16x16x32_bf16 v[54:57], a[76:79], v[160:163], v[54:57]
    ds_read_b64_tr_b16 a[200:201], v9 offset:4096
    buffer_load_dwordx4 v[188:191], v19, s[44:47], s3 offen offset:2048 sc1
    s_waitcnt vmcnt(6)
    v_mfma_f32_16x16x32_bf16 v[132:135], v[88:91], v[164:167], v[132:135]
    s_addk_i32 s3, 4096
    ds_read_b64_tr_b16 a[202:203], v9 offset:4608
    v_mfma_f32_16x16x32_bf16 v[34:37], a[80:83], v[164:167], v[34:37]
    ds_read_b64_tr_b16 a[204:205], v10 offset:4096
    v_mfma_f32_16x16x32_bf16 v[38:41], a[84:87], v[164:167], v[38:41]
    ds_read_b64_tr_b16 a[206:207], v10 offset:4608
    v_mfma_f32_16x16x32_bf16 v[46:49], a[88:91], v[164:167], v[46:49]
    ds_read_b128 v[116:119], v23 offset:768
    buffer_load_dwordx4 v[192:195], v19, s[44:47], s3 offen offset:0 sc1
    v_mfma_f32_16x16x32_bf16 v[54:57], a[92:95], v[164:167], v[54:57]
    ds_read_b64_tr_b16 a[208:209], v7 offset:8192
    s_waitcnt vmcnt(6)
    v_mfma_f32_16x16x32_bf16 v[132:135], v[92:95], v[168:171], v[132:135]
    ds_read_b64_tr_b16 a[210:211], v7 offset:8704
    v_mfma_f32_16x16x32_bf16 v[34:37], a[96:99], v[168:171], v[34:37]
    ds_read_b64_tr_b16 a[212:213], v8 offset:8192
    v_mfma_f32_16x16x32_bf16 v[38:41], a[100:103], v[168:171], v[38:41]
    ds_read_b64_tr_b16 a[214:215], v8 offset:8704
    buffer_load_dwordx4 v[196:199], v19, s[44:47], s3 offen offset:2048 sc1
    v_mfma_f32_16x16x32_bf16 v[46:49], a[104:107], v[168:171], v[46:49]
    s_addk_i32 s3, 4096
    ds_read_b64_tr_b16 a[216:217], v9 offset:8192
    v_mfma_f32_16x16x32_bf16 v[54:57], a[108:111], v[168:171], v[54:57]
    ds_read_b64_tr_b16 a[218:219], v9 offset:8704
    s_waitcnt vmcnt(6)
    v_mfma_f32_16x16x32_bf16 v[132:135], v[96:99], v[172:175], v[132:135]
    ds_read_b64_tr_b16 a[220:221], v10 offset:8192
    v_mfma_f32_16x16x32_bf16 v[34:37], a[112:115], v[172:175], v[34:37]
    ds_read_b64_tr_b16 a[222:223], v10 offset:8704
    buffer_load_dwordx4 v[200:203], v19, s[44:47], s3 offen offset:0 sc1
    v_mfma_f32_16x16x32_bf16 v[38:41], a[116:119], v[172:175], v[38:41]
    ds_read_b128 v[120:123], v23 offset:832
    v_mfma_f32_16x16x32_bf16 v[46:49], a[120:123], v[172:175], v[46:49]
    ds_read_b64_tr_b16 a[224:225], v7 offset:12288
    v_mfma_f32_16x16x32_bf16 v[54:57], a[124:127], v[172:175], v[54:57]
    ds_read_b64_tr_b16 a[226:227], v7 offset:12800
    s_waitcnt vmcnt(6) lgkmcnt(14)
    v_mfma_f32_16x16x32_bf16 v[132:135], v[100:103], v[176:179], v[132:135]
    ds_read_b64_tr_b16 a[228:229], v8 offset:12288
    buffer_load_dwordx4 v[204:207], v19, s[44:47], s3 offen offset:2048 sc1
    v_mfma_f32_16x16x32_bf16 v[34:37], a[128:131], v[176:179], v[34:37]
    s_add_u32 m0, s66, 65536
    ds_read_b64_tr_b16 a[230:231], v8 offset:12800
    v_mfma_f32_16x16x32_bf16 v[38:41], a[132:135], v[176:179], v[38:41]
    ds_read_b64_tr_b16 a[232:233], v9 offset:12288
    v_mfma_f32_16x16x32_bf16 v[46:49], a[136:139], v[176:179], v[46:49]
    ds_read_b64_tr_b16 a[234:235], v9 offset:12800
    v_mfma_f32_16x16x32_bf16 v[54:57], a[140:143], v[176:179], v[54:57]
    ds_read_b64_tr_b16 a[236:237], v10 offset:12288
    buffer_load_dwordx4 v62, s[36:39], s19 offen lds
    s_waitcnt vmcnt(7)
    v_mfma_f32_16x16x32_bf16 v[132:135], v[104:107], v[180:183], v[132:135]
    s_addk_i32 m0, 4096
    ds_read_b64_tr_b16 a[238:239], v10 offset:12800
    v_mfma_f32_16x16x32_bf16 v[34:37], a[144:147], v[180:183], v[34:37]
    s_mov_b32 s22, 704512
    ds_read_b128 v[124:127], v23 offset:896
    v_mfma_f32_16x16x32_bf16 v[38:41], a[148:151], v[180:183], v[38:41]
    ds_read_b64_tr_b16 a[240:241], v7 offset:16384
    v_mfma_f32_16x16x32_bf16 v[46:49], a[152:155], v[180:183], v[46:49]
    ds_read_b64_tr_b16 a[242:243], v7 offset:16896
    buffer_load_dwordx4 v60, s[36:39], s22 offen lds
    v_mfma_f32_16x16x32_bf16 v[54:57], a[156:159], v[180:183], v[54:57]
    s_addk_i32 m0, 4096
    ds_read_b64_tr_b16 a[244:245], v8 offset:16384
    s_waitcnt vmcnt(7)
    v_mfma_f32_16x16x32_bf16 v[132:135], v[108:111], v[184:187], v[132:135]
    ds_read_b64_tr_b16 a[246:247], v8 offset:16896
    v_mfma_f32_16x16x32_bf16 v[34:37], a[160:163], v[184:187], v[34:37]
    ds_read_b64_tr_b16 a[248:249], v9 offset:16384
    v_mfma_f32_16x16x32_bf16 v[38:41], a[164:167], v[184:187], v[38:41]
    ds_read_b64_tr_b16 a[250:251], v9 offset:16896
    buffer_load_dwordx4 v61, s[36:39], s22 offen lds
    v_mfma_f32_16x16x32_bf16 v[46:49], a[168:171], v[184:187], v[46:49]
    s_add_u32 m0, s66, 77824
    ds_read_b64_tr_b16 a[252:253], v10 offset:16384
    v_mfma_f32_16x16x32_bf16 v[54:57], a[172:175], v[184:187], v[54:57]
    ds_read_b64_tr_b16 a[254:255], v10 offset:16896
    s_waitcnt vmcnt(7)
    v_mfma_f32_16x16x32_bf16 v[132:135], v[112:115], v[188:191], v[132:135]
    ds_read_b128 v[128:131], v23 offset:960
    v_mfma_f32_16x16x32_bf16 v[34:37], a[176:179], v[188:191], v[34:37]
    buffer_load_dwordx4 v62, s[36:39], s22 offen lds
    s_addk_i32 m0, 4096
    v_mfma_f32_16x16x32_bf16 v[38:41], a[180:183], v[188:191], v[38:41]
    s_mov_b32 s23, 880640
    v_mfma_f32_16x16x32_bf16 v[46:49], a[184:187], v[188:191], v[46:49]
    v_mfma_f32_16x16x32_bf16 v[54:57], a[188:191], v[188:191], v[54:57]
    s_waitcnt vmcnt(7) lgkmcnt(14)
    v_mfma_f32_16x16x32_bf16 v[132:135], v[116:119], v[192:195], v[132:135]
    buffer_load_dwordx4 v60, s[36:39], s23 offen lds
    v_mfma_f32_16x16x32_bf16 v[34:37], a[192:195], v[192:195], v[34:37]
    v_mfma_f32_16x16x32_bf16 v[38:41], a[196:199], v[192:195], v[38:41]
    v_mfma_f32_16x16x32_bf16 v[46:49], a[200:203], v[192:195], v[46:49]
    v_mfma_f32_16x16x32_bf16 v[54:57], a[204:207], v[192:195], v[54:57]
    s_waitcnt vmcnt(7)
    v_mfma_f32_16x16x32_bf16 v[132:135], v[120:123], v[196:199], v[132:135]
    v_mfma_f32_16x16x32_bf16 v[34:37], a[208:211], v[196:199], v[34:37]
    v_mfma_f32_16x16x32_bf16 v[38:41], a[212:215], v[196:199], v[38:41]
    v_mfma_f32_16x16x32_bf16 v[46:49], a[216:219], v[196:199], v[46:49]
    v_mfma_f32_16x16x32_bf16 v[54:57], a[220:223], v[196:199], v[54:57]
    s_waitcnt vmcnt(6) lgkmcnt(9)
    v_mfma_f32_16x16x32_bf16 v[132:135], v[124:127], v[200:203], v[132:135]
    v_mfma_f32_16x16x32_bf16 v[34:37], a[224:227], v[200:203], v[34:37]
    v_mfma_f32_16x16x32_bf16 v[38:41], a[228:231], v[200:203], v[38:41]
    v_mfma_f32_16x16x32_bf16 v[46:49], a[232:235], v[200:203], v[46:49]
    v_mfma_f32_16x16x32_bf16 v[54:57], a[236:239], v[200:203], v[54:57]
    s_waitcnt vmcnt(5) lgkmcnt(0)
    v_mfma_f32_16x16x32_bf16 v[132:135], v[128:131], v[204:207], v[132:135]
    v_mfma_f32_16x16x32_bf16 v[34:37], a[240:243], v[204:207], v[34:37]
    v_mfma_f32_16x16x32_bf16 v[38:41], a[244:247], v[204:207], v[38:41]
    v_mfma_f32_16x16x32_bf16 v[46:49], a[248:251], v[204:207], v[46:49]
    v_mfma_f32_16x16x32_bf16 v[54:57], a[252:255], v[204:207], v[54:57]
    s_barrier
    s_nop 2
    v_add_f32_e64 v132, v132, v133
    v_pk_add_f32 v[168:169], v[34:35], v[132:133] op_sel_hi:[1,0]
    v_pk_add_f32 v[170:171], v[36:37], v[132:133] op_sel_hi:[1,0]
    v_pk_add_f32 v[172:173], v[38:39], v[132:133] op_sel_hi:[1,0]
    v_pk_add_f32 v[174:175], v[40:41], v[132:133] op_sel_hi:[1,0]
    v_pk_add_f32 v[176:177], v[46:47], v[132:133] op_sel_hi:[1,0]
    v_pk_add_f32 v[178:179], v[48:49], v[132:133] op_sel_hi:[1,0]
    v_pk_add_f32 v[180:181], v[54:55], v[132:133] op_sel_hi:[1,0]
    v_pk_add_f32 v[182:183], v[56:57], v[132:133] op_sel_hi:[1,0]
    v_cvt_pk_bf16_f32 v136, v168, v170
    v_cvt_pk_bf16_f32 v137, v172, v174
    v_cvt_pk_bf16_f32 v138, v176, v178
    v_cvt_pk_bf16_f32 v139, v180, v182
    v_cvt_pk_bf16_f32 v140, v169, v171
    v_cvt_pk_bf16_f32 v141, v173, v175
    v_cvt_pk_bf16_f32 v142, v177, v179
    v_cvt_pk_bf16_f32 v143, v181, v183
    v_mfma_f32_16x16x32_bf16 v[152:155], v[136:139], v[136:139], 0
    buffer_store_dwordx4 v[136:139], v17, s[48:51], s88 offen
    v_mfma_f32_16x16x32_bf16 v[152:155], v[140:143], v[140:143], v[152:155]
    buffer_store_dwordx4 v[140:143], v17, s[48:51], s88 offen offset:2048
    v_cvt_pk_bf16_f32 v144, v34, v35
    v_cvt_pk_bf16_f32 v145, v36, v37
    v_cvt_pk_bf16_f32 v146, v38, v39
    v_cvt_pk_bf16_f32 v147, v40, v41
    v_cvt_pk_bf16_f32 v148, v46, v47
    v_cvt_pk_bf16_f32 v149, v48, v49
    v_cvt_pk_bf16_f32 v150, v54, v55
    v_cndmask_b32 v152, v152, v153, s[10:11]
    v_cndmask_b32 v154, v154, v155, s[10:11]
    v_cndmask_b32 v157, v152, v154, s[12:13]
    s_mov_b64 exec, s[14:15]
    buffer_store_dword v157, v21, s[48:51], s16 offen
    s_mov_b64 exec, -1
    v_cvt_pk_bf16_f32 v151, v56, v57
    s_addk_i32 m0, 4096
    v_lshlrev_b32 v4, 9, v32
    buffer_load_dwordx4 v61, s[36:39], s23 offen lds
    v_add3_u32 v7, v4, v45, v44
    v_xor_b32 v8, 32, v7
    v_xor_b32 v9, 64, v7
    v_xor_b32 v10, 96, v7
    s_add_u32 m0, s66, 24576
    v_lshrrev_b32 v4, 2, v1
    buffer_load_dwordx4 v62, s[36:39], s23 offen lds
    v_and_b32 v5, 3, v1
    v_lshlrev_b32 v5, 3, v5
    v_lshl_add_u32 v4, v4, 6, v5
    v_and_b32 v5, 1, v32
    s_add_u32 m0, s66, 28672
    s_mov_b32 s59, 1056768
    buffer_load_dwordx4 v60, s[36:39], s59 offen lds
    v_lshl_add_u32 v11, v5, 5, v4
    v_xor_b32 v14, 32, v11
    v_lshlrev_b32 v20, 2, v31
    s_lshl_b32 s70, s60, 15
    s_add_u32 m0, s66, 0
    s_nop 0
    buffer_load_dwordx4 v61, s[36:39], s59 offen lds
    s_add_u32 s3, s70, s73
    s_waitcnt vmcnt(4)
    s_barrier
    s_mov_b64 exec, s[4:5]
    buffer_store_dword v2, off, s[48:51], s79 offset:128
    s_mov_b64 exec, -1
    s_add_u32 m0, s66, 4096
    v_add_u32 v13, 65536, v7
    buffer_load_dwordx4 v62, s[36:39], s59 offen lds
    ds_read_b64_tr_b16 a[208:209], v13 offset:24576
    ds_read_b64_tr_b16 a[210:211], v7 offset:32768
    ds_read_b64_tr_b16 a[212:213], v13 offset:26624
    ds_read_b64_tr_b16 a[214:215], v7 offset:34816
    v_add_u32 v23, 65536, v8
    ds_read_b64_tr_b16 a[216:217], v23 offset:24576
    s_add_u32 m0, s66, 8192
    s_mov_b32 s74, 1232896
    buffer_load_dwordx4 v60, s[36:39], s74 offen lds
    ds_read_b64_tr_b16 a[218:219], v8 offset:32768
    ds_read_b64_tr_b16 a[220:221], v23 offset:26624
    ds_read_b64_tr_b16 a[222:223], v8 offset:34816
    ds_read_b64_tr_b16 a[224:225], v11 offset:36864
    ds_read_b64_tr_b16 a[226:227], v11 offset:37888
    ds_read_b64_tr_b16 a[228:229], v11 offset:38912
    s_add_u32 m0, s66, 12288
    ds_read_b64_tr_b16 a[230:231], v11 offset:39936
    buffer_load_dwordx4 v61, s[36:39], s74 offen lds
    s_add_u32 m0, s66, 94208
    s_nop 0
    buffer_load_dwordx4 v62, s[36:39], s74 offen lds
    s_addk_i32 m0, 4096
    s_mov_b32 s38, s9
    v_add_u32 v60, s56, v60
    v_add_u32 v61, s56, v61
    buffer_load_dwordx4 v60, s[36:39], 0 offen lds
    s_cmp_ge_u32 s62, 14
    s_cbranch_scc1 L_help
    s_mov_b64 exec, s[6:7]
    buffer_load_dword v3, v20, s[48:51], s71 offen offset:128 sc1
    s_mov_b64 exec, -1
    s_add_u32 m0, s66, 102400
    s_nop 0
    buffer_load_dwordx4 v61, s[36:39], 0 offen lds
    s_addk_i32 m0, 4096
    s_nop 0
    buffer_load_dwordx4 v60, s[36:39], s17 offen lds
    s_addk_i32 m0, 4096
    s_nop 0
    buffer_load_dwordx4 v61, s[36:39], s17 offen lds
    s_addk_i32 m0, 4096
    s_nop 0
    buffer_load_dwordx4 v60, s[36:39], s18 offen lds
    s_waitcnt vmcnt(4)
    v_cmp_eq_u32 vcc, 0, v3
    s_nop 0
    s_and_b64 vcc, vcc, s[6:7]
    s_cbranch_vccnz L_late2
L_back2:
    s_barrier
    buffer_load_dwordx4 a[0:3], v17, s[48:51], s3 offen offset:0 sc1
    buffer_load_dwordx4 a[4:7], v17, s[48:51], s3 offen offset:1024 sc1
    buffer_load_dwordx4 a[8:11], v17, s[48:51], s3 offen offset:2048 sc1
    buffer_load_dwordx4 a[12:15], v17, s[48:51], s3 offen offset:3072 sc1
    s_add_u32 s10, s66, s73
    s_add_u32 s10, s10, 131072
    s_lshl_b32 s68, s60, 15
    s_lshl_b32 s69, s62, 11
    s_add_u32 s69, s69, s68
    s_add_u32 s12, s69, s73
    s_lshl_b32 s15, s64, 17
    s_add_u32 s11, s15, s69
    s_lshr_b32 s68, s60, 1
    s_lshl1_add_u32 s68, s63, s68
    s_lshl_b32 s68, s68, 15
    s_add_u32 s15, s15, s68
    s_add_u32 s16, s73, s68
    s_and_b32 s58, s60, 1
    s_lshl_b32 s57, s58, 30
    s_add_u32 s57, s57, s15
    s_addk_i32 s3, 4096
    s_addk_i32 s57, 28672
    buffer_load_dwordx4 a[16:19], v17, s[48:51], s3 offen offset:0 sc1
    s_mul_i32 s68, s58, 3072
    v_add_u32 v22, s68, v17
    v_xor_b32 v21, 1024, v22
    v_lshl_add_u32 v15, s58, 11, v7
    v_lshl_add_u32 v16, s58, 11, v8
    v_lshl_add_u32 v18, s58, 11, v9
    v_lshl_add_u32 v19, s58, 11, v10
    buffer_load_dwordx4 a[20:23], v17, s[48:51], s3 offen offset:1024 sc1
    buffer_load_dwordx4 a[24:27], v17, s[48:51], s3 offen offset:2048 sc1
    buffer_load_dwordx4 a[28:31], v17, s[48:51], s3 offen offset:3072 sc1
    s_add_u32 s3, s3, 4096
    buffer_load_dwordx4 a[32:35], v17, s[48:51], s3 offen offset:0 sc1
    s_waitcnt vmcnt(7) lgkmcnt(10)
    v_mfma_f32_16x16x32_bf16 v[34:37], a[208:211], a[0:3], 0
    ds_read_b64_tr_b16 a[232:233], v14 offset:36864
    ds_read_b64_tr_b16 a[234:235], v14 offset:37888
    v_mfma_f32_16x16x32_bf16 v[38:41], a[208:211], a[4:7], 0
    buffer_load_dwordx4 a[36:39], v17, s[48:51], s3 offen offset:1024 sc1
    s_waitcnt lgkmcnt(10)
    v_mfma_f32_16x16x32_bf16 v[42:45], a[212:215], a[0:3], 0
    ds_read_b64_tr_b16 a[236:237], v14 offset:38912
    v_mfma_f32_16x16x32_bf16 v[46:49], a[212:215], a[4:7], 0
    ds_read_b64_tr_b16 a[238:239], v14 offset:39936
    s_waitcnt lgkmcnt(10)
    v_mfma_f32_16x16x32_bf16 v[68:71], a[216:219], a[0:3], 0
    ds_read_b64_tr_b16 a[240:241], v7 offset:40960
    v_mfma_f32_16x16x32_bf16 v[72:75], a[216:219], a[4:7], 0
    ds_read_b64_tr_b16 a[242:243], v7 offset:45056
L_vis_v0_2:
    s_cbranch_execz L_ret_v0
    s_waitcnt lgkmcnt(10)
    v_mfma_f32_16x16x32_bf16 v[76:79], a[220:223], a[0:3], 0
    ds_read_b64_tr_b16 a[244:245], v7 offset:43008
    ds_read_b64_tr_b16 a[246:247], v7 offset:47104
    v_mfma_f32_16x16x32_bf16 v[80:83], a[220:223], a[4:7], 0
    s_waitcnt lgkmcnt(4)
    buffer_load_dwordx4 a[40:43], v17, s[48:51], s3 offen offset:2048 sc1
    s_waitcnt vmcnt(7)
    v_mfma_f32_16x16x32_bf16 v[34:37], a[224:227], a[8:11], v[34:37]
    ds_read_b64_tr_b16 a[248:249], v8 offset:40960
    ds_read_b64_tr_b16 a[250:251], v8 offset:45056
    v_mfma_f32_16x16x32_bf16 v[38:41], a[224:227], a[12:15], v[38:41]
    buffer_load_dwordx4 a[44:47], v17, s[48:51], s3 offen offset:3072 sc1
    v_mfma_f32_16x16x32_bf16 v[42:45], a[228:231], a[8:11], v[42:45]
    ds_read_b64_tr_b16 a[252:253], v8 offset:43008
    v_mfma_f32_16x16x32_bf16 v[46:49], a[228:231], a[12:15], v[46:49]
    ds_read_b64_tr_b16 a[254:255], v8 offset:47104
    v_mfma_f32_16x16x32_bf16 v[68:71], a[232:235], a[8:11], v[68:71]
    ds_read_b64_tr_b16 a[208:209], v11 offset:49152
    v_mfma_f32_16x16x32_bf16 v[72:75], a[232:235], a[12:15], v[72:75]
    ds_read_b64_tr_b16 a[210:211], v11 offset:50176
    v_mfma_f32_16x16x32_bf16 v[76:79], a[236:239], a[8:11], v[76:79]
    s_addk_i32 s3, 4096
    ds_read_b64_tr_b16 a[212:213], v11 offset:51200
    ds_read_b64_tr_b16 a[214:215], v11 offset:52224
    v_mfma_f32_16x16x32_bf16 v[80:83], a[236:239], a[12:15], v[80:83]
    s_waitcnt lgkmcnt(4)
    buffer_load_dwordx4 a[48:51], v17, s[48:51], s3 offen offset:0 sc1
    s_waitcnt vmcnt(7)
    v_mfma_f32_16x16x32_bf16 v[34:37], a[240:243], a[16:19], v[34:37]
    ds_read_b64_tr_b16 a[216:217], v14 offset:49152
    ds_read_b64_tr_b16 a[218:219], v14 offset:50176
    v_mfma_f32_16x16x32_bf16 v[38:41], a[240:243], a[20:23], v[38:41]
    buffer_load_dwordx4 a[52:55], v17, s[48:51], s3 offen offset:1024 sc1
    v_mfma_f32_16x16x32_bf16 v[42:45], a[244:247], a[16:19], v[42:45]
    ds_read_b64_tr_b16 a[220:221], v14 offset:51200
    v_mfma_f32_16x16x32_bf16 v[46:49], a[244:247], a[20:23], v[46:49]
    ds_read_b64_tr_b16 a[222:223], v14 offset:52224
    v_mfma_f32_16x16x32_bf16 v[68:71], a[248:251], a[16:19], v[68:71]
    ds_read_b64_tr_b16 a[224:225], v7 offset:53248
    v_mfma_f32_16x16x32_bf16 v[72:75], a[248:251], a[20:23], v[72:75]
    ds_read_b64_tr_b16 a[226:227], v7 offset:57344
    v_mfma_f32_16x16x32_bf16 v[76:79], a[252:255], a[16:19], v[76:79]
    ds_read_b64_tr_b16 a[228:229], v7 offset:55296
    ds_read_b64_tr_b16 a[230:231], v7 offset:59392
    v_mfma_f32_16x16x32_bf16 v[80:83], a[252:255], a[20:23], v[80:83]
    s_waitcnt lgkmcnt(4)
    buffer_load_dwordx4 a[56:59], v17, s[48:51], s3 offen offset:2048 sc1
    s_waitcnt vmcnt(7)
    v_mfma_f32_16x16x32_bf16 v[34:37], a[208:211], a[24:27], v[34:37]
    ds_read_b64_tr_b16 a[232:233], v8 offset:53248
    ds_read_b64_tr_b16 a[234:235], v8 offset:57344
    v_mfma_f32_16x16x32_bf16 v[38:41], a[208:211], a[28:31], v[38:41]
    buffer_load_dwordx4 a[60:63], v17, s[48:51], s3 offen offset:3072 sc1
    v_mfma_f32_16x16x32_bf16 v[42:45], a[212:215], a[24:27], v[42:45]
    ds_read_b64_tr_b16 a[236:237], v8 offset:55296
    v_mfma_f32_16x16x32_bf16 v[46:49], a[212:215], a[28:31], v[46:49]
    ds_read_b64_tr_b16 a[238:239], v8 offset:59392
    v_mfma_f32_16x16x32_bf16 v[68:71], a[216:219], a[24:27], v[68:71]
    ds_read_b64_tr_b16 a[240:241], v11 offset:61440
    v_mfma_f32_16x16x32_bf16 v[72:75], a[216:219], a[28:31], v[72:75]
    ds_read_b64_tr_b16 a[242:243], v11 offset:62464
    v_mfma_f32_16x16x32_bf16 v[76:79], a[220:223], a[24:27], v[76:79]
    s_add_u32 s3, s3, 4096
    ds_read_b64_tr_b16 a[244:245], v11 offset:63488
    ds_read_b64_tr_b16 a[246:247], v11 offset:64512
    v_mfma_f32_16x16x32_bf16 v[80:83], a[220:223], a[28:31], v[80:83]
    s_waitcnt lgkmcnt(4)
    buffer_load_dwordx4 a[64:67], v17, s[48:51], s3 offen offset:0 sc1
    s_waitcnt vmcnt(7)
    v_mfma_f32_16x16x32_bf16 v[34:37], a[224:227], a[32:35], v[34:37]
    ds_read_b64_tr_b16 a[248:249], v14 offset:61440
    ds_read_b64_tr_b16 a[250:251], v14 offset:62464
    v_mfma_f32_16x16x32_bf16 v[38:41], a[224:227], a[36:39], v[38:41]
    buffer_load_dwordx4 a[68:71], v17, s[48:51], s3 offen offset:1024 sc1
    v_mfma_f32_16x16x32_bf16 v[42:45], a[228:231], a[32:35], v[42:45]
    ds_read_b64_tr_b16 a[252:253], v14 offset:63488
    v_mfma_f32_16x16x32_bf16 v[46:49], a[228:231], a[36:39], v[46:49]
    ds_read_b64_tr_b16 a[254:255], v14 offset:64512
    v_mfma_f32_16x16x32_bf16 v[68:71], a[232:235], a[32:35], v[68:71]
    ds_read_b64_tr_b16 a[208:209], v7 offset:16384
    v_mfma_f32_16x16x32_bf16 v[72:75], a[232:235], a[36:39], v[72:75]
    ds_read_b64_tr_b16 a[210:211], v7 offset:20480
    v_mfma_f32_16x16x32_bf16 v[76:79], a[236:239], a[32:35], v[76:79]
    ds_read_b64_tr_b16 a[212:213], v7 offset:18432
    ds_read_b64_tr_b16 a[214:215], v7 offset:22528
    v_mfma_f32_16x16x32_bf16 v[80:83], a[236:239], a[36:39], v[80:83]
    s_waitcnt lgkmcnt(4)
    buffer_load_dwordx4 a[72:75], v17, s[48:51], s3 offen offset:2048 sc1
    s_waitcnt vmcnt(7)
    v_mfma_f32_16x16x32_bf16 v[34:37], a[240:243], a[40:43], v[34:37]
    ds_read_b64_tr_b16 a[216:217], v8 offset:16384
    ds_read_b64_tr_b16 a[218:219], v8 offset:20480
    v_mfma_f32_16x16x32_bf16 v[38:41], a[240:243], a[44:47], v[38:41]
    buffer_load_dwordx4 a[76:79], v17, s[48:51], s3 offen offset:3072 sc1
    v_mfma_f32_16x16x32_bf16 v[42:45], a[244:247], a[40:43], v[42:45]
    ds_read_b64_tr_b16 a[220:221], v8 offset:18432
    ds_read_b64_tr_b16 a[222:223], v8 offset:22528
    v_mfma_f32_16x16x32_bf16 v[46:49], a[244:247], a[44:47], v[46:49]
    v_add_u32 v172, 65536, v11
    v_mfma_f32_16x16x32_bf16 v[68:71], a[248:251], a[40:43], v[68:71]
    ds_read_b64_tr_b16 a[224:225], v172 offset:0
    v_mfma_f32_16x16x32_bf16 v[72:75], a[248:251], a[44:47], v[72:75]
    ds_read_b64_tr_b16 a[226:227], v172 offset:1024
    v_mfma_f32_16x16x32_bf16 v[76:79], a[252:255], a[40:43], v[76:79]
    s_add_u32 s3, s3, 4096
    ds_read_b64_tr_b16 a[228:229], v172 offset:2048
    ds_read_b64_tr_b16 a[230:231], v172 offset:3072
    v_mfma_f32_16x16x32_bf16 v[80:83], a[252:255], a[44:47], v[80:83]
    s_waitcnt lgkmcnt(4)
    buffer_load_dwordx4 a[80:83], v17, s[48:51], s3 offen offset:0 sc1
    v_add_u32 v173, 65536, v14
    s_waitcnt vmcnt(7)
    v_mfma_f32_16x16x32_bf16 v[34:37], a[208:211], a[48:51], v[34:37]
    ds_read_b64_tr_b16 a[232:233], v173 offset:0
    ds_read_b64_tr_b16 a[234:235], v173 offset:1024
    v_mfma_f32_16x16x32_bf16 v[38:41], a[208:211], a[52:55], v[38:41]
    buffer_load_dwordx4 a[84:87], v17, s[48:51], s3 offen offset:1024 sc1
    v_mfma_f32_16x16x32_bf16 v[42:45], a[212:215], a[48:51], v[42:45]
    ds_read_b64_tr_b16 a[236:237], v173 offset:2048
    v_mfma_f32_16x16x32_bf16 v[46:49], a[212:215], a[52:55], v[46:49]
    ds_read_b64_tr_b16 a[238:239], v173 offset:3072
    v_mfma_f32_16x16x32_bf16 v[68:71], a[216:219], a[48:51], v[68:71]
    ds_read_b64_tr_b16 a[240:241], v13 offset:4096
    v_mfma_f32_16x16x32_bf16 v[72:75], a[216:219], a[52:55], v[72:75]
    ds_read_b64_tr_b16 a[242:243], v13 offset:8192
    v_mfma_f32_16x16x32_bf16 v[76:79], a[220:223], a[48:51], v[76:79]
    ds_read_b64_tr_b16 a[244:245], v13 offset:6144
    ds_read_b64_tr_b16 a[246:247], v13 offset:10240
    v_mfma_f32_16x16x32_bf16 v[80:83], a[220:223], a[52:55], v[80:83]
    s_waitcnt lgkmcnt(4)
    buffer_load_dwordx4 a[88:91], v17, s[48:51], s3 offen offset:2048 sc1
    s_waitcnt vmcnt(7)
    v_mfma_f32_16x16x32_bf16 v[34:37], a[224:227], a[56:59], v[34:37]
    ds_read_b64_tr_b16 a[248:249], v23 offset:4096
    ds_read_b64_tr_b16 a[250:251], v23 offset:8192
    v_mfma_f32_16x16x32_bf16 v[38:41], a[224:227], a[60:63], v[38:41]
    buffer_load_dwordx4 a[92:95], v17, s[48:51], s3 offen offset:3072 sc1
    v_mfma_f32_16x16x32_bf16 v[42:45], a[228:231], a[56:59], v[42:45]
    ds_read_b64_tr_b16 a[252:253], v23 offset:6144
    v_mfma_f32_16x16x32_bf16 v[46:49], a[228:231], a[60:63], v[46:49]
    ds_read_b64_tr_b16 a[254:255], v23 offset:10240
    v_mfma_f32_16x16x32_bf16 v[68:71], a[232:235], a[56:59], v[68:71]
    ds_read_b64_tr_b16 a[208:209], v172 offset:12288
    v_mfma_f32_16x16x32_bf16 v[72:75], a[232:235], a[60:63], v[72:75]
    ds_read_b64_tr_b16 a[210:211], v172 offset:13312
    v_mfma_f32_16x16x32_bf16 v[76:79], a[236:239], a[56:59], v[76:79]
    s_addk_i32 s3, 4096
    ds_read_b64_tr_b16 a[212:213], v172 offset:14336
    ds_read_b64_tr_b16 a[214:215], v172 offset:15360
    v_mfma_f32_16x16x32_bf16 v[80:83], a[236:239], a[60:63], v[80:83]
    s_waitcnt lgkmcnt(4)
    buffer_load_dwordx4 a[96:99], v17, s[48:51], s3 offen offset:0 sc1
    s_waitcnt vmcnt(7)
    v_mfma_f32_16x16x32_bf16 v[34:37], a[240:243], a[64:67], v[34:37]
    ds_read_b64_tr_b16 a[216:217], v173 offset:12288
    ds_read_b64_tr_b16 a[218:219], v173 offset:13312
    v_mfma_f32_16x16x32_bf16 v[38:41], a[240:243], a[68:71], v[38:41]
    buffer_load_dwordx4 a[100:103], v17, s[48:51], s3 offen offset:1024 sc1
    v_mfma_f32_16x16x32_bf16 v[42:45], a[244:247], a[64:67], v[42:45]
    ds_read_b64_tr_b16 a[220:221], v173 offset:14336
    ds_read_b64_tr_b16 a[222:223], v173 offset:15360
    v_mfma_f32_16x16x32_bf16 v[46:49], a[244:247], a[68:71], v[46:49]
    s_barrier
    v_mfma_f32_16x16x32_bf16 v[68:71], a[248:251], a[64:67], v[68:71]
    ds_read_b64_tr_b16 a[224:225], v13 offset:16384
    ds_read_b64_tr_b16 a[226:227], v13 offset:20480
    v_mfma_f32_16x16x32_bf16 v[72:75], a[248:251], a[68:71], v[72:75]
    buffer_load_dwordx4 a[104:107], v17, s[48:51], s3 offen offset:2048 sc1
    v_mfma_f32_16x16x32_bf16 v[76:79], a[252:255], a[64:67], v[76:79]
    ds_read_b64_tr_b16 a[228:229], v13 offset:18432
    ds_read_b64_tr_b16 a[230:231], v13 offset:22528
    v_mfma_f32_16x16x32_bf16 v[80:83], a[252:255], a[68:71], v[80:83]
    s_waitcnt vmcnt(7) lgkmcnt(4)
    v_mfma_f32_16x16x32_bf16 v[34:37], a[208:211], a[72:75], v[34:37]
    ds_read_b64_tr_b16 a[232:233], v23 offset:16384
    ds_read_b64_tr_b16 a[234:235], v23 offset:20480
    v_mfma_f32_16x16x32_bf16 v[38:41], a[208:211], a[76:79], v[38:41]
    buffer_load_dwordx4 a[108:111], v17, s[48:51], s3 offen offset:3072 sc1
    v_mfma_f32_16x16x32_bf16 v[42:45], a[212:215], a[72:75], v[42:45]
    ds_read_b64_tr_b16 a[236:237], v23 offset:18432
    v_mfma_f32_16x16x32_bf16 v[46:49], a[212:215], a[76:79], v[46:49]
    ds_read_b64_tr_b16 a[238:239], v23 offset:22528
    v_mfma_f32_16x16x32_bf16 v[68:71], a[216:219], a[72:75], v[68:71]
    ds_read_b64_tr_b16 a[240:241], v11 offset:24576
    v_mfma_f32_16x16x32_bf16 v[72:75], a[216:219], a[76:79], v[72:75]
    ds_read_b64_tr_b16 a[242:243], v11 offset:25600
    v_mfma_f32_16x16x32_bf16 v[76:79], a[220:223], a[72:75], v[76:79]
    s_addk_i32 s3, 4096
    ds_read_b64_tr_b16 a[244:245], v11 offset:26624
    ds_read_b64_tr_b16 a[246:247], v11 offset:27648
    v_mfma_f32_16x16x32_bf16 v[80:83], a[220:223], a[76:79], v[80:83]
    s_waitcnt lgkmcnt(4)
    buffer_load_dwordx4 a[112:115], v17, s[48:51], s3 offen offset:0 sc1
    s_waitcnt vmcnt(7)
    v_mfma_f32_16x16x32_bf16 v[34:37], a[224:227], a[80:83], v[34:37]
    ds_read_b64_tr_b16 a[248:249], v14 offset:24576
    ds_read_b64_tr_b16 a[250:251], v14 offset:25600
    v_mfma_f32_16x16x32_bf16 v[38:41], a[224:227], a[84:87], v[38:41]
    buffer_load_dwordx4 a[116:119], v17, s[48:51], s3 offen offset:1024 sc1
    v_mfma_f32_16x16x32_bf16 v[42:45], a[228:231], a[80:83], v[42:45]
    ds_read_b64_tr_b16 a[252:253], v14 offset:26624
    v_mfma_f32_16x16x32_bf16 v[46:49], a[228:231], a[84:87], v[46:49]
    ds_read_b64_tr_b16 a[254:255], v14 offset:27648
    v_mfma_f32_16x16x32_bf16 v[68:71], a[232:235], a[80:83], v[68:71]
    ds_read_b64_tr_b16 a[208:209], v7 offset:28672
    v_mfma_f32_16x16x32_bf16 v[72:75], a[232:235], a[84:87], v[72:75]
    ds_read_b64_tr_b16 a[210:211], v7 offset:0
    v_mfma_f32_16x16x32_bf16 v[76:79], a[236:239], a[80:83], v[76:79]
    ds_read_b64_tr_b16 a[212:213], v7 offset:30720
    ds_read_b64_tr_b16 a[214:215], v7 offset:2048
    v_mfma_f32_16x16x32_bf16 v[80:83], a[236:239], a[84:87], v[80:83]
    s_waitcnt lgkmcnt(4)
    buffer_load_dwordx4 a[120:123], v17, s[48:51], s3 offen offset:2048 sc1
    s_waitcnt vmcnt(7)
    v_mfma_f32_16x16x32_bf16 v[34:37], a[240:243], a[88:91], v[34:37]
    ds_read_b64_tr_b16 a[216:217], v8 offset:28672
    ds_read_b64_tr_b16 a[218:219], v8 offset:0
    v_mfma_f32_16x16x32_bf16 v[38:41], a[240:243], a[92:95], v[38:41]
    buffer_load_dwordx4 a[124:127], v17, s[48:51], s3 offen offset:3072 sc1
    v_mfma_f32_16x16x32_bf16 v[42:45], a[244:247], a[88:91], v[42:45]
    ds_read_b64_tr_b16 a[220:221], v8 offset:30720
    v_mfma_f32_16x16x32_bf16 v[46:49], a[244:247], a[92:95], v[46:49]
    ds_read_b64_tr_b16 a[222:223], v8 offset:2048
    v_mfma_f32_16x16x32_bf16 v[68:71], a[248:251], a[88:91], v[68:71]
    ds_read_b64_tr_b16 a[224:225], v11 offset:4096
    v_mfma_f32_16x16x32_bf16 v[72:75], a[248:251], a[92:95], v[72:75]
    ds_read_b64_tr_b16 a[226:227], v11 offset:5120
    v_mfma_f32_16x16x32_bf16 v[76:79], a[252:255], a[88:91], v[76:79]
    ds_read_b64_tr_b16 a[228:229], v11 offset:6144
    ds_read_b64_tr_b16 a[230:231], v11 offset:7168
    v_mfma_f32_16x16x32_bf16 v[80:83], a[252:255], a[92:95], v[80:83]
    s_waitcnt lgkmcnt(4)
    buffer_load_dwordx4 v[26:29], v17, s[48:51], s10 offen sc1
    s_waitcnt vmcnt(7)
    v_mfma_f32_16x16x32_bf16 v[34:37], a[208:211], a[96:99], v[34:37]
    s_add_u32 m0, s66, 118784
    ds_read_b64_tr_b16 a[232:233], v14 offset:4096
    ds_read_b64_tr_b16 a[234:235], v14 offset:5120
    v_mfma_f32_16x16x32_bf16 v[38:41], a[208:211], a[100:103], v[38:41]
    buffer_load_dwordx4 v61, s[36:39], s18 offen lds
    v_mfma_f32_16x16x32_bf16 v[42:45], a[212:215], a[96:99], v[42:45]
    ds_read_b64_tr_b16 a[236:237], v14 offset:6144
    v_mfma_f32_16x16x32_bf16 v[46:49], a[212:215], a[100:103], v[46:49]
    ds_read_b64_tr_b16 a[238:239], v14 offset:7168
    v_mfma_f32_16x16x32_bf16 v[68:71], a[216:219], a[96:99], v[68:71]
    ds_read_b64_tr_b16 a[240:241], v7 offset:8192
    v_mfma_f32_16x16x32_bf16 v[72:75], a[216:219], a[100:103], v[72:75]
    ds_read_b64_tr_b16 a[242:243], v7 offset:12288
    v_mfma_f32_16x16x32_bf16 v[76:79], a[220:223], a[96:99], v[76:79]
    s_add_u32 m0, s66, 122880
    ds_read_b64_tr_b16 a[244:245], v7 offset:10240
    ds_read_b64_tr_b16 a[246:247], v7 offset:14336
    v_mfma_f32_16x16x32_bf16 v[80:83], a[220:223], a[100:103], v[80:83]
    s_waitcnt lgkmcnt(4)
    buffer_load_dwordx4 v60, s[36:39], s19 offen lds
    s_waitcnt vmcnt(7)
    v_mfma_f32_16x16x32_bf16 v[34:37], a[224:227], a[104:107], v[34:37]
    s_add_u32 m0, s66, 126976
    ds_read_b64_tr_b16 a[248:249], v8 offset:8192
    ds_read_b64_tr_b16 a[250:251], v8 offset:12288
    v_mfma_f32_16x16x32_bf16 v[38:41], a[224:227], a[108:111], v[38:41]
    buffer_load_dwordx4 v61, s[36:39], s19 offen lds
    v_mfma_f32_16x16x32_bf16 v[42:45], a[228:231], a[104:107], v[42:45]
    ds_read_b64_tr_b16 a[252:253], v8 offset:10240
    v_mfma_f32_16x16x32_bf16 v[46:49], a[228:231], a[108:111], v[46:49]
    ds_read_b64_tr_b16 a[254:255], v8 offset:14336
    v_mfma_f32_16x16x32_bf16 v[68:71], a[232:235], a[104:107], v[68:71]
    ds_read_b64_tr_b16 a[208:209], v172 offset:28672
    v_mfma_f32_16x16x32_bf16 v[72:75], a[232:235], a[108:111], v[72:75]
    ds_read_b64_tr_b16 a[210:211], v172 offset:29696
    v_mfma_f32_16x16x32_bf16 v[76:79], a[236:239], a[104:107], v[76:79]
    s_add_u32 m0, s66, 131072
    ds_read_b64_tr_b16 a[212:213], v172 offset:30720
    ds_read_b64_tr_b16 a[214:215], v172 offset:31744
    v_mfma_f32_16x16x32_bf16 v[80:83], a[236:239], a[108:111], v[80:83]
    s_waitcnt lgkmcnt(4)
    buffer_load_dwordx4 v60, s[36:39], s22 offen lds
    s_waitcnt vmcnt(7)
    v_mfma_f32_16x16x32_bf16 v[34:37], a[240:243], a[112:115], v[34:37]
    s_add_u32 m0, s66, 135168
    ds_read_b64_tr_b16 a[216:217], v173 offset:28672
    ds_read_b64_tr_b16 a[218:219], v173 offset:29696
    v_mfma_f32_16x16x32_bf16 v[38:41], a[240:243], a[116:119], v[38:41]
    buffer_load_dwordx4 v61, s[36:39], s22 offen lds
    v_mfma_f32_16x16x32_bf16 v[42:45], a[244:247], a[112:115], v[42:45]
    ds_read_b64_tr_b16 a[220:221], v173 offset:30720
    ds_read_b64_tr_b16 a[222:223], v173 offset:31744
    v_mfma_f32_16x16x32_bf16 v[46:49], a[244:247], a[116:119], v[46:49]
    v_add_u32 v174, 65536, v9
    v_mfma_f32_16x16x32_bf16 v[68:71], a[248:251], a[112:115], v[68:71]
    ds_read_b64_tr_b16 a[224:225], v174 offset:24576
    v_mfma_f32_16x16x32_bf16 v[72:75], a[248:251], a[116:119], v[72:75]
    ds_read_b64_tr_b16 a[226:227], v9 offset:32768
    v_mfma_f32_16x16x32_bf16 v[76:79], a[252:255], a[112:115], v[76:79]
    s_addk_i32 m0, 4096
    ds_read_b64_tr_b16 a[228:229], v174 offset:26624
    ds_read_b64_tr_b16 a[230:231], v9 offset:34816
    v_mfma_f32_16x16x32_bf16 v[80:83], a[252:255], a[116:119], v[80:83]
    s_waitcnt lgkmcnt(4)
    buffer_load_dwordx4 v60, s[36:39], s23 offen lds
    v_add_u32 v175, 65536, v10
    s_waitcnt vmcnt(7)
    v_mfma_f32_16x16x32_bf16 v[34:37], a[208:211], a[120:123], v[34:37]
    s_addk_i32 m0, 4096
    ds_read_b64_tr_b16 a[232:233], v175 offset:24576
    ds_read_b64_tr_b16 a[234:235], v10 offset:32768
    v_mfma_f32_16x16x32_bf16 v[38:41], a[208:211], a[124:127], v[38:41]
    buffer_load_dwordx4 v61, s[36:39], s23 offen lds
    v_mfma_f32_16x16x32_bf16 v[42:45], a[212:215], a[120:123], v[42:45]
    ds_read_b64_tr_b16 a[236:237], v175 offset:26624
    v_mfma_f32_16x16x32_bf16 v[46:49], a[212:215], a[124:127], v[46:49]
    ds_read_b64_tr_b16 a[238:239], v10 offset:34816
    v_mfma_f32_16x16x32_bf16 v[68:71], a[216:219], a[120:123], v[68:71]
    ds_read_b64_tr_b16 a[240:241], v9 offset:40960
    ds_read_b64_tr_b16 a[242:243], v9 offset:45056
    v_mfma_f32_16x16x32_bf16 v[72:75], a[216:219], a[124:127], v[72:75]
    s_waitcnt vmcnt(7)
    v_add_f32 v26, v26, v27
    v_add_f32 v28, v28, v29
    v_mfma_f32_16x16x32_bf16 v[76:79], a[220:223], a[120:123], v[76:79]
    s_addk_i32 m0, 4096
    ds_read_b64_tr_b16 a[244:245], v9 offset:43008
    ds_read_b64_tr_b16 a[246:247], v9 offset:47104
    v_mfma_f32_16x16x32_bf16 v[80:83], a[220:223], a[124:127], v[80:83]
    s_waitcnt lgkmcnt(4)
    buffer_load_dwordx4 v60, s[36:39], s59 offen lds
    v_permlane32_swap_b32 v26, v28
    v_mfma_f32_16x16x32_bf16 v[84:87], a[224:227], a[0:3], 0
    ds_read_b64_tr_b16 a[248:249], v10 offset:40960
    ds_read_b64_tr_b16 a[250:251], v10 offset:45056
    v_mfma_f32_16x16x32_bf16 v[88:91], a[224:227], a[4:7], 0
    v_add_f32 v27, v26, v28
    v_add_f32_e64 v26, v26, v28
    v_mfma_f32_16x16x32_bf16 v[92:95], a[228:231], a[0:3], 0
    s_add_u32 m0, s66, 151552
    ds_read_b64_tr_b16 a[252:253], v10 offset:43008
    ds_read_b64_tr_b16 a[254:255], v10 offset:47104
    v_mfma_f32_16x16x32_bf16 v[96:99], a[228:231], a[4:7], 0
    buffer_load_dwordx4 v61, s[36:39], s59 offen lds
    v_permlane16_swap_b32 v26, v27
    v_mfma_f32_16x16x32_bf16 v[100:103], a[232:235], a[0:3], 0
    ds_read_b64_tr_b16 a[208:209], v9 offset:53248
    ds_read_b64_tr_b16 a[210:211], v9 offset:57344
    v_mfma_f32_16x16x32_bf16 v[104:107], a[232:235], a[4:7], 0
    v_add_f32_e64 v26, v26, v27
    v_fma_f32 v54, v26, s1, v30
    v_fma_f32 v55, v26, s1, v30
    v_mfma_f32_16x16x32_bf16 v[108:111], a[236:239], a[0:3], 0
    s_add_u32 m0, s66, 155648
    ds_read_b64_tr_b16 a[212:213], v9 offset:55296
    ds_read_b64_tr_b16 a[214:215], v9 offset:59392
    v_mfma_f32_16x16x32_bf16 v[112:115], a[236:239], a[4:7], 0
    s_waitcnt lgkmcnt(4)
    buffer_load_dwordx4 v60, s[36:39], s74 offen lds
    v_permlane32_swap_b32 v54, v55
    v_mfma_f32_16x16x32_bf16 v[84:87], a[240:243], a[16:19], v[84:87]
    ds_read_b64_tr_b16 a[216:217], v10 offset:53248
    ds_read_b64_tr_b16 a[218:219], v10 offset:57344
    v_mfma_f32_16x16x32_bf16 v[88:91], a[240:243], a[20:23], v[88:91]
    v_rsq_f32_e64 v26, v54
    v_mfma_f32_16x16x32_bf16 v[92:95], a[244:247], a[16:19], v[92:95]
    ds_read_b64_tr_b16 a[220:221], v10 offset:55296
    ds_read_b64_tr_b16 a[222:223], v10 offset:59392
    v_mfma_f32_16x16x32_bf16 v[96:99], a[244:247], a[20:23], v[96:99]
    v_rsq_f32_e64 v27, v55
    v_mul_f32 v50, 0xc0135761, v26
    v_mfma_f32_16x16x32_bf16 v[100:103], a[248:251], a[16:19], v[100:103]
    s_add_u32 m0, s66, 36864
    ds_read_b64_tr_b16 a[224:225], v9 offset:16384
    ds_read_b64_tr_b16 a[226:227], v9 offset:20480
    v_mfma_f32_16x16x32_bf16 v[104:107], a[248:251], a[20:23], v[104:107]
    buffer_load_dwordx4 v61, s[36:39], s74 offen lds
    v_mul_f32_e64 v26, v26, v26
    v_mul_f32 v51, 0x3d372713, v50
    v_mfma_f32_16x16x32_bf16 v[108:111], a[252:255], a[16:19], v[108:111]
    ds_read_b64_tr_b16 a[228:229], v9 offset:18432
    ds_read_b64_tr_b16 a[230:231], v9 offset:22528
    v_mfma_f32_16x16x32_bf16 v[112:115], a[252:255], a[20:23], v[112:115]
    s_waitcnt lgkmcnt(4)
    v_mul_f32 v51, v51, v26
    v_mul_f32 v52, 0xc0135761, v27
    v_mul_f32_e64 v27, v27, v27
    v_mfma_f32_16x16x32_bf16 v[84:87], a[208:211], a[32:35], v[84:87]
    s_addk_i32 m0, 12288
    s_lshl1_add_u32 s52, s56, 0xffffdfc0
    v_add_u32 v62, s52, v62
    ds_read_b64_tr_b16 a[232:233], v10 offset:16384
    ds_read_b64_tr_b16 a[234:235], v10 offset:20480
    v_mfma_f32_16x16x32_bf16 v[88:91], a[208:211], a[36:39], v[88:91]
    buffer_load_dwordx4 v62, s[36:39], 0 offen lds
    v_mul_f32 v53, 0x3d372713, v52
    v_mul_f32_e64 v53, v53, v27
    v_mfma_f32_16x16x32_bf16 v[92:95], a[212:215], a[32:35], v[92:95]
    ds_read_b64_tr_b16 a[236:237], v10 offset:18432
    ds_read_b64_tr_b16 a[238:239], v10 offset:22528
    v_mfma_f32_16x16x32_bf16 v[96:99], a[212:215], a[36:39], v[96:99]
    v_pk_mul_f32 v[132:133], v[34:35], v[34:35]
    v_pk_mul_f32 v[134:135], v[36:37], v[36:37]
    v_pk_mul_f32 v[136:137], v[38:39], v[38:39]
    v_pk_mul_f32 v[138:139], v[40:41], v[40:41]
    v_pk_fma_f32 v[132:133], v[132:133], v[50:51], v[50:51] op_sel:[0,1,0] op_sel_hi:[1,1,0]
    v_pk_fma_f32 v[134:135], v[134:135], v[50:51], v[50:51] op_sel:[0,1,0] op_sel_hi:[1,1,0]
    v_pk_fma_f32 v[136:137], v[136:137], v[52:53], v[52:53] op_sel:[0,1,0] op_sel_hi:[1,1,0]
    v_pk_fma_f32 v[138:139], v[138:139], v[52:53], v[52:53] op_sel:[0,1,0] op_sel_hi:[1,1,0]
    v_pk_mul_f32 v[132:133], v[132:133], v[34:35]
    v_pk_mul_f32 v[134:135], v[134:135], v[36:37]
    v_pk_mul_f32 v[136:137], v[136:137], v[38:39]
    v_pk_mul_f32 v[138:139], v[138:139], v[40:41]
    v_mfma_f32_16x16x32_bf16 v[100:103], a[216:219], a[32:35], v[100:103]
    ds_read_b64_tr_b16 a[240:241], v174 offset:4096
    ds_read_b64_tr_b16 a[242:243], v174 offset:8192
    v_mfma_f32_16x16x32_bf16 v[104:107], a[216:219], a[36:39], v[104:107]
    v_exp_f32 v132, v132
    v_mfma_f32_16x16x32_bf16 v[108:111], a[220:223], a[32:35], v[108:111]
    s_addk_i32 m0, 12288
    ds_read_b64_tr_b16 a[244:245], v174 offset:6144
    ds_read_b64_tr_b16 a[246:247], v174 offset:10240
    v_mfma_f32_16x16x32_bf16 v[112:115], a[220:223], a[36:39], v[112:115]
    s_waitcnt lgkmcnt(4)
    buffer_load_dwordx4 v62, s[36:39], s17 offen lds
    v_exp_f32 v133, v133
    s_waitcnt vmcnt(12)
    s_barrier
    v_mfma_f32_16x16x32_bf16 v[84:87], a[224:227], a[48:51], v[84:87]
    ds_read_b64_tr_b16 a[248:249], v175 offset:4096
    ds_read_b64_tr_b16 a[250:251], v175 offset:8192
    v_mfma_f32_16x16x32_bf16 v[88:91], a[224:227], a[52:55], v[88:91]
    v_exp_f32_e64 v134, v134
    v_mfma_f32_16x16x32_bf16 v[92:95], a[228:231], a[48:51], v[92:95]
    ds_read_b64_tr_b16 a[252:253], v175 offset:6144
    ds_read_b64_tr_b16 a[254:255], v175 offset:10240
    v_mfma_f32_16x16x32_bf16 v[96:99], a[228:231], a[52:55], v[96:99]
    v_exp_f32_e64 v135, v135
    v_mfma_f32_16x16x32_bf16 v[100:103], a[232:235], a[48:51], v[100:103]
    ds_read_b64_tr_b16 a[208:209], v174 offset:16384
    ds_read_b64_tr_b16 a[210:211], v174 offset:20480
    v_mfma_f32_16x16x32_bf16 v[104:107], a[232:235], a[52:55], v[104:107]
    v_exp_f32_e64 v136, v136
    v_mfma_f32_16x16x32_bf16 v[108:111], a[236:239], a[48:51], v[108:111]
    s_add_u32 m0, s66, 65536
    ds_read_b64_tr_b16 a[212:213], v174 offset:18432
    ds_read_b64_tr_b16 a[214:215], v174 offset:22528
    v_mfma_f32_16x16x32_bf16 v[112:115], a[236:239], a[52:55], v[112:115]
    s_waitcnt lgkmcnt(4)
    buffer_load_dwordx4 v62, s[36:39], s18 offen lds
    v_exp_f32 v137, v137
    v_mfma_f32_16x16x32_bf16 v[84:87], a[240:243], a[64:67], v[84:87]
    ds_read_b64_tr_b16 a[216:217], v175 offset:16384
    ds_read_b64_tr_b16 a[218:219], v175 offset:20480
    v_mfma_f32_16x16x32_bf16 v[88:91], a[240:243], a[68:71], v[88:91]
    v_exp_f32 v138, v138
    v_exp_f32 v139, v139
    v_pk_mul_f32 v[42:43], v[34:35], v[42:43]
    v_pk_mul_f32 v[44:45], v[36:37], v[44:45]
    v_pk_mul_f32 v[46:47], v[38:39], v[46:47]
    v_pk_mul_f32 v[48:49], v[40:41], v[48:49]
    v_pk_fma_f32 v[132:133], v[132:133], v[54:55], v[54:55] op_sel:[0,0,0] op_sel_hi:[1,0,0]
    v_pk_fma_f32 v[134:135], v[134:135], v[54:55], v[54:55] op_sel:[0,0,0] op_sel_hi:[1,0,0]
    v_pk_fma_f32 v[136:137], v[136:137], v[54:55], v[54:55] op_sel:[0,1,1] op_sel_hi:[1,1,1]
    v_pk_fma_f32 v[138:139], v[138:139], v[54:55], v[54:55] op_sel:[0,1,1] op_sel_hi:[1,1,1]
    v_mfma_f32_16x16x32_bf16 v[92:95], a[244:247], a[64:67], v[92:95]
    ds_read_b64_tr_b16 a[220:221], v175 offset:18432
    ds_read_b64_tr_b16 a[222:223], v175 offset:22528
    v_mfma_f32_16x16x32_bf16 v[96:99], a[244:247], a[68:71], v[96:99]
    v_rcp_f32_e64 v132, v132
    v_mfma_f32_16x16x32_bf16 v[100:103], a[248:251], a[64:67], v[100:103]
    ds_read_b64_tr_b16 a[224:225], v9 offset:28672
    ds_read_b64_tr_b16 a[226:227], v9 offset:0
    v_mfma_f32_16x16x32_bf16 v[104:107], a[248:251], a[68:71], v[104:107]
    v_rcp_f32 v133, v133
    v_mfma_f32_16x16x32_bf16 v[108:111], a[252:255], a[64:67], v[108:111]
    s_addk_i32 m0, 24576
    ds_read_b64_tr_b16 a[228:229], v9 offset:30720
    ds_read_b64_tr_b16 a[230:231], v9 offset:2048
    v_mfma_f32_16x16x32_bf16 v[112:115], a[252:255], a[68:71], v[112:115]
    s_waitcnt lgkmcnt(4)
    buffer_load_dwordx4 v62, s[36:39], s19 offen lds
    v_rcp_f32 v134, v134
    v_mfma_f32_16x16x32_bf16 v[84:87], a[208:211], a[80:83], v[84:87]
    ds_read_b64_tr_b16 a[232:233], v10 offset:28672
    ds_read_b64_tr_b16 a[234:235], v10 offset:0
    v_mfma_f32_16x16x32_bf16 v[88:91], a[208:211], a[84:87], v[88:91]
    v_rcp_f32_e64 v135, v135
    v_mfma_f32_16x16x32_bf16 v[92:95], a[212:215], a[80:83], v[92:95]
    ds_read_b64_tr_b16 a[236:237], v10 offset:30720
    ds_read_b64_tr_b16 a[238:239], v10 offset:2048
    v_mfma_f32_16x16x32_bf16 v[96:99], a[212:215], a[84:87], v[96:99]
    v_rcp_f32_e64 v136, v136
    v_mfma_f32_16x16x32_bf16 v[100:103], a[216:219], a[80:83], v[100:103]
    ds_read_b64_tr_b16 a[240:241], v9 offset:8192
    ds_read_b64_tr_b16 a[242:243], v9 offset:12288
    v_mfma_f32_16x16x32_bf16 v[104:107], a[216:219], a[84:87], v[104:107]
    v_rcp_f32_e64 v137, v137
    v_mfma_f32_16x16x32_bf16 v[108:111], a[220:223], a[80:83], v[108:111]
    ds_read_b64_tr_b16 a[244:245], v9 offset:10240
    ds_read_b64_tr_b16 a[246:247], v9 offset:14336
    v_mfma_f32_16x16x32_bf16 v[112:115], a[220:223], a[84:87], v[112:115]
    s_waitcnt lgkmcnt(4)
    v_rcp_f32 v138, v138
    v_rcp_f32_e64 v139, v139
    v_pk_mul_f32 v[42:43], v[42:43], v[132:133]
    v_pk_mul_f32 v[44:45], v[44:45], v[134:135]
    v_pk_mul_f32 v[46:47], v[46:47], v[136:137]
    v_pk_mul_f32 v[48:49], v[48:49], v[138:139]
    v_mfma_f32_16x16x32_bf16 v[84:87], a[224:227], a[96:99], v[84:87]
    s_add_u32 m0, s66, 32768
    ds_read_b64_tr_b16 a[248:249], v10 offset:8192
    ds_read_b64_tr_b16 a[250:251], v10 offset:12288
    v_mfma_f32_16x16x32_bf16 v[88:91], a[224:227], a[100:103], v[88:91]
    buffer_load_dwordx4 v62, s[36:39], s22 offen lds
    v_cvt_pk_bf16_f32 v56, v42, v43
    v_cvt_pk_bf16_f32 v57, v44, v45
    v_mfma_f32_16x16x32_bf16 v[92:95], a[228:231], a[96:99], v[92:95]
    ds_read_b64_tr_b16 a[252:253], v10 offset:10240
    ds_read_b64_tr_b16 a[254:255], v10 offset:14336
    v_mfma_f32_16x16x32_bf16 v[96:99], a[228:231], a[100:103], v[96:99]
    v_cvt_pk_bf16_f32 v140, v46, v47
    v_cvt_pk_bf16_f32 v141, v48, v49
    v_mfma_f32_16x16x32_bf16 v[100:103], a[232:235], a[96:99], v[100:103]
    ds_read_b64_tr_b16 a[208:209], v13 offset:32768
    ds_read_b64_tr_b16 a[210:211], v13 offset:36864
    v_mfma_f32_16x16x32_bf16 v[104:107], a[232:235], a[100:103], v[104:107]
    v_pk_mul_f32 v[132:133], v[68:69], v[68:69]
    v_pk_mul_f32 v[134:135], v[70:71], v[70:71]
    v_pk_mul_f32 v[136:137], v[72:73], v[72:73]
    v_pk_mul_f32 v[138:139], v[74:75], v[74:75]
    v_pk_fma_f32 v[132:133], v[132:133], v[50:51], v[50:51] op_sel:[0,1,0] op_sel_hi:[1,1,0]
    v_pk_fma_f32 v[134:135], v[134:135], v[50:51], v[50:51] op_sel:[0,1,0] op_sel_hi:[1,1,0]
    v_pk_fma_f32 v[136:137], v[136:137], v[52:53], v[52:53] op_sel:[0,1,0] op_sel_hi:[1,1,0]
    v_pk_fma_f32 v[138:139], v[138:139], v[52:53], v[52:53] op_sel:[0,1,0] op_sel_hi:[1,1,0]
    v_pk_mul_f32 v[132:133], v[132:133], v[68:69]
    v_pk_mul_f32 v[134:135], v[134:135], v[70:71]
    v_pk_mul_f32 v[136:137], v[136:137], v[72:73]
    v_pk_mul_f32 v[138:139], v[138:139], v[74:75]
    v_mfma_f32_16x16x32_bf16 v[108:111], a[236:239], a[96:99], v[108:111]
    s_add_u32 m0, s66, 40960
    ds_read_b64_tr_b16 a[212:213], v13 offset:34816
    ds_read_b64_tr_b16 a[214:215], v13 offset:38912
    v_mfma_f32_16x16x32_bf16 v[112:115], a[236:239], a[100:103], v[112:115]
    s_waitcnt lgkmcnt(4)
    buffer_load_dwordx4 v62, s[36:39], s23 offen lds
    v_exp_f32 v132, v132
    v_mfma_f32_16x16x32_bf16 v[84:87], a[240:243], a[112:115], v[84:87]
    ds_read_b64_tr_b16 a[216:217], v13 offset:40960
L_vis_v1_0:
    s_cbranch_execz L_ret_v1
    ds_read_b64_tr_b16 a[218:219], v13 offset:45056
    v_mfma_f32_16x16x32_bf16 v[88:91], a[240:243], a[116:119], v[88:91]
    v_exp_f32 v133, v133
    v_mfma_f32_16x16x32_bf16 v[92:95], a[244:247], a[112:115], v[92:95]
    ds_read_b64_tr_b16 a[220:221], v13 offset:43008
    ds_read_b64_tr_b16 a[222:223], v13 offset:47104
    v_mfma_f32_16x16x32_bf16 v[96:99], a[244:247], a[116:119], v[96:99]
    v_exp_f32_e64 v134, v134
    v_mfma_f32_16x16x32_bf16 v[100:103], a[248:251], a[112:115], v[100:103]
    ds_read_b64_tr_b16 a[224:225], v13 offset:49152
    ds_read_b64_tr_b16 a[226:227], v13 offset:53248
    v_mfma_f32_16x16x32_bf16 v[104:107], a[248:251], a[116:119], v[104:107]
    v_exp_f32 v135, v135
    v_mfma_f32_16x16x32_bf16 v[108:111], a[252:255], a[112:115], v[108:111]
    s_addk_i32 m0, 4096
    ds_read_b64_tr_b16 a[228:229], v13 offset:51200
    ds_read_b64_tr_b16 a[230:231], v13 offset:55296
    v_mfma_f32_16x16x32_bf16 v[112:115], a[252:255], a[116:119], v[112:115]
    s_waitcnt lgkmcnt(4)
    buffer_load_dwordx4 v62, s[36:39], s59 offen lds
    v_exp_f32 v136, v136
    s_waitcnt vmcnt(7)
    s_barrier
    v_mfma_f32_16x16x32_bf16 v[84:87], a[208:211], a[8:11], v[84:87]
    ds_read_b64_tr_b16 a[232:233], v13 offset:57344
    ds_read_b64_tr_b16 a[234:235], v13 offset:61440
    v_mfma_f32_16x16x32_bf16 v[88:91], a[208:211], a[12:15], v[88:91]
    v_exp_f32_e64 v137, v137
    v_mfma_f32_16x16x32_bf16 v[92:95], a[212:215], a[8:11], v[92:95]
    ds_read_b64_tr_b16 a[236:237], v13 offset:59392
    ds_read_b64_tr_b16 a[238:239], v13 offset:63488
    v_mfma_f32_16x16x32_bf16 v[96:99], a[212:215], a[12:15], v[96:99]
    v_add_u32 v176, 131072, v7
    v_exp_f32 v138, v138
    v_exp_f32 v139, v139
    v_pk_mul_f32 v[76:77], v[68:69], v[76:77]
    v_pk_mul_f32 v[78:79], v[70:71], v[78:79]
    v_pk_mul_f32 v[80:81], v[72:73], v[80:81]
    v_pk_mul_f32 v[82:83], v[74:75], v[82:83]
    v_pk_fma_f32 v[132:133], v[132:133], v[54:55], v[54:55] op_sel:[0,0,0] op_sel_hi:[1,0,0]
    v_pk_fma_f32 v[134:135], v[134:135], v[54:55], v[54:55] op_sel:[0,0,0] op_sel_hi:[1,0,0]
    v_pk_fma_f32 v[136:137], v[136:137], v[54:55], v[54:55] op_sel:[0,1,1] op_sel_hi:[1,1,1]
    v_pk_fma_f32 v[138:139], v[138:139], v[54:55], v[54:55] op_sel:[0,1,1] op_sel_hi:[1,1,1]
    v_mfma_f32_16x16x32_bf16 v[84:87], a[216:219], a[24:27], v[84:87]
    s_add_u32 m0, s66, 53248
    ds_read_b64_tr_b16 a[240:241], v176 offset:0
    ds_read_b64_tr_b16 a[242:243], v176 offset:4096
    v_mfma_f32_16x16x32_bf16 v[88:91], a[216:219], a[28:31], v[88:91]
    buffer_load_dwordx4 v62, s[36:39], s74 offen lds
    v_rcp_f32_e64 v132, v132
    v_mfma_f32_16x16x32_bf16 v[92:95], a[220:223], a[24:27], v[92:95]
    ds_read_b64_tr_b16 a[244:245], v176 offset:2048
    ds_read_b64_tr_b16 a[246:247], v176 offset:6144
    v_mfma_f32_16x16x32_bf16 v[96:99], a[220:223], a[28:31], v[96:99]
    s_waitcnt lgkmcnt(4)
    v_rcp_f32 v133, v133
    v_mfma_f32_16x16x32_bf16 v[84:87], a[224:227], a[40:43], v[84:87]
    ds_read_b64_tr_b16 a[248:249], v176 offset:8192
    ds_read_b64_tr_b16 a[250:251], v176 offset:12288
    v_mfma_f32_16x16x32_bf16 v[88:91], a[224:227], a[44:47], v[88:91]
    v_rcp_f32_e64 v134, v134
    v_mfma_f32_16x16x32_bf16 v[92:95], a[228:231], a[40:43], v[92:95]
    ds_read_b64_tr_b16 a[252:253], v176 offset:10240
    ds_read_b64_tr_b16 a[254:255], v176 offset:14336
    v_mfma_f32_16x16x32_bf16 v[96:99], a[228:231], a[44:47], v[96:99]
    v_rcp_f32_e64 v135, v135
    v_mfma_f32_16x16x32_bf16 v[84:87], a[232:235], a[56:59], v[84:87]
    ds_read_b64_tr_b16 a[208:209], v176 offset:16384
    ds_read_b64_tr_b16 a[210:211], v176 offset:20480
    v_mfma_f32_16x16x32_bf16 v[88:91], a[232:235], a[60:63], v[88:91]
    v_rcp_f32 v136, v136
    v_mfma_f32_16x16x32_bf16 v[92:95], a[236:239], a[56:59], v[92:95]
    s_add_u32 m0, s66, 57344
    s_add_u32 s52, s53, 0
    v_add_u32 v65, 16384, v64
    v_add_u32 v66, 196608, v64
    v_add_u32 v67, 212992, v64
    ds_read_b64_tr_b16 a[212:213], v176 offset:18432
    ds_read_b64_tr_b16 a[214:215], v176 offset:22528
    v_mfma_f32_16x16x32_bf16 v[96:99], a[236:239], a[60:63], v[96:99]
    s_waitcnt lgkmcnt(4)
    buffer_load_dwordx4 v64, s[40:43], s52 offen lds
    v_rcp_f32 v137, v137
    v_mfma_f32_16x16x32_bf16 v[84:87], a[240:243], a[72:75], v[84:87]
    ds_read_b64_tr_b16 a[216:217], v176 offset:24576
    ds_read_b64_tr_b16 a[218:219], v7 offset:36864
    v_mfma_f32_16x16x32_bf16 v[88:91], a[240:243], a[76:79], v[88:91]
    v_rcp_f32 v138, v138
    v_rcp_f32 v139, v139
    v_pk_mul_f32 v[76:77], v[76:77], v[132:133]
    v_pk_mul_f32 v[78:79], v[78:79], v[134:135]
    v_pk_mul_f32 v[80:81], v[80:81], v[136:137]
    v_pk_mul_f32 v[82:83], v[82:83], v[138:139]
    v_mfma_f32_16x16x32_bf16 v[92:95], a[244:247], a[72:75], v[92:95]
    s_add_u32 m0, s66, 77824
    ds_read_b64_tr_b16 a[220:221], v176 offset:26624
    ds_read_b64_tr_b16 a[222:223], v7 offset:38912
    v_mfma_f32_16x16x32_bf16 v[96:99], a[244:247], a[76:79], v[96:99]
    buffer_load_dwordx4 v65, s[40:43], s52 offen lds
    v_cvt_pk_bf16_f32 v58, v76, v77
    v_cvt_pk_bf16_f32 v59, v78, v79
    v_mfma_f32_16x16x32_bf16 v[84:87], a[248:251], a[88:91], v[84:87]
    s_add_u32 m0, s66, 24576
    ds_read_b64_tr_b16 a[224:225], v23 offset:32768
    ds_read_b64_tr_b16 a[226:227], v23 offset:36864
    v_mfma_f32_16x16x32_bf16 v[88:91], a[248:251], a[92:95], v[88:91]
    buffer_load_dwordx4 v66, s[40:43], s52 offen lds
    v_cvt_pk_bf16_f32 v142, v80, v81
    v_cvt_pk_bf16_f32 v143, v82, v83
    v_mfma_f32_16x16x32_bf16 v[92:95], a[252:255], a[88:91], v[92:95]
    ds_read_b64_tr_b16 a[228:229], v23 offset:34816
    ds_read_b64_tr_b16 a[230:231], v23 offset:38912
    v_mfma_f32_16x16x32_bf16 v[96:99], a[252:255], a[92:95], v[96:99]
    s_waitcnt lgkmcnt(4)
    buffer_store_dwordx4 v[56:59], v17, s[44:47], s11 offen
    buffer_store_dwordx4 v[140:143], v17, s[44:47], s11 offen offset:1024
    v_lshlrev_b32 v34, 16, v144
    v_mfma_f32_16x16x32_bf16 v[84:87], a[208:211], a[104:107], v[84:87]
    ds_read_b64_tr_b16 a[232:233], v23 offset:40960
    ds_read_b64_tr_b16 a[234:235], v23 offset:45056
    v_mfma_f32_16x16x32_bf16 v[88:91], a[208:211], a[108:111], v[88:91]
    v_and_b32 v35, 0xffff0000, v144
    v_lshlrev_b32_e64 v36, 16, v145
    v_and_b32 v37, 0xffff0000, v145
    v_mfma_f32_16x16x32_bf16 v[92:95], a[212:215], a[104:107], v[92:95]
    ds_read_b64_tr_b16 a[236:237], v23 offset:43008
    ds_read_b64_tr_b16 a[238:239], v23 offset:47104
    v_mfma_f32_16x16x32_bf16 v[96:99], a[212:215], a[108:111], v[96:99]
    v_lshlrev_b32_e64 v38, 16, v146
    v_and_b32 v39, 0xffff0000, v146
    v_lshlrev_b32_e64 v40, 16, v147
    v_mfma_f32_16x16x32_bf16 v[84:87], a[216:219], a[120:123], v[84:87]
    ds_read_b64_tr_b16 a[240:241], v23 offset:49152
    ds_read_b64_tr_b16 a[242:243], v23 offset:53248
    v_mfma_f32_16x16x32_bf16 v[88:91], a[216:219], a[124:127], v[88:91]
    v_and_b32 v41, 0xffff0000, v147
    v_lshlrev_b32_e64 v42, 16, v148
    v_and_b32 v43, 0xffff0000, v148
    v_mfma_f32_16x16x32_bf16 v[92:95], a[220:223], a[120:123], v[92:95]
    ds_read_b64_tr_b16 a[244:245], v23 offset:51200
    ds_read_b64_tr_b16 a[246:247], v23 offset:55296
    v_mfma_f32_16x16x32_bf16 v[96:99], a[220:223], a[124:127], v[96:99]
    s_waitcnt lgkmcnt(4)
    v_lshlrev_b32 v44, 16, v149
    v_and_b32 v45, 0xffff0000, v149
    v_lshlrev_b32_e64 v46, 16, v150
    v_mfma_f32_16x16x32_bf16 v[100:103], a[224:227], a[8:11], v[100:103]
    ds_read_b64_tr_b16 a[248:249], v23 offset:57344
    ds_read_b64_tr_b16 a[250:251], v23 offset:61440
    v_mfma_f32_16x16x32_bf16 v[104:107], a[224:227], a[12:15], v[104:107]
    v_and_b32 v47, 0xffff0000, v150
    v_lshlrev_b32 v48, 16, v151
    v_and_b32 v49, 0xffff0000, v151
    v_mfma_f32_16x16x32_bf16 v[108:111], a[228:231], a[8:11], v[108:111]
    s_addk_i32 m0, -20480
    ds_read_b64_tr_b16 a[252:253], v23 offset:59392
    ds_read_b64_tr_b16 a[254:255], v23 offset:63488
    v_mfma_f32_16x16x32_bf16 v[112:115], a[228:231], a[12:15], v[112:115]
    buffer_load_dwordx4 v67, s[40:43], s52 offen lds
    v_add_u32 v177, 131072, v8
    v_pk_mul_f32 v[132:133], v[84:85], v[84:85]
    v_pk_mul_f32 v[134:135], v[86:87], v[86:87]
    v_pk_mul_f32 v[136:137], v[88:89], v[88:89]
    v_pk_mul_f32 v[138:139], v[90:91], v[90:91]
    v_pk_fma_f32 v[132:133], v[132:133], v[50:51], v[50:51] op_sel:[0,1,0] op_sel_hi:[1,1,0]
    v_pk_fma_f32 v[134:135], v[134:135], v[50:51], v[50:51] op_sel:[0,1,0] op_sel_hi:[1,1,0]
    v_pk_fma_f32 v[136:137], v[136:137], v[52:53], v[52:53] op_sel:[0,1,0] op_sel_hi:[1,1,0]
    v_pk_fma_f32 v[138:139], v[138:139], v[52:53], v[52:53] op_sel:[0,1,0] op_sel_hi:[1,1,0]
    v_pk_mul_f32 v[132:133], v[132:133], v[84:85]
    v_pk_mul_f32 v[134:135], v[134:135], v[86:87]
    v_pk_mul_f32 v[136:137], v[136:137], v[88:89]
    v_pk_mul_f32 v[138:139], v[138:139], v[90:91]
    v_mfma_f32_16x16x32_bf16 v[100:103], a[232:235], a[24:27], v[100:103]
    s_add_u32 m0, s66, 94208
    s_add_u32 s52, s53, 393216
    ds_read_b64_tr_b16 a[208:209], v177 offset:0
    ds_read_b64_tr_b16 a[210:211], v177 offset:4096
    v_mfma_f32_16x16x32_bf16 v[104:107], a[232:235], a[28:31], v[104:107]
    buffer_load_dwordx4 v64, s[40:43], s52 offen lds
    v_exp_f32_e64 v132, v132
    v_mfma_f32_16x16x32_bf16 v[108:111], a[236:239], a[24:27], v[108:111]
    ds_read_b64_tr_b16 a[212:213], v177 offset:2048
    ds_read_b64_tr_b16 a[214:215], v177 offset:6144
    v_mfma_f32_16x16x32_bf16 v[112:115], a[236:239], a[28:31], v[112:115]
    s_waitcnt lgkmcnt(4)
    v_exp_f32 v133, v133
    v_mfma_f32_16x16x32_bf16 v[100:103], a[240:243], a[40:43], v[100:103]
    s_add_u32 m0, s66, 16384
    ds_read_b64_tr_b16 a[216:217], v177 offset:8192
    ds_read_b64_tr_b16 a[218:219], v177 offset:12288
    v_mfma_f32_16x16x32_bf16 v[104:107], a[240:243], a[44:47], v[104:107]
    buffer_load_dwordx4 v65, s[40:43], s52 offen lds
    v_exp_f32_e64 v134, v134
    v_mfma_f32_16x16x32_bf16 v[108:111], a[244:247], a[40:43], v[108:111]
    ds_read_b64_tr_b16 a[220:221], v177 offset:10240
    ds_read_b64_tr_b16 a[222:223], v177 offset:14336
    v_mfma_f32_16x16x32_bf16 v[112:115], a[244:247], a[44:47], v[112:115]
    v_exp_f32 v135, v135
    v_mfma_f32_16x16x32_bf16 v[100:103], a[248:251], a[56:59], v[100:103]
    s_addk_i32 m0, 4096
    ds_read_b64_tr_b16 a[224:225], v177 offset:16384
    ds_read_b64_tr_b16 a[226:227], v177 offset:20480
    v_mfma_f32_16x16x32_bf16 v[104:107], a[248:251], a[60:63], v[104:107]
    buffer_load_dwordx4 v66, s[40:43], s52 offen lds
    v_exp_f32_e64 v136, v136
    v_mfma_f32_16x16x32_bf16 v[108:111], a[252:255], a[56:59], v[108:111]
    ds_read_b64_tr_b16 a[228:229], v177 offset:18432
    ds_read_b64_tr_b16 a[230:231], v177 offset:22528
    v_mfma_f32_16x16x32_bf16 v[112:115], a[252:255], a[60:63], v[112:115]
    s_waitcnt lgkmcnt(4)
    v_exp_f32 v137, v137
    v_mfma_f32_16x16x32_bf16 v[100:103], a[208:211], a[72:75], v[100:103]
    ds_read_b64_tr_b16 a[232:233], v177 offset:24576
    ds_read_b64_tr_b16 a[234:235], v8 offset:36864
    v_mfma_f32_16x16x32_bf16 v[104:107], a[208:211], a[76:79], v[104:107]
    v_exp_f32 v138, v138
    v_exp_f32 v139, v139
    v_pk_mul_f32 v[92:93], v[84:85], v[92:93]
    v_pk_mul_f32 v[94:95], v[86:87], v[94:95]
    v_pk_mul_f32 v[96:97], v[88:89], v[96:97]
    v_pk_mul_f32 v[98:99], v[90:91], v[98:99]
    v_pk_fma_f32 v[132:133], v[132:133], v[54:55], v[54:55] op_sel:[0,0,0] op_sel_hi:[1,0,0]
    v_pk_fma_f32 v[134:135], v[134:135], v[54:55], v[54:55] op_sel:[0,0,0] op_sel_hi:[1,0,0]
    v_pk_fma_f32 v[136:137], v[136:137], v[54:55], v[54:55] op_sel:[0,1,1] op_sel_hi:[1,1,1]
    v_pk_fma_f32 v[138:139], v[138:139], v[54:55], v[54:55] op_sel:[0,1,1] op_sel_hi:[1,1,1]
    v_mfma_f32_16x16x32_bf16 v[108:111], a[212:215], a[72:75], v[108:111]
    s_add_u32 m0, s66, 69632
    ds_read_b64_tr_b16 a[236:237], v177 offset:26624
    ds_read_b64_tr_b16 a[238:239], v8 offset:38912
    v_mfma_f32_16x16x32_bf16 v[112:115], a[212:215], a[76:79], v[112:115]
    buffer_load_dwordx4 v67, s[40:43], s52 offen lds
    v_rcp_f32_e64 v132, v132
    v_mfma_f32_16x16x32_bf16 v[100:103], a[216:219], a[88:91], v[100:103]
    s_add_u32 m0, s66, 73728
    s_add_u32 s52, s53, 786432
    ds_read_b64_tr_b16 a[240:241], v174 offset:32768
    ds_read_b64_tr_b16 a[242:243], v174 offset:36864
    v_mfma_f32_16x16x32_bf16 v[104:107], a[216:219], a[92:95], v[104:107]
    buffer_load_dwordx4 v64, s[40:43], s52 offen lds
    v_rcp_f32_e64 v133, v133
    v_mfma_f32_16x16x32_bf16 v[108:111], a[220:223], a[88:91], v[108:111]
    ds_read_b64_tr_b16 a[244:245], v174 offset:34816
    ds_read_b64_tr_b16 a[246:247], v174 offset:38912
    v_mfma_f32_16x16x32_bf16 v[112:115], a[220:223], a[92:95], v[112:115]
    s_waitcnt lgkmcnt(4)
    v_rcp_f32 v134, v134
    v_mfma_f32_16x16x32_bf16 v[100:103], a[224:227], a[104:107], v[100:103]
    s_add_u32 m0, s66, 81920
    ds_read_b64_tr_b16 a[248:249], v175 offset:32768
    ds_read_b64_tr_b16 a[250:251], v175 offset:36864
    v_mfma_f32_16x16x32_bf16 v[104:107], a[224:227], a[108:111], v[104:107]
    buffer_load_dwordx4 v65, s[40:43], s52 offen lds
    v_rcp_f32_e64 v135, v135
    v_mfma_f32_16x16x32_bf16 v[108:111], a[228:231], a[104:107], v[108:111]
    ds_read_b64_tr_b16 a[252:253], v175 offset:34816
    ds_read_b64_tr_b16 a[254:255], v175 offset:38912
    v_mfma_f32_16x16x32_bf16 v[112:115], a[228:231], a[108:111], v[112:115]
    v_rcp_f32_e64 v136, v136
    v_mfma_f32_16x16x32_bf16 v[100:103], a[232:235], a[120:123], v[100:103]
    ds_read_b64_tr_b16 a[208:209], v174 offset:40960
    ds_read_b64_tr_b16 a[210:211], v174 offset:45056
    v_mfma_f32_16x16x32_bf16 v[104:107], a[232:235], a[124:127], v[104:107]
    v_rcp_f32_e64 v137, v137
    v_mfma_f32_16x16x32_bf16 v[108:111], a[236:239], a[120:123], v[108:111]
    s_add_u32 m0, s66, 86016
    ds_read_b64_tr_b16 a[212:213], v174 offset:43008
    ds_read_b64_tr_b16 a[214:215], v174 offset:47104
    v_mfma_f32_16x16x32_bf16 v[112:115], a[236:239], a[124:127], v[112:115]
    s_waitcnt lgkmcnt(4)
    buffer_load_dwordx4 v66, s[40:43], s52 offen lds
    v_rcp_f32 v138, v138
    v_rcp_f32_e64 v139, v139
    v_pk_mul_f32 v[92:93], v[92:93], v[132:133]
    v_pk_mul_f32 v[94:95], v[94:95], v[134:135]
    v_pk_mul_f32 v[96:97], v[96:97], v[136:137]
    v_pk_mul_f32 v[98:99], v[98:99], v[138:139]
    v_mfma_f32_16x16x32_bf16 v[116:119], a[240:243], a[8:11], 0
    s_add_u32 m0, s66, 28672
    ds_read_b64_tr_b16 a[216:217], v175 offset:40960
    ds_read_b64_tr_b16 a[218:219], v175 offset:45056
    v_mfma_f32_16x16x32_bf16 v[120:123], a[240:243], a[12:15], 0
    buffer_load_dwordx4 v67, s[40:43], s52 offen lds
    v_cvt_pk_bf16_f32 v56, v92, v93
    v_cvt_pk_bf16_f32 v57, v94, v95
    v_mfma_f32_16x16x32_bf16 v[124:127], a[244:247], a[8:11], 0
    ds_read_b64_tr_b16 a[220:221], v175 offset:43008
    ds_read_b64_tr_b16 a[222:223], v175 offset:47104
    v_mfma_f32_16x16x32_bf16 v[128:131], a[244:247], a[12:15], 0
    v_cvt_pk_bf16_f32 v140, v96, v97
    v_cvt_pk_bf16_f32 v141, v98, v99
    v_mfma_f32_16x16x32_bf16 v[152:155], a[248:251], a[8:11], 0
    ds_read_b64_tr_b16 a[224:225], v174 offset:49152
    ds_read_b64_tr_b16 a[226:227], v174 offset:53248
    v_mfma_f32_16x16x32_bf16 v[156:159], a[248:251], a[12:15], 0
    v_pk_mul_f32 v[132:133], v[100:101], v[100:101]
    v_pk_mul_f32 v[134:135], v[102:103], v[102:103]
    v_pk_mul_f32 v[136:137], v[104:105], v[104:105]
    v_pk_mul_f32 v[138:139], v[106:107], v[106:107]
    v_pk_fma_f32 v[132:133], v[132:133], v[50:51], v[50:51] op_sel:[0,1,0] op_sel_hi:[1,1,0]
    v_pk_fma_f32 v[134:135], v[134:135], v[50:51], v[50:51] op_sel:[0,1,0] op_sel_hi:[1,1,0]
    v_pk_fma_f32 v[136:137], v[136:137], v[52:53], v[52:53] op_sel:[0,1,0] op_sel_hi:[1,1,0]
    v_pk_fma_f32 v[138:139], v[138:139], v[52:53], v[52:53] op_sel:[0,1,0] op_sel_hi:[1,1,0]
    v_pk_mul_f32 v[132:133], v[132:133], v[100:101]
    v_pk_mul_f32 v[134:135], v[134:135], v[102:103]
    v_pk_mul_f32 v[136:137], v[136:137], v[104:105]
    v_pk_mul_f32 v[138:139], v[138:139], v[106:107]
    s_waitcnt vmcnt(9)
    s_barrier
    v_mfma_f32_16x16x32_bf16 v[160:163], a[252:255], a[8:11], 0
    s_add_u32 m0, s66, 0
    s_add_u32 s52, s53, 1179648
    ds_read_b64_tr_b16 a[228:229], v174 offset:51200
    ds_read_b64_tr_b16 a[230:231], v174 offset:55296
    v_mfma_f32_16x16x32_bf16 v[164:167], a[252:255], a[12:15], 0
    s_waitcnt lgkmcnt(4)
    buffer_load_dwordx4 v64, s[40:43], s52 offen lds
    v_exp_f32_e64 v132, v132
    v_mfma_f32_16x16x32_bf16 v[116:119], a[208:211], a[24:27], v[116:119]
    s_add_u32 m0, s66, 8192
    ds_read_b64_tr_b16 a[232:233], v175 offset:49152
    ds_read_b64_tr_b16 a[234:235], v175 offset:53248
    v_mfma_f32_16x16x32_bf16 v[120:123], a[208:211], a[28:31], v[120:123]
    buffer_load_dwordx4 v65, s[40:43], s52 offen lds
    v_exp_f32_e64 v133, v133
    v_mfma_f32_16x16x32_bf16 v[124:127], a[212:215], a[24:27], v[124:127]
    s_add_u32 m0, s66, 12288
    ds_read_b64_tr_b16 a[236:237], v175 offset:51200
    ds_read_b64_tr_b16 a[238:239], v175 offset:55296
    v_mfma_f32_16x16x32_bf16 v[128:131], a[212:215], a[28:31], v[128:131]
    buffer_load_dwordx4 v66, s[40:43], s52 offen lds
    v_exp_f32_e64 v134, v134
    v_mfma_f32_16x16x32_bf16 v[152:155], a[216:219], a[24:27], v[152:155]
    ds_read_b64_tr_b16 a[240:241], v174 offset:57344
    ds_read_b64_tr_b16 a[242:243], v174 offset:61440
    v_mfma_f32_16x16x32_bf16 v[156:159], a[216:219], a[28:31], v[156:159]
    s_mov_b64 exec, s[4:5]
    buffer_store_dword v2, off, s[48:51], s79 offset:256
    s_mov_b64 exec, -1
    v_exp_f32_e64 v135, v135
    v_mfma_f32_16x16x32_bf16 v[160:163], a[220:223], a[24:27], v[160:163]
    ds_read_b64_tr_b16 a[244:245], v174 offset:59392
    ds_read_b64_tr_b16 a[246:247], v174 offset:63488
    v_mfma_f32_16x16x32_bf16 v[164:167], a[220:223], a[28:31], v[164:167]
    s_waitcnt lgkmcnt(4)
    v_exp_f32 v136, v136
    v_mfma_f32_16x16x32_bf16 v[116:119], a[224:227], a[40:43], v[116:119]
    ds_read_b64_tr_b16 a[248:249], v175 offset:57344
    ds_read_b64_tr_b16 a[250:251], v175 offset:61440
    v_mfma_f32_16x16x32_bf16 v[120:123], a[224:227], a[44:47], v[120:123]
    v_exp_f32_e64 v137, v137
    v_mfma_f32_16x16x32_bf16 v[124:127], a[228:231], a[40:43], v[124:127]
    ds_read_b64_tr_b16 a[252:253], v175 offset:59392
    ds_read_b64_tr_b16 a[254:255], v175 offset:63488
    v_mfma_f32_16x16x32_bf16 v[128:131], a[228:231], a[44:47], v[128:131]
    v_add_u32 v178, 131072, v9
    v_exp_f32 v138, v138
    v_exp_f32 v139, v139
    v_pk_mul_f32 v[108:109], v[100:101], v[108:109]
    v_pk_mul_f32 v[110:111], v[102:103], v[110:111]
    v_pk_mul_f32 v[112:113], v[104:105], v[112:113]
    v_pk_mul_f32 v[114:115], v[106:107], v[114:115]
    v_pk_fma_f32 v[132:133], v[132:133], v[54:55], v[54:55] op_sel:[0,0,0] op_sel_hi:[1,0,0]
    v_pk_fma_f32 v[134:135], v[134:135], v[54:55], v[54:55] op_sel:[0,0,0] op_sel_hi:[1,0,0]
    v_pk_fma_f32 v[136:137], v[136:137], v[54:55], v[54:55] op_sel:[0,1,1] op_sel_hi:[1,1,1]
    v_pk_fma_f32 v[138:139], v[138:139], v[54:55], v[54:55] op_sel:[0,1,1] op_sel_hi:[1,1,1]
    v_mfma_f32_16x16x32_bf16 v[152:155], a[232:235], a[40:43], v[152:155]
    ds_read_b64_tr_b16 a[208:209], v178 offset:0
    ds_read_b64_tr_b16 a[210:211], v178 offset:4096
    v_mfma_f32_16x16x32_bf16 v[156:159], a[232:235], a[44:47], v[156:159]
    v_rcp_f32_e64 v132, v132
    v_mfma_f32_16x16x32_bf16 v[160:163], a[236:239], a[40:43], v[160:163]
    ds_read_b64_tr_b16 a[212:213], v178 offset:2048
    ds_read_b64_tr_b16 a[214:215], v178 offset:6144
    v_mfma_f32_16x16x32_bf16 v[164:167], a[236:239], a[44:47], v[164:167]
    s_waitcnt lgkmcnt(4)
    v_add_u32 v179, 131072, v10
    v_rcp_f32 v133, v133
    s_waitcnt vmcnt(11)
    s_barrier
    v_mfma_f32_16x16x32_bf16 v[116:119], a[240:243], a[56:59], v[116:119]
    s_add_u32 m0, s66, 98304
    ds_read_b64_tr_b16 a[216:217], v179 offset:0
    ds_read_b64_tr_b16 a[218:219], v179 offset:4096
    v_mfma_f32_16x16x32_bf16 v[120:123], a[240:243], a[60:63], v[120:123]
    buffer_load_dwordx4 v67, s[40:43], s52 offen lds
    v_rcp_f32 v134, v134
    v_mfma_f32_16x16x32_bf16 v[124:127], a[244:247], a[56:59], v[124:127]
    s_add_u32 m0, s66, 102400
    s_add_u32 s52, s54, 0
    ds_read_b64_tr_b16 a[220:221], v179 offset:2048
    ds_read_b64_tr_b16 a[222:223], v179 offset:6144
    v_mfma_f32_16x16x32_bf16 v[128:131], a[244:247], a[60:63], v[128:131]
    buffer_load_dwordx4 v64, s[40:43], s52 offen lds
    v_rcp_f32 v135, v135
    v_mfma_f32_16x16x32_bf16 v[152:155], a[248:251], a[56:59], v[152:155]
    s_addk_i32 m0, 4096
    ds_read_b64_tr_b16 a[224:225], v178 offset:8192
    ds_read_b64_tr_b16 a[226:227], v178 offset:12288
    v_mfma_f32_16x16x32_bf16 v[156:159], a[248:251], a[60:63], v[156:159]
    buffer_load_dwordx4 v65, s[40:43], s52 offen lds
    v_rcp_f32_e64 v136, v136
    v_mfma_f32_16x16x32_bf16 v[160:163], a[252:255], a[56:59], v[160:163]
    s_add_u32 m0, s66, 110592
    ds_read_b64_tr_b16 a[228:229], v178 offset:10240
    ds_read_b64_tr_b16 a[230:231], v178 offset:14336
    v_mfma_f32_16x16x32_bf16 v[164:167], a[252:255], a[60:63], v[164:167]
    s_waitcnt lgkmcnt(4)
    buffer_load_dwordx4 v66, s[40:43], s52 offen lds
    v_rcp_f32 v137, v137
    v_mfma_f32_16x16x32_bf16 v[116:119], a[208:211], a[72:75], v[116:119]
    s_add_u32 m0, s66, 114688
    ds_read_b64_tr_b16 a[232:233], v179 offset:8192
    ds_read_b64_tr_b16 a[234:235], v179 offset:12288
    v_mfma_f32_16x16x32_bf16 v[120:123], a[208:211], a[76:79], v[120:123]
    buffer_load_dwordx4 v67, s[40:43], s52 offen lds
    v_rcp_f32 v138, v138
    v_rcp_f32 v139, v139
    v_pk_mul_f32 v[108:109], v[108:109], v[132:133]
    v_pk_mul_f32 v[110:111], v[110:111], v[134:135]
    v_pk_mul_f32 v[112:113], v[112:113], v[136:137]
    v_pk_mul_f32 v[114:115], v[114:115], v[138:139]
    v_mfma_f32_16x16x32_bf16 v[124:127], a[212:215], a[72:75], v[124:127]
    s_add_u32 m0, s66, 118784
    s_add_u32 s52, s54, 393216
    ds_read_b64_tr_b16 a[236:237], v179 offset:10240
    ds_read_b64_tr_b16 a[238:239], v179 offset:14336
    v_mfma_f32_16x16x32_bf16 v[128:131], a[212:215], a[76:79], v[128:131]
    buffer_load_dwordx4 v64, s[40:43], s52 offen lds
    v_cvt_pk_bf16_f32 v58, v108, v109
    v_cvt_pk_bf16_f32 v59, v110, v111
    v_mfma_f32_16x16x32_bf16 v[152:155], a[216:219], a[72:75], v[152:155]
    ds_read_b64_tr_b16 a[240:241], v178 offset:16384
    ds_read_b64_tr_b16 a[242:243], v178 offset:20480
    v_mfma_f32_16x16x32_bf16 v[156:159], a[216:219], a[76:79], v[156:159]
    v_cvt_pk_bf16_f32 v142, v112, v113
    v_cvt_pk_bf16_f32 v143, v114, v115
    s_add_u32 s13, s12, 262144
    buffer_store_dwordx4 v[56:59], v17, s[48:51], s13 offen offset:0 sc1
    buffer_store_dwordx4 v[140:143], v17, s[48:51], s13 offen offset:1024 sc1
    v_mfma_f32_16x16x32_bf16 v[160:163], a[220:223], a[72:75], v[160:163]
    ds_read_b64_tr_b16 a[244:245], v178 offset:18432
    ds_read_b64_tr_b16 a[246:247], v178 offset:22528
    v_mfma_f32_16x16x32_bf16 v[164:167], a[220:223], a[76:79], v[164:167]
    s_waitcnt lgkmcnt(4)
    v_mfma_f32_16x16x32_bf16 v[116:119], a[224:227], a[88:91], v[116:119]
    ds_read_b64_tr_b16 a[248:249], v179 offset:16384
    v_mfma_f32_16x16x32_bf16 v[120:123], a[224:227], a[92:95], v[120:123]
    ds_read_b64_tr_b16 a[250:251], v179 offset:20480
    v_mfma_f32_16x16x32_bf16 v[124:127], a[228:231], a[88:91], v[124:127]
    ds_read_b64_tr_b16 a[252:253], v179 offset:18432
    v_mfma_f32_16x16x32_bf16 v[128:131], a[228:231], a[92:95], v[128:131]
    ds_read_b64_tr_b16 a[254:255], v179 offset:22528
    v_mfma_f32_16x16x32_bf16 v[152:155], a[232:235], a[88:91], v[152:155]
    ds_read_b64_tr_b16 a[208:209], v178 offset:24576
    v_mfma_f32_16x16x32_bf16 v[156:159], a[232:235], a[92:95], v[156:159]
    ds_read_b64_tr_b16 a[210:211], v9 offset:36864
    v_mfma_f32_16x16x32_bf16 v[160:163], a[236:239], a[88:91], v[160:163]
    ds_read_b64_tr_b16 a[212:213], v178 offset:26624
    ds_read_b64_tr_b16 a[214:215], v9 offset:38912
    v_mfma_f32_16x16x32_bf16 v[164:167], a[236:239], a[92:95], v[164:167]
    s_waitcnt vmcnt(13) lgkmcnt(4)
    s_barrier
    v_mfma_f32_16x16x32_bf16 v[116:119], a[240:243], a[104:107], v[116:119]
    s_addk_i32 m0, 4096
    ds_read_b64_tr_b16 a[216:217], v179 offset:24576
    ds_read_b64_tr_b16 a[218:219], v10 offset:36864
    v_mfma_f32_16x16x32_bf16 v[120:123], a[240:243], a[108:111], v[120:123]
    buffer_load_dwordx4 v65, s[40:43], s52 offen lds
    v_mfma_f32_16x16x32_bf16 v[124:127], a[244:247], a[104:107], v[124:127]
    s_add_u32 m0, s66, 126976
    ds_read_b64_tr_b16 a[220:221], v179 offset:26624
    ds_read_b64_tr_b16 a[222:223], v10 offset:38912
    v_mfma_f32_16x16x32_bf16 v[128:131], a[244:247], a[108:111], v[128:131]
    buffer_load_dwordx4 v66, s[40:43], s52 offen lds
    v_mfma_f32_16x16x32_bf16 v[152:155], a[248:251], a[104:107], v[152:155]
    ds_read_b64_tr_b16 a[224:225], v11 offset:49152
    v_mfma_f32_16x16x32_bf16 v[156:159], a[248:251], a[108:111], v[156:159]
    ds_read_b64_tr_b16 a[226:227], v11 offset:50176
    v_mfma_f32_16x16x32_bf16 v[160:163], a[252:255], a[104:107], v[160:163]
    ds_read_b64_tr_b16 a[228:229], v11 offset:51200
    ds_read_b64_tr_b16 a[230:231], v11 offset:52224
    v_mfma_f32_16x16x32_bf16 v[164:167], a[252:255], a[108:111], v[164:167]
    s_waitcnt lgkmcnt(4)
    v_mfma_f32_16x16x32_bf16 v[116:119], a[208:211], a[120:123], v[116:119]
    s_addk_i32 m0, 4096
    ds_read_b64_tr_b16 a[232:233], v14 offset:49152
    ds_read_b64_tr_b16 a[234:235], v14 offset:50176
    v_mfma_f32_16x16x32_bf16 v[120:123], a[208:211], a[124:127], v[120:123]
    buffer_load_dwordx4 v67, s[40:43], s52 offen lds
    v_mfma_f32_16x16x32_bf16 v[124:127], a[212:215], a[120:123], v[124:127]
    ds_read_b64_tr_b16 a[236:237], v14 offset:51200
    ds_read_b64_tr_b16 a[238:239], v14 offset:52224
    v_mfma_f32_16x16x32_bf16 v[128:131], a[212:215], a[124:127], v[128:131]
    s_mov_b64 exec, s[6:7]
    buffer_load_dword v33, v20, s[48:51], s71 offen offset:256 sc1
    s_mov_b64 exec, -1
    v_mfma_f32_16x16x32_bf16 v[152:155], a[216:219], a[120:123], v[152:155]
    ds_read_b64_tr_b16 a[240:241], v11 offset:61440
    v_mfma_f32_16x16x32_bf16 v[156:159], a[216:219], a[124:127], v[156:159]
    ds_read_b64_tr_b16 a[242:243], v11 offset:62464
    v_mfma_f32_16x16x32_bf16 v[160:163], a[220:223], a[120:123], v[160:163]
    s_addk_i32 m0, 4096
    s_add_u32 s52, s54, 786432
    ds_read_b64_tr_b16 a[244:245], v11 offset:63488
    ds_read_b64_tr_b16 a[246:247], v11 offset:64512
    v_mfma_f32_16x16x32_bf16 v[164:167], a[220:223], a[124:127], v[164:167]
    s_waitcnt lgkmcnt(4)
    buffer_load_dwordx4 v64, s[40:43], s52 offen lds
    v_mfma_f32_16x16x32_bf16 v[116:119], a[224:227], a[0:3], v[116:119]
    ds_read_b64_tr_b16 a[248:249], v14 offset:61440
    v_mfma_f32_16x16x32_bf16 v[120:123], a[224:227], a[4:7], v[120:123]
    ds_read_b64_tr_b16 a[250:251], v14 offset:62464
    v_mfma_f32_16x16x32_bf16 v[124:127], a[228:231], a[0:3], v[124:127]
    s_add_u32 m0, s66, 139264
    ds_read_b64_tr_b16 a[252:253], v14 offset:63488
    ds_read_b64_tr_b16 a[254:255], v14 offset:64512
    v_mfma_f32_16x16x32_bf16 v[128:131], a[228:231], a[4:7], v[128:131]
    buffer_load_dwordx4 v65, s[40:43], s52 offen lds
    v_mfma_f32_16x16x32_bf16 v[152:155], a[232:235], a[0:3], v[152:155]
    ds_read_b64_tr_b16 a[208:209], v172 offset:0
    v_mfma_f32_16x16x32_bf16 v[156:159], a[232:235], a[4:7], v[156:159]
    ds_read_b64_tr_b16 a[210:211], v172 offset:1024
    v_mfma_f32_16x16x32_bf16 v[160:163], a[236:239], a[0:3], v[160:163]
    ds_read_b64_tr_b16 a[212:213], v172 offset:2048
    ds_read_b64_tr_b16 a[214:215], v172 offset:3072
    v_mfma_f32_16x16x32_bf16 v[164:167], a[236:239], a[4:7], v[164:167]
    s_waitcnt lgkmcnt(4)
    v_mfma_f32_16x16x32_bf16 v[116:119], a[240:243], a[16:19], v[116:119]
    s_addk_i32 m0, 4096
    ds_read_b64_tr_b16 a[216:217], v173 offset:0
    ds_read_b64_tr_b16 a[218:219], v173 offset:1024
    v_mfma_f32_16x16x32_bf16 v[120:123], a[240:243], a[20:23], v[120:123]
    buffer_load_dwordx4 v66, s[40:43], s52 offen lds
    v_mfma_f32_16x16x32_bf16 v[124:127], a[244:247], a[16:19], v[124:127]
    ds_read_b64_tr_b16 a[220:221], v173 offset:2048
    v_mfma_f32_16x16x32_bf16 v[128:131], a[244:247], a[20:23], v[128:131]
    ds_read_b64_tr_b16 a[222:223], v173 offset:3072
    v_mfma_f32_16x16x32_bf16 v[152:155], a[248:251], a[16:19], v[152:155]
    ds_read_b64_tr_b16 a[224:225], v172 offset:24576
    v_mfma_f32_16x16x32_bf16 v[156:159], a[248:251], a[20:23], v[156:159]
    ds_read_b64_tr_b16 a[226:227], v172 offset:25600
    v_mfma_f32_16x16x32_bf16 v[160:163], a[252:255], a[16:19], v[160:163]
    ds_read_b64_tr_b16 a[228:229], v172 offset:26624
    ds_read_b64_tr_b16 a[230:231], v172 offset:27648
    v_mfma_f32_16x16x32_bf16 v[164:167], a[252:255], a[20:23], v[164:167]
    s_waitcnt vmcnt(13) lgkmcnt(4)
    s_barrier
L_vis_v1_1:
    s_cbranch_execz L_ret_v1
    v_mfma_f32_16x16x32_bf16 v[116:119], a[208:211], a[32:35], v[116:119]
    s_addk_i32 m0, 4096
    ds_read_b64_tr_b16 a[232:233], v173 offset:24576
    ds_read_b64_tr_b16 a[234:235], v173 offset:25600
    v_mfma_f32_16x16x32_bf16 v[120:123], a[208:211], a[36:39], v[120:123]
    buffer_load_dwordx4 v67, s[40:43], s52 offen lds
    v_mfma_f32_16x16x32_bf16 v[124:127], a[212:215], a[32:35], v[124:127]
    s_add_u32 m0, s66, 151552
    s_add_u32 s52, s54, 1179648
    ds_read_b64_tr_b16 a[236:237], v173 offset:26624
    ds_read_b64_tr_b16 a[238:239], v173 offset:27648
    v_mfma_f32_16x16x32_bf16 v[128:131], a[212:215], a[36:39], v[128:131]
    buffer_load_dwordx4 v64, s[40:43], s52 offen lds
    v_mfma_f32_16x16x32_bf16 v[152:155], a[216:219], a[32:35], v[152:155]
    ds_read_b64_tr_b16 a[240:241], v11 offset:32768
    v_mfma_f32_16x16x32_bf16 v[156:159], a[216:219], a[36:39], v[156:159]
    ds_read_b64_tr_b16 a[242:243], v11 offset:33792
    v_mfma_f32_16x16x32_bf16 v[160:163], a[220:223], a[32:35], v[160:163]
    s_add_u32 m0, s66, 155648
    ds_read_b64_tr_b16 a[244:245], v11 offset:34816
    ds_read_b64_tr_b16 a[246:247], v11 offset:35840
    v_mfma_f32_16x16x32_bf16 v[164:167], a[220:223], a[36:39], v[164:167]
    s_waitcnt lgkmcnt(4)
    buffer_load_dwordx4 v65, s[40:43], s52 offen lds
    v_mfma_f32_16x16x32_bf16 v[116:119], a[224:227], a[48:51], v[116:119]
    ds_read_b64_tr_b16 a[248:249], v14 offset:32768
    v_mfma_f32_16x16x32_bf16 v[120:123], a[224:227], a[52:55], v[120:123]
    ds_read_b64_tr_b16 a[250:251], v14 offset:33792
    v_mfma_f32_16x16x32_bf16 v[124:127], a[228:231], a[48:51], v[124:127]
    s_add_u32 m0, s66, 36864
    s_add_u32 s52, s55, 0
    ds_read_b64_tr_b16 a[252:253], v14 offset:34816
    ds_read_b64_tr_b16 a[254:255], v14 offset:35840
    v_mfma_f32_16x16x32_bf16 v[128:131], a[228:231], a[52:55], v[128:131]
    buffer_load_dwordx4 v64, s[40:43], s52 offen lds
    v_mfma_f32_16x16x32_bf16 v[152:155], a[232:235], a[48:51], v[152:155]
    ds_read_b64_tr_b16 a[208:209], v11 offset:40960
    v_mfma_f32_16x16x32_bf16 v[156:159], a[232:235], a[52:55], v[156:159]
    ds_read_b64_tr_b16 a[210:211], v11 offset:41984
    v_mfma_f32_16x16x32_bf16 v[160:163], a[236:239], a[48:51], v[160:163]
    ds_read_b64_tr_b16 a[212:213], v11 offset:43008
    ds_read_b64_tr_b16 a[214:215], v11 offset:44032
    v_mfma_f32_16x16x32_bf16 v[164:167], a[236:239], a[52:55], v[164:167]
    s_waitcnt vmcnt(11) lgkmcnt(4)
    s_barrier
    v_mfma_f32_16x16x32_bf16 v[116:119], a[240:243], a[64:67], v[116:119]
    s_add_u32 m0, s66, 49152
    ds_read_b64_tr_b16 a[216:217], v14 offset:40960
    ds_read_b64_tr_b16 a[218:219], v14 offset:41984
    v_mfma_f32_16x16x32_bf16 v[120:123], a[240:243], a[68:71], v[120:123]
    buffer_load_dwordx4 v65, s[40:43], s52 offen lds
    s_mov_b64 exec, s[4:5]
    buffer_store_dword v2, off, s[48:51], s79 offset:384
    s_mov_b64 exec, -1
    v_mfma_f32_16x16x32_bf16 v[124:127], a[244:247], a[64:67], v[124:127]
    ds_read_b64_tr_b16 a[220:221], v14 offset:43008
    v_mfma_f32_16x16x32_bf16 v[128:131], a[244:247], a[68:71], v[128:131]
    ds_read_b64_tr_b16 a[222:223], v14 offset:44032
    v_mfma_f32_16x16x32_bf16 v[152:155], a[248:251], a[64:67], v[152:155]
    s_add_u32 m0, s66, 61440
    ds_read_b64_tr_b16 a[224:225], v11 offset:45056
    ds_read_b64_tr_b16 a[226:227], v11 offset:46080
    v_mfma_f32_16x16x32_bf16 v[156:159], a[248:251], a[68:71], v[156:159]
    buffer_load_dwordx4 v66, s[40:43], s52 offen lds
    v_mfma_f32_16x16x32_bf16 v[160:163], a[252:255], a[64:67], v[160:163]
    ds_read_b64_tr_b16 a[228:229], v11 offset:47104
    ds_read_b64_tr_b16 a[230:231], v11 offset:48128
    v_mfma_f32_16x16x32_bf16 v[164:167], a[252:255], a[68:71], v[164:167]
    s_waitcnt lgkmcnt(4)
    v_mfma_f32_16x16x32_bf16 v[116:119], a[208:211], a[80:83], v[116:119]
    ds_read_b64_tr_b16 a[232:233], v14 offset:45056
    v_mfma_f32_16x16x32_bf16 v[120:123], a[208:211], a[84:87], v[120:123]
    ds_read_b64_tr_b16 a[234:235], v14 offset:46080
    v_mfma_f32_16x16x32_bf16 v[124:127], a[212:215], a[80:83], v[124:127]
    s_addk_i32 m0, 4096
    ds_read_b64_tr_b16 a[236:237], v14 offset:47104
    ds_read_b64_tr_b16 a[238:239], v14 offset:48128
    v_mfma_f32_16x16x32_bf16 v[128:131], a[212:215], a[84:87], v[128:131]
    buffer_load_dwordx4 v67, s[40:43], s52 offen lds
    s_waitcnt vmcnt(11)
    v_cmp_eq_u32 vcc, 0, v33
    s_nop 0
    s_and_b64 vcc, vcc, s[6:7]
    s_cbranch_vccnz L_late4
L_back4:
    v_mfma_f32_16x16x32_bf16 v[152:155], a[216:219], a[80:83], v[152:155]
    ds_read_b64_tr_b16 a[240:241], v11 offset:53248
    v_mfma_f32_16x16x32_bf16 v[156:159], a[216:219], a[84:87], v[156:159]
    ds_read_b64_tr_b16 a[242:243], v11 offset:54272
    v_mfma_f32_16x16x32_bf16 v[160:163], a[220:223], a[80:83], v[160:163]
    s_addk_i32 m0, 24576
    s_add_u32 s52, s55, 393216
    ds_read_b64_tr_b16 a[244:245], v11 offset:55296
    ds_read_b64_tr_b16 a[246:247], v11 offset:56320
    v_mfma_f32_16x16x32_bf16 v[164:167], a[220:223], a[84:87], v[164:167]
    s_waitcnt lgkmcnt(4)
    buffer_load_dwordx4 v64, s[40:43], s52 offen lds
    v_mfma_f32_16x16x32_bf16 v[116:119], a[224:227], a[96:99], v[116:119]
    ds_read_b64_tr_b16 a[248:249], v14 offset:53248
    ds_read_b64_tr_b16 a[250:251], v14 offset:54272
    v_mfma_f32_16x16x32_bf16 v[120:123], a[224:227], a[100:103], v[120:123]
    s_barrier
    v_mfma_f32_16x16x32_bf16 v[124:127], a[228:231], a[96:99], v[124:127]
    s_add_u32 s14, s15, 0
    ds_read_b64_tr_b16 a[252:253], v14 offset:55296
    ds_read_b64_tr_b16 a[254:255], v14 offset:56320
    v_mfma_f32_16x16x32_bf16 v[128:131], a[228:231], a[100:103], v[128:131]
    buffer_load_dwordx4 a[128:131], v21, s[44:47], s14 offen sc1
    v_add_u32 v180, 65536, v15
    v_mfma_f32_16x16x32_bf16 v[152:155], a[232:235], a[96:99], v[152:155]
    ds_read_b64_tr_b16 a[208:209], v15 offset:57344
    ds_read_b64_tr_b16 a[210:211], v180 offset:12288
    v_mfma_f32_16x16x32_bf16 v[156:159], a[232:235], a[100:103], v[156:159]
    v_add_u32 v181, 65536, v16
    v_mfma_f32_16x16x32_bf16 v[160:163], a[236:239], a[96:99], v[160:163]
    ds_read_b64_tr_b16 a[212:213], v16 offset:57344
    ds_read_b64_tr_b16 a[214:215], v181 offset:12288
    v_mfma_f32_16x16x32_bf16 v[164:167], a[236:239], a[100:103], v[164:167]
    s_waitcnt lgkmcnt(4)
    buffer_load_dwordx4 a[132:135], v22, s[44:47], s14 offen sc1
    v_add_u32 v182, 65536, v18
    v_mfma_f32_16x16x32_bf16 v[116:119], a[240:243], a[112:115], v[116:119]
    ds_read_b64_tr_b16 a[216:217], v18 offset:57344
    ds_read_b64_tr_b16 a[218:219], v182 offset:12288
    v_mfma_f32_16x16x32_bf16 v[120:123], a[240:243], a[116:119], v[120:123]
    v_add_u32 v183, 65536, v19
    v_mfma_f32_16x16x32_bf16 v[124:127], a[244:247], a[112:115], v[124:127]
    ds_read_b64_tr_b16 a[220:221], v19 offset:57344
    v_mfma_f32_16x16x32_bf16 v[128:131], a[244:247], a[116:119], v[128:131]
    ds_read_b64_tr_b16 a[222:223], v183 offset:12288
    v_mfma_f32_16x16x32_bf16 v[152:155], a[248:251], a[112:115], v[152:155]
    s_add_u32 s14, s15, 4096
    ds_read_b64_tr_b16 a[224:225], v15 offset:24576
    ds_read_b64_tr_b16 a[226:227], v15 offset:4096
    v_mfma_f32_16x16x32_bf16 v[156:159], a[248:251], a[116:119], v[156:159]
    buffer_load_dwordx4 a[136:139], v21, s[44:47], s14 offen sc1
    v_pk_mul_f32 v[132:133], v[116:117], v[116:117]
    v_pk_mul_f32 v[134:135], v[118:119], v[118:119]
    v_pk_mul_f32 v[136:137], v[120:121], v[120:121]
    v_pk_mul_f32 v[138:139], v[122:123], v[122:123]
    v_pk_fma_f32 v[132:133], v[132:133], v[50:51], v[50:51] op_sel:[0,1,0] op_sel_hi:[1,1,0]
    v_pk_fma_f32 v[134:135], v[134:135], v[50:51], v[50:51] op_sel:[0,1,0] op_sel_hi:[1,1,0]
    v_pk_fma_f32 v[136:137], v[136:137], v[52:53], v[52:53] op_sel:[0,1,0] op_sel_hi:[1,1,0]
    v_pk_fma_f32 v[138:139], v[138:139], v[52:53], v[52:53] op_sel:[0,1,0] op_sel_hi:[1,1,0]
    v_pk_mul_f32 v[132:133], v[132:133], v[116:117]
    v_pk_mul_f32 v[134:135], v[134:135], v[118:119]
    v_pk_mul_f32 v[136:137], v[136:137], v[120:121]
    v_pk_mul_f32 v[138:139], v[138:139], v[122:123]
    v_mfma_f32_16x16x32_bf16 v[160:163], a[252:255], a[112:115], v[160:163]
    ds_read_b64_tr_b16 a[228:229], v16 offset:24576
    ds_read_b64_tr_b16 a[230:231], v16 offset:4096
    v_mfma_f32_16x16x32_bf16 v[164:167], a[252:255], a[116:119], v[164:167]
    s_waitcnt lgkmcnt(4)
    buffer_load_dwordx4 a[140:143], v22, s[44:47], s14 offen sc1
    v_exp_f32 v132, v132
    v_exp_f32 v133, v133
    v_exp_f32 v134, v134
    v_exp_f32 v135, v135
    s_add_u32 s14, s15, 8192
    buffer_load_dwordx4 a[144:147], v21, s[44:47], s14 offen sc1
    v_exp_f32 v136, v136
    v_exp_f32 v137, v137
    v_exp_f32 v138, v138
    v_exp_f32_e64 v139, v139
    v_pk_mul_f32 v[124:125], v[116:117], v[124:125]
    v_pk_mul_f32 v[126:127], v[118:119], v[126:127]
    v_pk_mul_f32 v[128:129], v[120:121], v[128:129]
    v_pk_mul_f32 v[130:131], v[122:123], v[130:131]
    v_pk_fma_f32 v[132:133], v[132:133], v[54:55], v[54:55] op_sel:[0,0,0] op_sel_hi:[1,0,0]
    v_pk_fma_f32 v[134:135], v[134:135], v[54:55], v[54:55] op_sel:[0,0,0] op_sel_hi:[1,0,0]
    v_pk_fma_f32 v[136:137], v[136:137], v[54:55], v[54:55] op_sel:[0,1,1] op_sel_hi:[1,1,1]
    v_pk_fma_f32 v[138:139], v[138:139], v[54:55], v[54:55] op_sel:[0,1,1] op_sel_hi:[1,1,1]
    buffer_load_dwordx4 a[148:151], v22, s[44:47], s14 offen sc1
    v_rcp_f32 v132, v132
    v_rcp_f32 v133, v133
    v_rcp_f32 v134, v134
    v_rcp_f32 v135, v135
    v_rcp_f32 v136, v136
    v_rcp_f32 v137, v137
    v_rcp_f32 v138, v138
    v_rcp_f32 v139, v139
    v_pk_mul_f32 v[124:125], v[124:125], v[132:133]
    v_pk_mul_f32 v[126:127], v[126:127], v[134:135]
    v_pk_mul_f32 v[128:129], v[128:129], v[136:137]
    v_pk_mul_f32 v[130:131], v[130:131], v[138:139]
    s_add_u32 s14, s15, 12288
    buffer_load_dwordx4 a[152:155], v21, s[44:47], s14 offen sc1
    v_cvt_pk_bf16_f32 v56, v124, v125
    v_cvt_pk_bf16_f32 v57, v126, v127
    v_cvt_pk_bf16_f32 v140, v128, v129
    v_cvt_pk_bf16_f32 v141, v130, v131
    v_pk_mul_f32 v[132:133], v[152:153], v[152:153]
    v_pk_mul_f32 v[134:135], v[154:155], v[154:155]
    v_pk_mul_f32 v[136:137], v[156:157], v[156:157]
    v_pk_mul_f32 v[138:139], v[158:159], v[158:159]
    v_pk_fma_f32 v[132:133], v[132:133], v[50:51], v[50:51] op_sel:[0,1,0] op_sel_hi:[1,1,0]
    v_pk_fma_f32 v[134:135], v[134:135], v[50:51], v[50:51] op_sel:[0,1,0] op_sel_hi:[1,1,0]
    v_pk_fma_f32 v[136:137], v[136:137], v[52:53], v[52:53] op_sel:[0,1,0] op_sel_hi:[1,1,0]
    v_pk_fma_f32 v[138:139], v[138:139], v[52:53], v[52:53] op_sel:[0,1,0] op_sel_hi:[1,1,0]
    v_pk_mul_f32 v[132:133], v[132:133], v[152:153]
    v_pk_mul_f32 v[134:135], v[134:135], v[154:155]
    v_pk_mul_f32 v[136:137], v[136:137], v[156:157]
    v_pk_mul_f32 v[138:139], v[138:139], v[158:159]
    v_exp_f32 v132, v132
    v_exp_f32 v133, v133
    buffer_load_dwordx4 a[156:159], v22, s[44:47], s14 offen sc1
    v_exp_f32 v134, v134
    v_exp_f32 v135, v135
    v_exp_f32 v136, v136
    v_exp_f32 v137, v137
    s_mov_b64 exec, s[6:7]
    buffer_load_dword v25, v20, s[48:51], s71 offen offset:384 sc1
    s_mov_b64 exec, -1
    v_exp_f32 v138, v138
    v_exp_f32 v139, v139
    v_pk_fma_f32 v[132:133], v[132:133], v[54:55], v[54:55] op_sel:[0,0,0] op_sel_hi:[1,0,0]
    v_pk_fma_f32 v[134:135], v[134:135], v[54:55], v[54:55] op_sel:[0,0,0] op_sel_hi:[1,0,0]
    v_pk_fma_f32 v[136:137], v[136:137], v[54:55], v[54:55] op_sel:[0,1,1] op_sel_hi:[1,1,1]
    v_pk_fma_f32 v[138:139], v[138:139], v[54:55], v[54:55] op_sel:[0,1,1] op_sel_hi:[1,1,1]
    v_rcp_f32 v132, v132
    v_rcp_f32 v133, v133
    v_rcp_f32 v134, v134
    s_add_u32 s14, s15, 16384
    v_rcp_f32 v135, v135
    buffer_load_dwordx4 a[160:163], v21, s[44:47], s14 offen sc1
    v_rcp_f32 v136, v136
    v_rcp_f32 v137, v137
    v_rcp_f32 v138, v138
    v_rcp_f32 v139, v139
    v_pk_mul_f32 v[160:161], v[152:153], v[160:161]
    v_pk_mul_f32 v[162:163], v[154:155], v[162:163]
    v_pk_mul_f32 v[164:165], v[156:157], v[164:165]
    v_pk_mul_f32 v[166:167], v[158:159], v[166:167]
    v_pk_mul_f32 v[160:161], v[160:161], v[132:133]
    v_pk_mul_f32 v[162:163], v[162:163], v[134:135]
    v_pk_mul_f32 v[164:165], v[164:165], v[136:137]
    v_pk_mul_f32 v[166:167], v[166:167], v[138:139]
    buffer_load_dwordx4 a[164:167], v22, s[44:47], s14 offen sc1
    v_cvt_pk_bf16_f32 v58, v160, v161
    v_cvt_pk_bf16_f32 v59, v162, v163
    v_cvt_pk_bf16_f32 v142, v164, v165
    v_cvt_pk_bf16_f32 v143, v166, v167
    s_add_u32 s14, s15, 20480
    buffer_load_dwordx4 a[168:171], v21, s[44:47], s14 offen sc1
    buffer_load_dwordx4 a[172:175], v22, s[44:47], s14 offen sc1
    s_waitcnt vmcnt(11)
    v_mfma_f32_16x16x32_bf16 v[68:71], a[208:211], a[128:131], 0
    s_add_u32 s14, s15, 24576
    ds_read_b64_tr_b16 a[232:233], v18 offset:24576
    ds_read_b64_tr_b16 a[234:235], v18 offset:4096
    v_mfma_f32_16x16x32_bf16 v[34:37], a[208:211], a[132:135], v[34:37]
    buffer_load_dwordx4 a[176:179], v21, s[44:47], s14 offen sc1
    v_mfma_f32_16x16x32_bf16 v[72:75], a[212:215], a[128:131], 0
    ds_read_b64_tr_b16 a[236:237], v19 offset:24576
    v_mfma_f32_16x16x32_bf16 v[38:41], a[212:215], a[132:135], v[38:41]
    ds_read_b64_tr_b16 a[238:239], v19 offset:4096
    v_mfma_f32_16x16x32_bf16 v[76:79], a[216:219], a[128:131], 0
    ds_read_b64_tr_b16 a[240:241], v180 offset:28672
    ds_read_b64_tr_b16 a[242:243], v15 offset:16384
    v_mfma_f32_16x16x32_bf16 v[42:45], a[216:219], a[132:135], v[42:45]
    buffer_load_dwordx4 a[180:183], v22, s[44:47], s14 offen sc1
    v_mfma_f32_16x16x32_bf16 v[80:83], a[220:223], a[128:131], 0
    ds_read_b64_tr_b16 a[244:245], v181 offset:28672
    ds_read_b64_tr_b16 a[246:247], v16 offset:16384
    v_mfma_f32_16x16x32_bf16 v[46:49], a[220:223], a[132:135], v[46:49]
    s_waitcnt vmcnt(11) lgkmcnt(4)
    v_mfma_f32_16x16x32_bf16 v[68:71], a[224:227], a[136:139], v[68:71]
    ds_read_b64_tr_b16 a[248:249], v182 offset:28672
    ds_read_b64_tr_b16 a[250:251], v18 offset:16384
    v_mfma_f32_16x16x32_bf16 v[34:37], a[224:227], a[140:143], v[34:37]
    buffer_load_dwordx4 a[184:187], v21, s[44:47], s57 offen sc1
    v_mfma_f32_16x16x32_bf16 v[72:75], a[228:231], a[136:139], v[72:75]
    ds_read_b64_tr_b16 a[252:253], v183 offset:28672
    v_mfma_f32_16x16x32_bf16 v[38:41], a[228:231], a[140:143], v[38:41]
    ds_read_b64_tr_b16 a[254:255], v19 offset:16384
    v_mfma_f32_16x16x32_bf16 v[76:79], a[232:235], a[136:139], v[76:79]
    ds_read_b64_tr_b16 a[208:209], v15 offset:20480
    ds_read_b64_tr_b16 a[210:211], v180 offset:4096
    v_mfma_f32_16x16x32_bf16 v[42:45], a[232:235], a[140:143], v[42:45]
    buffer_load_dwordx4 a[188:191], v22, s[44:47], s57 offen sc1
    buffer_store_dwordx4 v[56:59], v17, s[48:51], s12 offen nt
    buffer_store_dwordx4 v[140:143], v17, s[48:51], s12 offen offset:1024 nt
    v_mfma_f32_16x16x32_bf16 v[80:83], a[236:239], a[136:139], v[80:83]
    ds_read_b64_tr_b16 a[212:213], v16 offset:20480
    ds_read_b64_tr_b16 a[214:215], v181 offset:4096
    v_mfma_f32_16x16x32_bf16 v[46:49], a[236:239], a[140:143], v[46:49]
    s_waitcnt vmcnt(13) lgkmcnt(4)
    v_mfma_f32_16x16x32_bf16 v[68:71], a[240:243], a[144:147], v[68:71]
    ds_read_b64_tr_b16 a[216:217], v18 offset:20480
    v_mfma_f32_16x16x32_bf16 v[34:37], a[240:243], a[148:151], v[34:37]
    ds_read_b64_tr_b16 a[218:219], v182 offset:4096
    v_mfma_f32_16x16x32_bf16 v[72:75], a[244:247], a[144:147], v[72:75]
    ds_read_b64_tr_b16 a[220:221], v19 offset:20480
    v_mfma_f32_16x16x32_bf16 v[38:41], a[244:247], a[148:151], v[38:41]
    ds_read_b64_tr_b16 a[222:223], v183 offset:4096
    v_mfma_f32_16x16x32_bf16 v[76:79], a[248:251], a[144:147], v[76:79]
    ds_read_b64_tr_b16 a[224:225], v180 offset:8192
    v_mfma_f32_16x16x32_bf16 v[42:45], a[248:251], a[148:151], v[42:45]
    ds_read_b64_tr_b16 a[226:227], v180 offset:16384
    v_mfma_f32_16x16x32_bf16 v[80:83], a[252:255], a[144:147], v[80:83]
    ds_read_b64_tr_b16 a[228:229], v181 offset:8192
    ds_read_b64_tr_b16 a[230:231], v181 offset:16384
    v_mfma_f32_16x16x32_bf16 v[46:49], a[252:255], a[148:151], v[46:49]
    s_waitcnt vmcnt(10) lgkmcnt(4)
    v_cmp_eq_u32 vcc, 0, v25
    s_nop 0
    s_and_b64 vcc, vcc, s[6:7]
    s_cbranch_vccnz L_late6
L_back6:
    s_barrier
    v_mfma_f32_16x16x32_bf16 v[68:71], a[208:211], a[152:155], v[68:71]
    s_add_u32 s14, s16, 262144
    ds_read_b64_tr_b16 a[232:233], v182 offset:8192
    ds_read_b64_tr_b16 a[234:235], v182 offset:16384
    v_mfma_f32_16x16x32_bf16 v[34:37], a[208:211], a[156:159], v[34:37]
    buffer_load_dwordx4 a[192:195], v21, s[48:51], s14 offen sc1
    v_mfma_f32_16x16x32_bf16 v[72:75], a[212:215], a[152:155], v[72:75]
    ds_read_b64_tr_b16 a[236:237], v183 offset:8192
    ds_read_b64_tr_b16 a[238:239], v183 offset:16384
    v_mfma_f32_16x16x32_bf16 v[38:41], a[212:215], a[156:159], v[38:41]
    buffer_load_dwordx4 a[196:199], v22, s[48:51], s14 offen sc1
    v_mfma_f32_16x16x32_bf16 v[76:79], a[216:219], a[152:155], v[76:79]
    ds_read_b64_tr_b16 a[240:241], v180 offset:20480
    v_mfma_f32_16x16x32_bf16 v[42:45], a[216:219], a[156:159], v[42:45]
    ds_read_b64_tr_b16 a[242:243], v15 offset:28672
    v_mfma_f32_16x16x32_bf16 v[80:83], a[220:223], a[152:155], v[80:83]
    ds_read_b64_tr_b16 a[244:245], v181 offset:20480
    ds_read_b64_tr_b16 a[246:247], v16 offset:28672
    v_mfma_f32_16x16x32_bf16 v[46:49], a[220:223], a[156:159], v[46:49]
    s_waitcnt vmcnt(10) lgkmcnt(4)
    v_mfma_f32_16x16x32_bf16 v[68:71], a[224:227], a[160:163], v[68:71]
    s_add_u32 s14, s16, 266240
    ds_read_b64_tr_b16 a[248:249], v182 offset:20480
    ds_read_b64_tr_b16 a[250:251], v18 offset:28672
    v_mfma_f32_16x16x32_bf16 v[34:37], a[224:227], a[164:167], v[34:37]
    buffer_load_dwordx4 a[200:203], v21, s[48:51], s14 offen sc1
    v_mfma_f32_16x16x32_bf16 v[72:75], a[228:231], a[160:163], v[72:75]
    ds_read_b64_tr_b16 a[252:253], v183 offset:20480
    v_mfma_f32_16x16x32_bf16 v[38:41], a[228:231], a[164:167], v[38:41]
    ds_read_b64_tr_b16 a[254:255], v19 offset:28672
    v_mfma_f32_16x16x32_bf16 v[76:79], a[232:235], a[160:163], v[76:79]
    ds_read_b64_tr_b16 a[208:209], v15 offset:0
    ds_read_b64_tr_b16 a[210:211], v15 offset:8192
    v_mfma_f32_16x16x32_bf16 v[42:45], a[232:235], a[164:167], v[42:45]
    buffer_load_dwordx4 a[204:207], v22, s[48:51], s14 offen sc1
    v_mfma_f32_16x16x32_bf16 v[80:83], a[236:239], a[160:163], v[80:83]
    ds_read_b64_tr_b16 a[212:213], v16 offset:0
    ds_read_b64_tr_b16 a[214:215], v16 offset:8192
    v_mfma_f32_16x16x32_bf16 v[46:49], a[236:239], a[164:167], v[46:49]
    s_waitcnt vmcnt(10) lgkmcnt(4)
    v_mfma_f32_16x16x32_bf16 v[68:71], a[240:243], a[168:171], v[68:71]
    s_add_u32 s14, s16, 270336
    ds_read_b64_tr_b16 a[216:217], v18 offset:0
    ds_read_b64_tr_b16 a[218:219], v18 offset:8192
    v_mfma_f32_16x16x32_bf16 v[34:37], a[240:243], a[172:175], v[34:37]
    buffer_load_dwordx4 a[8:11], v21, s[48:51], s14 offen sc1
    v_mfma_f32_16x16x32_bf16 v[72:75], a[244:247], a[168:171], v[72:75]
    ds_read_b64_tr_b16 a[220:221], v19 offset:0
    v_mfma_f32_16x16x32_bf16 v[38:41], a[244:247], a[172:175], v[38:41]
    ds_read_b64_tr_b16 a[222:223], v19 offset:8192
    v_mfma_f32_16x16x32_bf16 v[76:79], a[248:251], a[168:171], v[76:79]
    ds_read_b64_tr_b16 a[224:225], v15 offset:12288
    ds_read_b64_tr_b16 a[226:227], v180 offset:32768
    v_mfma_f32_16x16x32_bf16 v[42:45], a[248:251], a[172:175], v[42:45]
    buffer_load_dwordx4 a[12:15], v22, s[48:51], s14 offen sc1
    v_mfma_f32_16x16x32_bf16 v[80:83], a[252:255], a[168:171], v[80:83]
    ds_read_b64_tr_b16 a[228:229], v16 offset:12288
    ds_read_b64_tr_b16 a[230:231], v181 offset:32768
    v_mfma_f32_16x16x32_bf16 v[46:49], a[252:255], a[172:175], v[46:49]
    s_waitcnt vmcnt(10) lgkmcnt(4)
    v_mfma_f32_16x16x32_bf16 v[68:71], a[208:211], a[176:179], v[68:71]
    s_add_u32 s14, s16, 274432
    ds_read_b64_tr_b16 a[232:233], v18 offset:12288
    ds_read_b64_tr_b16 a[234:235], v182 offset:32768
    v_mfma_f32_16x16x32_bf16 v[34:37], a[208:211], a[180:183], v[34:37]
    buffer_load_dwordx4 a[24:27], v21, s[48:51], s14 offen sc1
    v_mfma_f32_16x16x32_bf16 v[72:75], a[212:215], a[176:179], v[72:75]
    ds_read_b64_tr_b16 a[236:237], v19 offset:12288
    v_mfma_f32_16x16x32_bf16 v[38:41], a[212:215], a[180:183], v[38:41]
    ds_read_b64_tr_b16 a[238:239], v183 offset:32768
    v_mfma_f32_16x16x32_bf16 v[76:79], a[216:219], a[176:179], v[76:79]
    ds_read_b64_tr_b16 a[240:241], v180 offset:36864
    ds_read_b64_tr_b16 a[242:243], v180 offset:40960
    v_mfma_f32_16x16x32_bf16 v[42:45], a[216:219], a[180:183], v[42:45]
    buffer_load_dwordx4 a[28:31], v22, s[48:51], s14 offen sc1
    s_waitcnt vmcnt(8)
    s_barrier
    v_mfma_f32_16x16x32_bf16 v[80:83], a[220:223], a[176:179], v[80:83]
    ds_read_b64_tr_b16 a[244:245], v181 offset:36864
    ds_read_b64_tr_b16 a[246:247], v181 offset:40960
    v_mfma_f32_16x16x32_bf16 v[46:49], a[220:223], a[180:183], v[46:49]
    s_waitcnt lgkmcnt(4)
    s_mov_b64 exec, s[4:5]
    buffer_store_dword v2, off, s[48:51], s79 offset:512
    s_mov_b64 exec, -1
    v_mfma_f32_16x16x32_bf16 v[68:71], a[224:227], a[184:187], v[68:71]
    s_add_u32 m0, s66, 32768
    ds_read_b64_tr_b16 a[248:249], v182 offset:36864
    ds_read_b64_tr_b16 a[250:251], v182 offset:40960
    v_mfma_f32_16x16x32_bf16 v[34:37], a[224:227], a[188:191], v[34:37]
    buffer_load_dwordx4 v65, s[40:43], s52 offen lds
    v_mfma_f32_16x16x32_bf16 v[72:75], a[228:231], a[184:187], v[72:75]
    ds_read_b64_tr_b16 a[252:253], v183 offset:36864
    v_mfma_f32_16x16x32_bf16 v[38:41], a[228:231], a[188:191], v[38:41]
    ds_read_b64_tr_b16 a[254:255], v183 offset:40960
    v_mfma_f32_16x16x32_bf16 v[76:79], a[232:235], a[184:187], v[76:79]
    s_add_u32 s14, s16, 278528
    ds_read_b64_tr_b16 a[208:209], v180 offset:45056
    ds_read_b64_tr_b16 a[210:211], v180 offset:49152
    v_mfma_f32_16x16x32_bf16 v[42:45], a[232:235], a[188:191], v[42:45]
    buffer_load_dwordx4 a[40:43], v21, s[48:51], s14 offen sc1
    v_mfma_f32_16x16x32_bf16 v[80:83], a[236:239], a[184:187], v[80:83]
    ds_read_b64_tr_b16 a[212:213], v181 offset:45056
    ds_read_b64_tr_b16 a[214:215], v181 offset:49152
    v_mfma_f32_16x16x32_bf16 v[46:49], a[236:239], a[188:191], v[46:49]
    s_waitcnt lgkmcnt(4)
    buffer_load_dwordx4 a[44:47], v22, s[48:51], s14 offen sc1
    s_add_u32 m0, s66, 40960
    s_nop 0
    buffer_load_dwordx4 v66, s[40:43], s52 offen lds
    s_waitcnt vmcnt(11)
    v_mfma_f32_16x16x32_bf16 v[68:71], a[240:243], a[192:195], v[68:71]
    s_add_u32 m0, s66, 45056
    ds_read_b64_tr_b16 a[216:217], v182 offset:45056
    ds_read_b64_tr_b16 a[218:219], v182 offset:49152
    v_mfma_f32_16x16x32_bf16 v[34:37], a[240:243], a[196:199], v[34:37]
    buffer_load_dwordx4 v67, s[40:43], s52 offen lds
    v_mfma_f32_16x16x32_bf16 v[72:75], a[244:247], a[192:195], v[72:75]
    ds_read_b64_tr_b16 a[220:221], v183 offset:45056
    v_mfma_f32_16x16x32_bf16 v[38:41], a[244:247], a[196:199], v[38:41]
    ds_read_b64_tr_b16 a[222:223], v183 offset:49152
    v_mfma_f32_16x16x32_bf16 v[76:79], a[248:251], a[192:195], v[76:79]
    s_add_u32 s14, s16, 282624
    ds_read_b64_tr_b16 a[224:225], v180 offset:53248
    ds_read_b64_tr_b16 a[226:227], v180 offset:57344
    v_mfma_f32_16x16x32_bf16 v[42:45], a[248:251], a[196:199], v[42:45]
    buffer_load_dwordx4 a[56:59], v21, s[48:51], s14 offen sc1
    v_mfma_f32_16x16x32_bf16 v[80:83], a[252:255], a[192:195], v[80:83]
    ds_read_b64_tr_b16 a[228:229], v181 offset:53248
    ds_read_b64_tr_b16 a[230:231], v181 offset:57344
    v_mfma_f32_16x16x32_bf16 v[46:49], a[252:255], a[196:199], v[46:49]
    s_waitcnt vmcnt(11) lgkmcnt(4)
    v_mfma_f32_16x16x32_bf16 v[68:71], a[208:211], a[200:203], v[68:71]
    ds_read_b64_tr_b16 a[232:233], v182 offset:53248
    ds_read_b64_tr_b16 a[234:235], v182 offset:57344
    v_mfma_f32_16x16x32_bf16 v[34:37], a[208:211], a[204:207], v[34:37]
    buffer_load_dwordx4 a[60:63], v22, s[48:51], s14 offen sc1
    v_mfma_f32_16x16x32_bf16 v[72:75], a[212:215], a[200:203], v[72:75]
    ds_read_b64_tr_b16 a[236:237], v183 offset:53248
    ds_read_b64_tr_b16 a[238:239], v183 offset:57344
    v_mfma_f32_16x16x32_bf16 v[38:41], a[212:215], a[204:207], v[38:41]
    v_add_u32 v184, 131072, v15
    v_mfma_f32_16x16x32_bf16 v[76:79], a[216:219], a[200:203], v[76:79]
    s_addk_i32 m0, 8192
    s_add_u32 s52, s55, 786432
    ds_read_b64_tr_b16 a[240:241], v180 offset:61440
    ds_read_b64_tr_b16 a[242:243], v184 offset:0
    v_mfma_f32_16x16x32_bf16 v[42:45], a[216:219], a[204:207], v[42:45]
    buffer_load_dwordx4 v64, s[40:43], s52 offen lds
    v_add_u32 v185, 131072, v16
    v_mfma_f32_16x16x32_bf16 v[80:83], a[220:223], a[200:203], v[80:83]
    ds_read_b64_tr_b16 a[244:245], v181 offset:61440
    ds_read_b64_tr_b16 a[246:247], v185 offset:0
    v_mfma_f32_16x16x32_bf16 v[46:49], a[220:223], a[204:207], v[46:49]
    s_waitcnt lgkmcnt(4)
    v_add_u32 v186, 131072, v18
    s_waitcnt vmcnt(11)
    v_mfma_f32_16x16x32_bf16 v[68:71], a[224:227], a[8:11], v[68:71]
    s_add_u32 m0, s66, 57344
    ds_read_b64_tr_b16 a[248:249], v182 offset:61440
    ds_read_b64_tr_b16 a[250:251], v186 offset:0
    v_mfma_f32_16x16x32_bf16 v[34:37], a[224:227], a[12:15], v[34:37]
    buffer_load_dwordx4 v65, s[40:43], s52 offen lds
    v_add_u32 v187, 131072, v19
    v_mfma_f32_16x16x32_bf16 v[72:75], a[228:231], a[8:11], v[72:75]
    ds_read_b64_tr_b16 a[252:253], v183 offset:61440
    v_mfma_f32_16x16x32_bf16 v[38:41], a[228:231], a[12:15], v[38:41]
    ds_read_b64_tr_b16 a[254:255], v187 offset:0
    v_mfma_f32_16x16x32_bf16 v[76:79], a[232:235], a[8:11], v[76:79]
    s_add_u32 s14, s16, 286720
    ds_read_b64_tr_b16 a[208:209], v184 offset:4096
    ds_read_b64_tr_b16 a[210:211], v184 offset:8192
    v_mfma_f32_16x16x32_bf16 v[42:45], a[232:235], a[12:15], v[42:45]
    buffer_load_dwordx4 a[72:75], v21, s[48:51], s14 offen sc1
    v_mfma_f32_16x16x32_bf16 v[80:83], a[236:239], a[8:11], v[80:83]
    ds_read_b64_tr_b16 a[212:213], v185 offset:4096
    ds_read_b64_tr_b16 a[214:215], v185 offset:8192
    v_mfma_f32_16x16x32_bf16 v[46:49], a[236:239], a[12:15], v[46:49]
    s_waitcnt lgkmcnt(4)
    s_mov_b64 exec, s[6:7]
    buffer_load_dword v3, v20, s[48:51], s71 offen offset:512 sc1
    s_mov_b64 exec, -1
    s_waitcnt vmcnt(12)
    v_mfma_f32_16x16x32_bf16 v[68:71], a[240:243], a[24:27], v[68:71]
    ds_read_b64_tr_b16 a[216:217], v186 offset:4096
    ds_read_b64_tr_b16 a[218:219], v186 offset:8192
    v_mfma_f32_16x16x32_bf16 v[34:37], a[240:243], a[28:31], v[34:37]
    buffer_load_dwordx4 a[76:79], v22, s[48:51], s14 offen sc1
    v_mfma_f32_16x16x32_bf16 v[72:75], a[244:247], a[24:27], v[72:75]
    ds_read_b64_tr_b16 a[220:221], v187 offset:4096
    v_mfma_f32_16x16x32_bf16 v[38:41], a[244:247], a[28:31], v[38:41]
    ds_read_b64_tr_b16 a[222:223], v187 offset:8192
    v_mfma_f32_16x16x32_bf16 v[76:79], a[248:251], a[24:27], v[76:79]
    ds_read_b64_tr_b16 a[224:225], v184 offset:12288
    v_mfma_f32_16x16x32_bf16 v[42:45], a[248:251], a[28:31], v[42:45]
    ds_read_b64_tr_b16 a[226:227], v184 offset:16384
    v_mfma_f32_16x16x32_bf16 v[80:83], a[252:255], a[24:27], v[80:83]
    s_add_u32 m0, s66, 77824
    ds_read_b64_tr_b16 a[228:229], v185 offset:12288
    ds_read_b64_tr_b16 a[230:231], v185 offset:16384
    v_mfma_f32_16x16x32_bf16 v[46:49], a[252:255], a[28:31], v[46:49]
    s_waitcnt lgkmcnt(4)
    buffer_load_dwordx4 v66, s[40:43], s52 offen lds
    s_add_u32 m0, s66, 24576
    s_nop 0
    buffer_load_dwordx4 v67, s[40:43], s52 offen lds
    s_waitcnt vmcnt(11)
    v_mfma_f32_16x16x32_bf16 v[68:71], a[208:211], a[40:43], v[68:71]
    s_addk_i32 m0, -20480
    s_add_u32 s52, s55, 1179648
    ds_read_b64_tr_b16 a[232:233], v186 offset:12288
    ds_read_b64_tr_b16 a[234:235], v186 offset:16384
    v_mfma_f32_16x16x32_bf16 v[34:37], a[208:211], a[44:47], v[34:37]
    buffer_load_dwordx4 v64, s[40:43], s52 offen lds
    v_mfma_f32_16x16x32_bf16 v[72:75], a[212:215], a[40:43], v[72:75]
    ds_read_b64_tr_b16 a[236:237], v187 offset:12288
    v_mfma_f32_16x16x32_bf16 v[38:41], a[212:215], a[44:47], v[38:41]
    ds_read_b64_tr_b16 a[238:239], v187 offset:16384
    v_mfma_f32_16x16x32_bf16 v[76:79], a[216:219], a[40:43], v[76:79]
    s_add_u32 m0, s66, 94208
    ds_read_b64_tr_b16 a[240:241], v184 offset:20480
    ds_read_b64_tr_b16 a[242:243], v184 offset:24576
    v_mfma_f32_16x16x32_bf16 v[42:45], a[216:219], a[44:47], v[42:45]
    buffer_load_dwordx4 v65, s[40:43], s52 offen lds
    v_mfma_f32_16x16x32_bf16 v[80:83], a[220:223], a[40:43], v[80:83]
    ds_read_b64_tr_b16 a[244:245], v185 offset:20480
    ds_read_b64_tr_b16 a[246:247], v185 offset:24576
    v_mfma_f32_16x16x32_bf16 v[46:49], a[220:223], a[44:47], v[46:49]
    s_waitcnt vmcnt(9) lgkmcnt(4)
    v_mfma_f32_16x16x32_bf16 v[68:71], a[224:227], a[56:59], v[68:71]
    ds_read_b64_tr_b16 a[248:249], v186 offset:20480
    v_mfma_f32_16x16x32_bf16 v[34:37], a[224:227], a[60:63], v[34:37]
    ds_read_b64_tr_b16 a[250:251], v186 offset:24576
    v_mfma_f32_16x16x32_bf16 v[72:75], a[228:231], a[56:59], v[72:75]
    ds_read_b64_tr_b16 a[252:253], v187 offset:20480
    v_mfma_f32_16x16x32_bf16 v[38:41], a[228:231], a[60:63], v[38:41]
    ds_read_b64_tr_b16 a[254:255], v187 offset:24576
    v_mfma_f32_16x16x32_bf16 v[76:79], a[232:235], a[56:59], v[76:79]
    ds_read_b64_tr_b16 a[208:209], v15 offset:36864
    v_mfma_f32_16x16x32_bf16 v[42:45], a[232:235], a[60:63], v[42:45]
    ds_read_b64_tr_b16 a[210:211], v15 offset:49152
    v_mfma_f32_16x16x32_bf16 v[80:83], a[236:239], a[56:59], v[80:83]
    ds_read_b64_tr_b16 a[212:213], v16 offset:36864
    ds_read_b64_tr_b16 a[214:215], v16 offset:49152
    v_mfma_f32_16x16x32_bf16 v[46:49], a[236:239], a[60:63], v[46:49]
    s_waitcnt vmcnt(5) lgkmcnt(4)
    v_cmp_eq_u32 vcc, 0, v3
    s_nop 0
L_vis_v1_2:
    s_cbranch_execz L_ret_v1
    s_and_b64 vcc, vcc, s[6:7]
    s_cbranch_vccnz L_late8
L_back8:
    s_barrier
    s_add_u32 s14, s16, 0
    buffer_load_dwordx4 a[88:91], v21, s[48:51], s14 offen sc1
    buffer_load_dwordx4 a[92:95], v22, s[48:51], s14 offen sc1
    s_add_u32 s14, s16, 4096
    buffer_load_dwordx4 a[104:107], v21, s[48:51], s14 offen sc1
    buffer_load_dwordx4 a[108:111], v22, s[48:51], s14 offen sc1
    s_lshl2_add_u32 s67, s66, 98304
    v_add_u32 v4, s67, v17
    s_xor_b32 s68, s66, 1024
    s_lshl2_add_u32 s68, s68, 98304
    v_add_u32_e64 v5, s68, v17
    s_add_u32 s67, s76, 114688
    v_add_u32 v171, s67, v17
    v_lshrrev_b32 v63, 1, v32
    v_and_b32 v168, 7, v1
    v_xor_b32 v63, v63, v168
    v_lshlrev_b32_e64 v63, 4, v63
    v_lshl_add_u32 v63, v31, 7, v63
    v_lshrrev_b32 v6, 3, v1
    v_xor_b32 v168, v168, v6
    v_lshlrev_b32 v168, 4, v168
    v_lshl_add_u32 v6, v6, 10, v168
    v_and_b32 v168, 1, v32
    v_lshlrev_b32 v168, 3, v168
    s_waitcnt vmcnt(8)
    v_mfma_f32_16x16x32_bf16 v[68:71], a[240:243], a[72:75], v[68:71]
    s_add_u32 s14, s16, 8192
    ds_read_b64_tr_b16 a[216:217], v18 offset:36864
    ds_read_b64_tr_b16 a[218:219], v18 offset:49152
    v_mfma_f32_16x16x32_bf16 v[34:37], a[240:243], a[76:79], v[34:37]
    buffer_load_dwordx4 a[120:123], v21, s[48:51], s14 offen sc1
    v_add3_u32 v63, v63, v168, s67
    v_mfma_f32_16x16x32_bf16 v[72:75], a[244:247], a[72:75], v[72:75]
    ds_read_b64_tr_b16 a[220:221], v19 offset:36864
    ds_read_b64_tr_b16 a[222:223], v19 offset:49152
    v_mfma_f32_16x16x32_bf16 v[38:41], a[244:247], a[76:79], v[38:41]
    v_xor_b32_e64 v168, 32, v63
    v_xor_b32_e64 v169, 64, v63
    v_mfma_f32_16x16x32_bf16 v[76:79], a[248:251], a[72:75], v[76:79]
    ds_read_b64_tr_b16 a[224:225], v15 offset:61440
    ds_read_b64_tr_b16 a[226:227], v180 offset:0
    v_mfma_f32_16x16x32_bf16 v[42:45], a[248:251], a[76:79], v[42:45]
    buffer_load_dwordx4 a[124:127], v22, s[48:51], s14 offen sc1
    v_xor_b32 v170, 96, v63
    v_mfma_f32_16x16x32_bf16 v[80:83], a[252:255], a[72:75], v[80:83]
    ds_read_b64_tr_b16 a[228:229], v16 offset:61440
    ds_read_b64_tr_b16 a[230:231], v181 offset:0
    v_mfma_f32_16x16x32_bf16 v[46:49], a[252:255], a[76:79], v[46:49]
    s_waitcnt lgkmcnt(4)
    s_lshl2_add_u32 s67, s65, s60
    s_lshl_b32 s67, s67, 14
    s_add_u32 s67, s67, s78
    s_add_u32 s68, s67, 8192
    s_add_u32 s14, s16, 12288
    buffer_load_dwordx4 a[0:3], v21, s[48:51], s14 offen sc1
    buffer_load_dwordx4 a[4:7], v22, s[48:51], s14 offen sc1
    s_add_u32 s14, s16, 16384
    buffer_load_dwordx4 a[16:19], v21, s[48:51], s14 offen sc1
    buffer_load_dwordx4 a[20:23], v22, s[48:51], s14 offen sc1
    s_waitcnt vmcnt(8)
    v_mfma_f32_16x16x32_bf16 v[68:71], a[208:211], a[88:91], v[68:71]
    s_add_u32 s14, s16, 20480
    ds_read_b64_tr_b16 a[232:233], v18 offset:61440
    ds_read_b64_tr_b16 a[234:235], v182 offset:0
    v_mfma_f32_16x16x32_bf16 v[34:37], a[208:211], a[92:95], v[34:37]
    buffer_load_dwordx4 a[32:35], v21, s[48:51], s14 offen sc1
    v_mfma_f32_16x16x32_bf16 v[72:75], a[212:215], a[88:91], v[72:75]
    ds_read_b64_tr_b16 a[236:237], v19 offset:61440
    v_mfma_f32_16x16x32_bf16 v[38:41], a[212:215], a[92:95], v[38:41]
    ds_read_b64_tr_b16 a[238:239], v183 offset:0
    v_mfma_f32_16x16x32_bf16 v[76:79], a[216:219], a[88:91], v[76:79]
    ds_read_b64_tr_b16 a[240:241], v180 offset:24576
    ds_read_b64_tr_b16 a[242:243], v15 offset:32768
    v_mfma_f32_16x16x32_bf16 v[42:45], a[216:219], a[92:95], v[42:45]
    buffer_load_dwordx4 a[36:39], v22, s[48:51], s14 offen sc1
    v_mfma_f32_16x16x32_bf16 v[80:83], a[220:223], a[88:91], v[80:83]
    ds_read_b64_tr_b16 a[244:245], v181 offset:24576
    ds_read_b64_tr_b16 a[246:247], v16 offset:32768
    v_mfma_f32_16x16x32_bf16 v[46:49], a[220:223], a[92:95], v[46:49]
    s_waitcnt vmcnt(8) lgkmcnt(4)
    v_mfma_f32_16x16x32_bf16 v[68:71], a[224:227], a[104:107], v[68:71]
    s_add_u32 s14, s16, 24576
    ds_read_b64_tr_b16 a[248:249], v182 offset:24576
    ds_read_b64_tr_b16 a[250:251], v18 offset:32768
    v_mfma_f32_16x16x32_bf16 v[34:37], a[224:227], a[108:111], v[34:37]
    buffer_load_dwordx4 a[48:51], v21, s[48:51], s14 offen sc1
    v_mfma_f32_16x16x32_bf16 v[72:75], a[228:231], a[104:107], v[72:75]
    ds_read_b64_tr_b16 a[252:253], v183 offset:24576
    v_mfma_f32_16x16x32_bf16 v[38:41], a[228:231], a[108:111], v[38:41]
    ds_read_b64_tr_b16 a[254:255], v19 offset:32768
    v_mfma_f32_16x16x32_bf16 v[76:79], a[232:235], a[104:107], v[76:79]
    ds_read_b64_tr_b16 a[208:209], v15 offset:40960
    ds_read_b64_tr_b16 a[210:211], v15 offset:45056
    v_mfma_f32_16x16x32_bf16 v[42:45], a[232:235], a[108:111], v[42:45]
    buffer_load_dwordx4 a[52:55], v22, s[48:51], s14 offen sc1
    v_mfma_f32_16x16x32_bf16 v[80:83], a[236:239], a[104:107], v[80:83]
    ds_read_b64_tr_b16 a[212:213], v16 offset:40960
    ds_read_b64_tr_b16 a[214:215], v16 offset:45056
    v_mfma_f32_16x16x32_bf16 v[46:49], a[236:239], a[108:111], v[46:49]
    s_waitcnt vmcnt(8) lgkmcnt(4)
    v_mfma_f32_16x16x32_bf16 v[68:71], a[240:243], a[120:123], v[68:71]
    ds_read_b64_tr_b16 a[216:217], v18 offset:40960
    v_mfma_f32_16x16x32_bf16 v[34:37], a[240:243], a[124:127], v[34:37]
    ds_read_b64_tr_b16 a[218:219], v18 offset:45056
    v_mfma_f32_16x16x32_bf16 v[72:75], a[244:247], a[120:123], v[72:75]
    ds_read_b64_tr_b16 a[220:221], v19 offset:40960
    ds_read_b64_tr_b16 a[222:223], v19 offset:45056
    v_mfma_f32_16x16x32_bf16 v[38:41], a[244:247], a[124:127], v[38:41]
    s_barrier
    v_mfma_f32_16x16x32_bf16 v[76:79], a[248:251], a[120:123], v[76:79]
    ds_read_b64_tr_b16 a[224:225], v15 offset:53248
    v_mfma_f32_16x16x32_bf16 v[42:45], a[248:251], a[124:127], v[42:45]
    ds_read_b64_tr_b16 a[226:227], v15 offset:57344
    v_mfma_f32_16x16x32_bf16 v[80:83], a[252:255], a[120:123], v[80:83]
    ds_read_b64_tr_b16 a[228:229], v16 offset:53248
    ds_read_b64_tr_b16 a[230:231], v16 offset:57344
    v_mfma_f32_16x16x32_bf16 v[46:49], a[252:255], a[124:127], v[46:49]
    s_waitcnt vmcnt(6) lgkmcnt(4)
    v_mfma_f32_16x16x32_bf16 v[68:71], a[208:211], a[0:3], v[68:71]
    ds_read_b64_tr_b16 a[232:233], v18 offset:53248
    v_mfma_f32_16x16x32_bf16 v[34:37], a[208:211], a[4:7], v[34:37]
    ds_read_b64_tr_b16 a[234:235], v18 offset:57344
    v_mfma_f32_16x16x32_bf16 v[72:75], a[212:215], a[0:3], v[72:75]
    ds_read_b64_tr_b16 a[236:237], v19 offset:53248
    v_mfma_f32_16x16x32_bf16 v[38:41], a[212:215], a[4:7], v[38:41]
    ds_read_b64_tr_b16 a[238:239], v19 offset:57344
    v_mfma_f32_16x16x32_bf16 v[76:79], a[216:219], a[0:3], v[76:79]
    ds_read_b64_tr_b16 a[240:241], v180 offset:12288
    v_mfma_f32_16x16x32_bf16 v[42:45], a[216:219], a[4:7], v[42:45]
    ds_read_b64_tr_b16 a[242:243], v15 offset:24576
    v_mfma_f32_16x16x32_bf16 v[80:83], a[220:223], a[0:3], v[80:83]
    ds_read_b64_tr_b16 a[244:245], v181 offset:12288
    ds_read_b64_tr_b16 a[246:247], v16 offset:24576
    v_mfma_f32_16x16x32_bf16 v[46:49], a[220:223], a[4:7], v[46:49]
    s_waitcnt vmcnt(4) lgkmcnt(4)
    v_mfma_f32_16x16x32_bf16 v[68:71], a[224:227], a[16:19], v[68:71]
    ds_read_b64_tr_b16 a[248:249], v182 offset:12288
    v_mfma_f32_16x16x32_bf16 v[34:37], a[224:227], a[20:23], v[34:37]
    ds_read_b64_tr_b16 a[250:251], v18 offset:24576
    v_mfma_f32_16x16x32_bf16 v[72:75], a[228:231], a[16:19], v[72:75]
    ds_read_b64_tr_b16 a[252:253], v183 offset:12288
    v_mfma_f32_16x16x32_bf16 v[38:41], a[228:231], a[20:23], v[38:41]
    ds_read_b64_tr_b16 a[254:255], v19 offset:24576
    v_mfma_f32_16x16x32_bf16 v[76:79], a[232:235], a[16:19], v[76:79]
    ds_read_b64_tr_b16 a[208:209], v15 offset:4096
    v_mfma_f32_16x16x32_bf16 v[42:45], a[232:235], a[20:23], v[42:45]
    ds_read_b64_tr_b16 a[210:211], v180 offset:28672
    v_mfma_f32_16x16x32_bf16 v[80:83], a[236:239], a[16:19], v[80:83]
    ds_read_b64_tr_b16 a[212:213], v16 offset:4096
    ds_read_b64_tr_b16 a[214:215], v181 offset:28672
    v_mfma_f32_16x16x32_bf16 v[46:49], a[236:239], a[20:23], v[46:49]
    s_waitcnt vmcnt(3) lgkmcnt(4)
    v_mfma_f32_16x16x32_bf16 v[68:71], a[240:243], a[32:35], v[68:71]
    ds_read_b64_tr_b16 a[216:217], v18 offset:4096
    v_mfma_f32_16x16x32_bf16 v[72:75], a[244:247], a[32:35], v[72:75]
    ds_read_b64_tr_b16 a[218:219], v182 offset:28672
    v_mfma_f32_16x16x32_bf16 v[76:79], a[248:251], a[32:35], v[76:79]
    ds_read_b64_tr_b16 a[220:221], v19 offset:4096
    ds_read_b64_tr_b16 a[222:223], v183 offset:28672
    v_mfma_f32_16x16x32_bf16 v[80:83], a[252:255], a[32:35], v[80:83]
    s_waitcnt vmcnt(1) lgkmcnt(6)
    v_mfma_f32_16x16x32_bf16 v[68:71], a[208:211], a[48:51], v[68:71]
    s_waitcnt lgkmcnt(4)
    v_mfma_f32_16x16x32_bf16 v[72:75], a[212:215], a[48:51], v[72:75]
    s_waitcnt lgkmcnt(2)
    v_mfma_f32_16x16x32_bf16 v[76:79], a[216:219], a[48:51], v[76:79]
    s_waitcnt lgkmcnt(0)
    v_mfma_f32_16x16x32_bf16 v[80:83], a[220:223], a[48:51], v[80:83]
    v_mfma_f32_16x16x32_bf16 v[34:37], a[240:243], a[36:39], v[34:37]
    v_mfma_f32_16x16x32_bf16 v[38:41], a[244:247], a[36:39], v[38:41]
    ds_write_b128 v4, v[68:71] offset:0
    v_mfma_f32_16x16x32_bf16 v[42:45], a[248:251], a[36:39], v[42:45]
    ds_write_b128 v4, v[72:75] offset:1024
    v_mfma_f32_16x16x32_bf16 v[46:49], a[252:255], a[36:39], v[46:49]
    ds_write_b128 v4, v[76:79] offset:2048
    s_waitcnt vmcnt(0)
    v_mfma_f32_16x16x32_bf16 v[34:37], a[208:211], a[52:55], v[34:37]
    ds_write_b128 v4, v[80:83] offset:3072
    v_mfma_f32_16x16x32_bf16 v[38:41], a[212:215], a[52:55], v[38:41]
    v_mfma_f32_16x16x32_bf16 v[42:45], a[216:219], a[52:55], v[42:45]
    v_mfma_f32_16x16x32_bf16 v[46:49], a[220:223], a[52:55], v[46:49]
    s_waitcnt lgkmcnt(0)
    s_barrier
    ds_read_b128 v[84:87], v5 offset:0
    ds_read_b128 v[88:91], v5 offset:1024
    ds_read_b128 v[92:95], v5 offset:2048
    ds_read_b128 v[96:99], v5 offset:3072
    s_waitcnt lgkmcnt(3)
    v_pk_add_f32 v[34:35], v[34:35], v[84:85]
    v_pk_add_f32 v[36:37], v[36:37], v[86:87]
    v_cvt_pk_bf16_f32 v132, v34, v35
    v_cvt_pk_bf16_f32 v133, v36, v37
    ds_write_b64 v63, v[132:133]
    s_waitcnt lgkmcnt(3)
    v_pk_add_f32 v[38:39], v[38:39], v[88:89]
    v_pk_add_f32 v[40:41], v[40:41], v[90:91]
    v_cvt_pk_bf16_f32 v134, v38, v39
    v_cvt_pk_bf16_f32 v135, v40, v41
    ds_write_b64 v168, v[134:135]
    s_waitcnt lgkmcnt(3)
    v_pk_add_f32 v[42:43], v[42:43], v[92:93]
    v_pk_add_f32 v[44:45], v[44:45], v[94:95]
    v_cvt_pk_bf16_f32 v136, v42, v43
    v_cvt_pk_bf16_f32 v137, v44, v45
    ds_write_b64 v169, v[136:137]
    s_waitcnt lgkmcnt(3)
    v_pk_add_f32 v[46:47], v[46:47], v[96:97]
    v_pk_add_f32 v[48:49], v[48:49], v[98:99]
    v_cvt_pk_bf16_f32 v138, v46, v47
    v_cvt_pk_bf16_f32 v139, v48, v49
    ds_write_b64 v170, v[138:139]
    ds_read_b128 v[56:59], v171 offset:0
    ds_read_b128 v[140:143], v171 offset:1024
    s_waitcnt lgkmcnt(1)
    buffer_store_dwordx4 v[56:59], v6, s[44:47], s67 offen nt
    s_waitcnt lgkmcnt(0)
    buffer_store_dwordx4 v[140:143], v6, s[44:47], s68 offen nt
L_main_end:
    s_endpgm
L_notfast:
    s_mov_b32 s68, 0x8000
L_cen_loop:
    global_load_dword v7, v50, s[20:21] sc1
    s_waitcnt vmcnt(0)
    v_and_b32 v8, 16, v7
    v_readlane_b32 s82, v7, s64
    v_cmp_eq_u32 vcc, 0, v8
    s_sub_u32 s68, s68, 1
    s_cbranch_scc1 L_cen_done
    s_cbranch_vccnz L_cen_loop
L_cen_done:
    s_cmp_eq_u32 s3, s82
    s_cbranch_scc1 L_mode_ok
    s_mov_b32 s0, 1
    v_mov_b32 v50, s90
    s_add_u32 s71, s71, 2048
    s_add_u32 s79, s79, 2048
    s_mov_b32 s68, 0x8000
    s_cmp_lg_u32 s60, 0
    s_cbranch_scc1 L_slow_loop
    s_mov_b64 exec, 0x3f
    v_mov_b32 v7, 0
    buffer_store_dword v7, v12, s[48:51], s79 offen sc1
    s_waitcnt vmcnt(0)
    s_mov_b64 exec, 1
    v_mov_b32 v7, 1
    global_atomic_add v50, v7, s[20:21] offset:4 sc1
    s_mov_b64 exec, -1
L_slow_loop:
    global_load_dword v7, v50, s[20:21] offset:4 sc1
    s_waitcnt vmcnt(0)
    v_readfirstlane_b32 s69, v7
    s_sub_u32 s68, s68, 1
    s_cbranch_scc1 L_slow_body
    s_cmp_lt_u32 s69, 16
    s_cbranch_scc1 L_slow_loop
    s_branch L_slow_body
L_late0:
    s_mov_b64 exec, s[6:7]
    s_mov_b32 s70, 0x20000
L_poll1:
    buffer_load_dword v3, v18, s[48:51], s71 offen offset:0 sc1
    s_waitcnt vmcnt(0)
    v_cmp_eq_u32 vcc, 0, v3
    s_sub_u32 s70, s70, 1
    s_cbranch_scc1 L_pd1
    s_cbranch_vccnz L_poll1
L_pd1:
    s_mov_b64 exec, -1
    s_branch L_back0
L_late2:
    s_mov_b64 exec, s[6:7]
    s_mov_b32 s70, 0x20000
L_poll3:
    buffer_load_dword v3, v20, s[48:51], s71 offen offset:128 sc1
    s_waitcnt vmcnt(0)
    v_cmp_eq_u32 vcc, 0, v3
    s_sub_u32 s70, s70, 1
    s_cbranch_scc1 L_pd3
    s_cbranch_vccnz L_poll3
L_pd3:
    s_mov_b64 exec, -1
    s_branch L_back2
L_late4:
    s_mov_b64 exec, s[6:7]
    s_mov_b32 s70, 0x20000
L_poll5:
    buffer_load_dword v33, v20, s[48:51], s71 offen offset:256 sc1
    s_waitcnt vmcnt(0)
    v_cmp_eq_u32 vcc, 0, v33
    s_sub_u32 s70, s70, 1
    s_cbranch_scc1 L_pd5
    s_cbranch_vccnz L_poll5
L_pd5:
    s_mov_b64 exec, -1
    s_branch L_back4
L_late6:
    s_mov_b64 exec, s[6:7]
    s_mov_b32 s70, 0x20000
L_poll7:
    buffer_load_dword v25, v20, s[48:51], s71 offen offset:384 sc1
    s_waitcnt vmcnt(0)
    v_cmp_eq_u32 vcc, 0, v25
    s_sub_u32 s70, s70, 1
    s_cbranch_scc1 L_pd7
    s_cbranch_vccnz L_poll7
L_pd7:
    s_mov_b64 exec, -1
    s_branch L_back6
L_late8:
    s_mov_b64 exec, s[6:7]
    s_mov_b32 s70, 0x20000
L_poll9:
    buffer_load_dword v3, v20, s[48:51], s71 offen offset:512 sc1
    s_waitcnt vmcnt(0)
    v_cmp_eq_u32 vcc, 0, v3
    s_sub_u32 s70, s70, 1
    s_cbranch_scc1 L_pd9
    s_cbranch_vccnz L_poll9
L_pd9:
    s_mov_b64 exec, -1
    s_branch L_back8
L_help:
    s_cmp_eq_u32 s62, 15
    s_cbranch_scc1 L_help15
L_help14:
    s_waitcnt lgkmcnt(0)
    s_mov_b64 exec, s[6:7]
    buffer_load_dword v3, v20, s[48:51], s71 offen offset:128 sc1
    s_mov_b64 exec, -1
    s_add_u32 m0, s66, 102400
    s_add_u32 m0, s66, 106496
    s_add_u32 m0, s66, 110592
    s_add_u32 m0, s66, 114688
    s_waitcnt vmcnt(0)
    v_cmp_eq_u32 vcc, 0, v3
    s_nop 0
    s_and_b64 vcc, vcc, s[6:7]
    s_cbranch_vccnz L_late2_h14
L_back2_h14:
    s_barrier
    buffer_load_dwordx4 a[0:3], v17, s[48:51], s3 offen offset:0 sc1
    buffer_load_dwordx4 a[4:7], v17, s[48:51], s3 offen offset:1024 sc1
    buffer_load_dwordx4 a[8:11], v17, s[48:51], s3 offen offset:2048 sc1
    buffer_load_dwordx4 a[12:15], v17, s[48:51], s3 offen offset:3072 sc1
    s_add_u32 s10, s66, s73
    s_add_u32 s10, s10, 131072
    s_lshl_b32 s68, s60, 15
    s_lshl_b32 s69, s62, 11
    s_add_u32 s69, s69, s68
    s_add_u32 s12, s69, s73
    s_lshl_b32 s15, s64, 17
    s_add_u32 s11, s15, s69
    s_lshr_b32 s68, s60, 1
    s_lshl1_add_u32 s68, s63, s68
    s_lshl_b32 s68, s68, 15
    s_add_u32 s15, s15, s68
    s_add_u32 s16, s73, s68
    s_and_b32 s58, s60, 1
    s_lshl_b32 s57, s58, 30
    s_add_u32 s57, s57, s15
    s_add_u32 s3, s3, 4096
    s_add_u32 s57, s57, 28672
    buffer_load_dwordx4 a[16:19], v17, s[48:51], s3 offen offset:0 sc1
    s_mul_i32 s68, s58, 3072
    v_add_u32 v22, s68, v17
    v_xor_b32 v21, 1024, v22
    v_lshl_add_u32 v15, s58, 11, v7
    v_lshl_add_u32 v16, s58, 11, v8
    v_lshl_add_u32 v18, s58, 11, v9
    v_lshl_add_u32 v19, s58, 11, v10
    buffer_load_dwordx4 a[20:23], v17, s[48:51], s3 offen offset:1024 sc1
    buffer_load_dwordx4 a[24:27], v17, s[48:51], s3 offen offset:2048 sc1
    buffer_load_dwordx4 a[28:31], v17, s[48:51], s3 offen offset:3072 sc1
    s_add_u32 s3, s3, 4096
    buffer_load_dwordx4 a[32:35], v17, s[48:51], s3 offen offset:0 sc1
    s_waitcnt vmcnt(7)
    v_mfma_f32_16x16x32_bf16 v[34:37], a[208:211], a[0:3], 0
    ds_read_b64_tr_b16 a[232:233], v14 offset:36864
    ds_read_b64_tr_b16 a[234:235], v14 offset:37888
    v_mfma_f32_16x16x32_bf16 v[38:41], a[208:211], a[4:7], 0
    buffer_load_dwordx4 a[36:39], v17, s[48:51], s3 offen offset:1024 sc1
    v_mfma_f32_16x16x32_bf16 v[42:45], a[212:215], a[0:3], 0
    ds_read_b64_tr_b16 a[236:237], v14 offset:38912
    v_mfma_f32_16x16x32_bf16 v[46:49], a[212:215], a[4:7], 0
    ds_read_b64_tr_b16 a[238:239], v14 offset:39936
    v_mfma_f32_16x16x32_bf16 v[68:71], a[216:219], a[0:3], 0
    ds_read_b64_tr_b16 a[240:241], v7 offset:40960
    v_mfma_f32_16x16x32_bf16 v[72:75], a[216:219], a[4:7], 0
    ds_read_b64_tr_b16 a[242:243], v7 offset:45056
    v_mfma_f32_16x16x32_bf16 v[76:79], a[220:223], a[0:3], 0
    ds_read_b64_tr_b16 a[244:245], v7 offset:43008
    ds_read_b64_tr_b16 a[246:247], v7 offset:47104
    v_mfma_f32_16x16x32_bf16 v[80:83], a[220:223], a[4:7], 0
    s_waitcnt lgkmcnt(4)
    buffer_load_dwordx4 a[40:43], v17, s[48:51], s3 offen offset:2048 sc1
    s_waitcnt vmcnt(7)
    v_mfma_f32_16x16x32_bf16 v[34:37], a[224:227], a[8:11], v[34:37]
    ds_read_b64_tr_b16 a[248:249], v8 offset:40960
    ds_read_b64_tr_b16 a[250:251], v8 offset:45056
    v_mfma_f32_16x16x32_bf16 v[38:41], a[224:227], a[12:15], v[38:41]
    buffer_load_dwordx4 a[44:47], v17, s[48:51], s3 offen offset:3072 sc1
    v_mfma_f32_16x16x32_bf16 v[42:45], a[228:231], a[8:11], v[42:45]
    ds_read_b64_tr_b16 a[252:253], v8 offset:43008
    v_mfma_f32_16x16x32_bf16 v[46:49], a[228:231], a[12:15], v[46:49]
    ds_read_b64_tr_b16 a[254:255], v8 offset:47104
    v_mfma_f32_16x16x32_bf16 v[68:71], a[232:235], a[8:11], v[68:71]
    ds_read_b64_tr_b16 a[208:209], v11 offset:49152
    v_mfma_f32_16x16x32_bf16 v[72:75], a[232:235], a[12:15], v[72:75]
    ds_read_b64_tr_b16 a[210:211], v11 offset:50176
    v_mfma_f32_16x16x32_bf16 v[76:79], a[236:239], a[8:11], v[76:79]
    s_add_u32 s3, s3, 4096
    ds_read_b64_tr_b16 a[212:213], v11 offset:51200
    ds_read_b64_tr_b16 a[214:215], v11 offset:52224
    v_mfma_f32_16x16x32_bf16 v[80:83], a[236:239], a[12:15], v[80:83]
    s_waitcnt lgkmcnt(4)
    buffer_load_dwordx4 a[48:51], v17, s[48:51], s3 offen offset:0 sc1
    s_waitcnt vmcnt(7)
    v_mfma_f32_16x16x32_bf16 v[34:37], a[240:243], a[16:19], v[34:37]
    ds_read_b64_tr_b16 a[216:217], v14 offset:49152
    ds_read_b64_tr_b16 a[218:219], v14 offset:50176
    v_mfma_f32_16x16x32_bf16 v[38:41], a[240:243], a[20:23], v[38:41]
    buffer_load_dwordx4 a[52:55], v17, s[48:51], s3 offen offset:1024 sc1
    v_mfma_f32_16x16x32_bf16 v[42:45], a[244:247], a[16:19], v[42:45]
    ds_read_b64_tr_b16 a[220:221], v14 offset:51200
    v_mfma_f32_16x16x32_bf16 v[46:49], a[244:247], a[20:23], v[46:49]
    ds_read_b64_tr_b16 a[222:223], v14 offset:52224
    v_mfma_f32_16x16x32_bf16 v[68:71], a[248:251], a[16:19], v[68:71]
    ds_read_b64_tr_b16 a[224:225], v7 offset:53248
    v_mfma_f32_16x16x32_bf16 v[72:75], a[248:251], a[20:23], v[72:75]
    ds_read_b64_tr_b16 a[226:227], v7 offset:57344
    v_mfma_f32_16x16x32_bf16 v[76:79], a[252:255], a[16:19], v[76:79]
    ds_read_b64_tr_b16 a[228:229], v7 offset:55296
    ds_read_b64_tr_b16 a[230:231], v7 offset:59392
    v_mfma_f32_16x16x32_bf16 v[80:83], a[252:255], a[20:23], v[80:83]
    s_waitcnt lgkmcnt(4)
    buffer_load_dwordx4 a[56:59], v17, s[48:51], s3 offen offset:2048 sc1
    s_waitcnt vmcnt(7)
    v_mfma_f32_16x16x32_bf16 v[34:37], a[208:211], a[24:27], v[34:37]
    ds_read_b64_tr_b16 a[232:233], v8 offset:53248
    ds_read_b64_tr_b16 a[234:235], v8 offset:57344
    v_mfma_f32_16x16x32_bf16 v[38:41], a[208:211], a[28:31], v[38:41]
    buffer_load_dwordx4 a[60:63], v17, s[48:51], s3 offen offset:3072 sc1
    v_mfma_f32_16x16x32_bf16 v[42:45], a[212:215], a[24:27], v[42:45]
    ds_read_b64_tr_b16 a[236:237], v8 offset:55296
    v_mfma_f32_16x16x32_bf16 v[46:49], a[212:215], a[28:31], v[46:49]
    ds_read_b64_tr_b16 a[238:239], v8 offset:59392
    v_mfma_f32_16x16x32_bf16 v[68:71], a[216:219], a[24:27], v[68:71]
    ds_read_b64_tr_b16 a[240:241], v11 offset:61440
    v_mfma_f32_16x16x32_bf16 v[72:75], a[216:219], a[28:31], v[72:75]
    ds_read_b64_tr_b16 a[242:243], v11 offset:62464
    v_mfma_f32_16x16x32_bf16 v[76:79], a[220:223], a[24:27], v[76:79]
    s_add_u32 s3, s3, 4096
    ds_read_b64_tr_b16 a[244:245], v11 offset:63488
    ds_read_b64_tr_b16 a[246:247], v11 offset:64512
    v_mfma_f32_16x16x32_bf16 v[80:83], a[220:223], a[28:31], v[80:83]
    s_waitcnt lgkmcnt(4)
    buffer_load_dwordx4 a[64:67], v17, s[48:51], s3 offen offset:0 sc1
    s_waitcnt vmcnt(7)
    v_mfma_f32_16x16x32_bf16 v[34:37], a[224:227], a[32:35], v[34:37]
    ds_read_b64_tr_b16 a[248:249], v14 offset:61440
    ds_read_b64_tr_b16 a[250:251], v14 offset:62464
    v_mfma_f32_16x16x32_bf16 v[38:41], a[224:227], a[36:39], v[38:41]
    buffer_load_dwordx4 a[68:71], v17, s[48:51], s3 offen offset:1024 sc1
    v_mfma_f32_16x16x32_bf16 v[42:45], a[228:231], a[32:35], v[42:45]
    ds_read_b64_tr_b16 a[252:253], v14 offset:63488
    v_mfma_f32_16x16x32_bf16 v[46:49], a[228:231], a[36:39], v[46:49]
    ds_read_b64_tr_b16 a[254:255], v14 offset:64512
    v_mfma_f32_16x16x32_bf16 v[68:71], a[232:235], a[32:35], v[68:71]
    ds_read_b64_tr_b16 a[208:209], v7 offset:16384
    v_mfma_f32_16x16x32_bf16 v[72:75], a[232:235], a[36:39], v[72:75]
    ds_read_b64_tr_b16 a[210:211], v7 offset:20480
    v_mfma_f32_16x16x32_bf16 v[76:79], a[236:239], a[32:35], v[76:79]
    ds_read_b64_tr_b16 a[212:213], v7 offset:18432
    ds_read_b64_tr_b16 a[214:215], v7 offset:22528
    v_mfma_f32_16x16x32_bf16 v[80:83], a[236:239], a[36:39], v[80:83]
    s_waitcnt lgkmcnt(4)
    buffer_load_dwordx4 a[72:75], v17, s[48:51], s3 offen offset:2048 sc1
    s_waitcnt vmcnt(7)
    v_mfma_f32_16x16x32_bf16 v[34:37], a[240:243], a[40:43], v[34:37]
    ds_read_b64_tr_b16 a[216:217], v8 offset:16384
    ds_read_b64_tr_b16 a[218:219], v8 offset:20480
    v_mfma_f32_16x16x32_bf16 v[38:41], a[240:243], a[44:47], v[38:41]
    buffer_load_dwordx4 a[76:79], v17, s[48:51], s3 offen offset:3072 sc1
    v_mfma_f32_16x16x32_bf16 v[42:45], a[244:247], a[40:43], v[42:45]
    ds_read_b64_tr_b16 a[220:221], v8 offset:18432
    ds_read_b64_tr_b16 a[222:223], v8 offset:22528
    v_mfma_f32_16x16x32_bf16 v[46:49], a[244:247], a[44:47], v[46:49]
    v_add_u32 v172, 65536, v11
    v_mfma_f32_16x16x32_bf16 v[68:71], a[248:251], a[40:43], v[68:71]
    ds_read_b64_tr_b16 a[224:225], v172 offset:0
    v_mfma_f32_16x16x32_bf16 v[72:75], a[248:251], a[44:47], v[72:75]
    ds_read_b64_tr_b16 a[226:227], v172 offset:1024
    v_mfma_f32_16x16x32_bf16 v[76:79], a[252:255], a[40:43], v[76:79]
    s_add_u32 s3, s3, 4096
    ds_read_b64_tr_b16 a[228:229], v172 offset:2048
    ds_read_b64_tr_b16 a[230:231], v172 offset:3072
    v_mfma_f32_16x16x32_bf16 v[80:83], a[252:255], a[44:47], v[80:83]
    s_waitcnt lgkmcnt(4)
    buffer_load_dwordx4 a[80:83], v17, s[48:51], s3 offen offset:0 sc1
    v_add_u32 v173, 65536, v14
    s_waitcnt vmcnt(7)
    v_mfma_f32_16x16x32_bf16 v[34:37], a[208:211], a[48:51], v[34:37]
    ds_read_b64_tr_b16 a[232:233], v173 offset:0
    ds_read_b64_tr_b16 a[234:235], v173 offset:1024
    v_mfma_f32_16x16x32_bf16 v[38:41], a[208:211], a[52:55], v[38:41]
    buffer_load_dwordx4 a[84:87], v17, s[48:51], s3 offen offset:1024 sc1
    v_mfma_f32_16x16x32_bf16 v[42:45], a[212:215], a[48:51], v[42:45]
    ds_read_b64_tr_b16 a[236:237], v173 offset:2048
    v_mfma_f32_16x16x32_bf16 v[46:49], a[212:215], a[52:55], v[46:49]
    ds_read_b64_tr_b16 a[238:239], v173 offset:3072
    v_mfma_f32_16x16x32_bf16 v[68:71], a[216:219], a[48:51], v[68:71]
    ds_read_b64_tr_b16 a[240:241], v13 offset:4096
    v_mfma_f32_16x16x32_bf16 v[72:75], a[216:219], a[52:55], v[72:75]
    ds_read_b64_tr_b16 a[242:243], v13 offset:8192
    v_mfma_f32_16x16x32_bf16 v[76:79], a[220:223], a[48:51], v[76:79]
    ds_read_b64_tr_b16 a[244:245], v13 offset:6144
    ds_read_b64_tr_b16 a[246:247], v13 offset:10240
    v_mfma_f32_16x16x32_bf16 v[80:83], a[220:223], a[52:55], v[80:83]
    s_waitcnt lgkmcnt(4)
    buffer_load_dwordx4 a[88:91], v17, s[48:51], s3 offen offset:2048 sc1
    s_waitcnt vmcnt(7)
    v_mfma_f32_16x16x32_bf16 v[34:37], a[224:227], a[56:59], v[34:37]
    ds_read_b64_tr_b16 a[248:249], v23 offset:4096
    ds_read_b64_tr_b16 a[250:251], v23 offset:8192
    v_mfma_f32_16x16x32_bf16 v[38:41], a[224:227], a[60:63], v[38:41]
    buffer_load_dwordx4 a[92:95], v17, s[48:51], s3 offen offset:3072 sc1
    v_mfma_f32_16x16x32_bf16 v[42:45], a[228:231], a[56:59], v[42:45]
    ds_read_b64_tr_b16 a[252:253], v23 offset:6144
    v_mfma_f32_16x16x32_bf16 v[46:49], a[228:231], a[60:63], v[46:49]
    ds_read_b64_tr_b16 a[254:255], v23 offset:10240
    v_mfma_f32_16x16x32_bf16 v[68:71], a[232:235], a[56:59], v[68:71]
    ds_read_b64_tr_b16 a[208:209], v172 offset:12288
    v_mfma_f32_16x16x32_bf16 v[72:75], a[232:235], a[60:63], v[72:75]
    ds_read_b64_tr_b16 a[210:211], v172 offset:13312
    v_mfma_f32_16x16x32_bf16 v[76:79], a[236:239], a[56:59], v[76:79]
    s_add_u32 s3, s3, 4096
    ds_read_b64_tr_b16 a[212:213], v172 offset:14336
    ds_read_b64_tr_b16 a[214:215], v172 offset:15360
    v_mfma_f32_16x16x32_bf16 v[80:83], a[236:239], a[60:63], v[80:83]
    s_waitcnt lgkmcnt(4)
    buffer_load_dwordx4 a[96:99], v17, s[48:51], s3 offen offset:0 sc1
    s_waitcnt vmcnt(7)
    v_mfma_f32_16x16x32_bf16 v[34:37], a[240:243], a[64:67], v[34:37]
    ds_read_b64_tr_b16 a[216:217], v173 offset:12288
    ds_read_b64_tr_b16 a[218:219], v173 offset:13312
    v_mfma_f32_16x16x32_bf16 v[38:41], a[240:243], a[68:71], v[38:41]
    buffer_load_dwordx4 a[100:103], v17, s[48:51], s3 offen offset:1024 sc1
    v_mfma_f32_16x16x32_bf16 v[42:45], a[244:247], a[64:67], v[42:45]
    ds_read_b64_tr_b16 a[220:221], v173 offset:14336
    ds_read_b64_tr_b16 a[222:223], v173 offset:15360
    v_mfma_f32_16x16x32_bf16 v[46:49], a[244:247], a[68:71], v[46:49]
    s_barrier
    v_mfma_f32_16x16x32_bf16 v[68:71], a[248:251], a[64:67], v[68:71]
    ds_read_b64_tr_b16 a[224:225], v13 offset:16384
    ds_read_b64_tr_b16 a[226:227], v13 offset:20480
    v_mfma_f32_16x16x32_bf16 v[72:75], a[248:251], a[68:71], v[72:75]
    buffer_load_dwordx4 a[104:107], v17, s[48:51], s3 offen offset:2048 sc1
    v_mfma_f32_16x16x32_bf16 v[76:79], a[252:255], a[64:67], v[76:79]
    ds_read_b64_tr_b16 a[228:229], v13 offset:18432
    ds_read_b64_tr_b16 a[230:231], v13 offset:22528
    v_mfma_f32_16x16x32_bf16 v[80:83], a[252:255], a[68:71], v[80:83]
    s_waitcnt vmcnt(7) lgkmcnt(4)
    v_mfma_f32_16x16x32_bf16 v[34:37], a[208:211], a[72:75], v[34:37]
    ds_read_b64_tr_b16 a[232:233], v23 offset:16384
    ds_read_b64_tr_b16 a[234:235], v23 offset:20480
    v_mfma_f32_16x16x32_bf16 v[38:41], a[208:211], a[76:79], v[38:41]
    buffer_load_dwordx4 a[108:111], v17, s[48:51], s3 offen offset:3072 sc1
    v_mfma_f32_16x16x32_bf16 v[42:45], a[212:215], a[72:75], v[42:45]
    ds_read_b64_tr_b16 a[236:237], v23 offset:18432
    v_mfma_f32_16x16x32_bf16 v[46:49], a[212:215], a[76:79], v[46:49]
    ds_read_b64_tr_b16 a[238:239], v23 offset:22528
    v_mfma_f32_16x16x32_bf16 v[68:71], a[216:219], a[72:75], v[68:71]
    ds_read_b64_tr_b16 a[240:241], v11 offset:24576
    v_mfma_f32_16x16x32_bf16 v[72:75], a[216:219], a[76:79], v[72:75]
    ds_read_b64_tr_b16 a[242:243], v11 offset:25600
    v_mfma_f32_16x16x32_bf16 v[76:79], a[220:223], a[72:75], v[76:79]
    s_add_u32 s3, s3, 4096
    ds_read_b64_tr_b16 a[244:245], v11 offset:26624
    ds_read_b64_tr_b16 a[246:247], v11 offset:27648
    v_mfma_f32_16x16x32_bf16 v[80:83], a[220:223], a[76:79], v[80:83]
    s_waitcnt lgkmcnt(4)
    buffer_load_dwordx4 a[112:115], v17, s[48:51], s3 offen offset:0 sc1
    s_waitcnt vmcnt(7)
    v_mfma_f32_16x16x32_bf16 v[34:37], a[224:227], a[80:83], v[34:37]
    ds_read_b64_tr_b16 a[248:249], v14 offset:24576
    ds_read_b64_tr_b16 a[250:251], v14 offset:25600
    v_mfma_f32_16x16x32_bf16 v[38:41], a[224:227], a[84:87], v[38:41]
    buffer_load_dwordx4 a[116:119], v17, s[48:51], s3 offen offset:1024 sc1
    v_mfma_f32_16x16x32_bf16 v[42:45], a[228:231], a[80:83], v[42:45]
    ds_read_b64_tr_b16 a[252:253], v14 offset:26624
    v_mfma_f32_16x16x32_bf16 v[46:49], a[228:231], a[84:87], v[46:49]
    ds_read_b64_tr_b16 a[254:255], v14 offset:27648
    v_mfma_f32_16x16x32_bf16 v[68:71], a[232:235], a[80:83], v[68:71]
    ds_read_b64_tr_b16 a[208:209], v7 offset:28672
    v_mfma_f32_16x16x32_bf16 v[72:75], a[232:235], a[84:87], v[72:75]
    ds_read_b64_tr_b16 a[210:211], v7 offset:0
    v_mfma_f32_16x16x32_bf16 v[76:79], a[236:239], a[80:83], v[76:79]
    ds_read_b64_tr_b16 a[212:213], v7 offset:30720
    ds_read_b64_tr_b16 a[214:215], v7 offset:2048
    v_mfma_f32_16x16x32_bf16 v[80:83], a[236:239], a[84:87], v[80:83]
    s_waitcnt lgkmcnt(4)
    buffer_load_dwordx4 a[120:123], v17, s[48:51], s3 offen offset:2048 sc1
    s_waitcnt vmcnt(7)
    v_mfma_f32_16x16x32_bf16 v[34:37], a[240:243], a[88:91], v[34:37]
    ds_read_b64_tr_b16 a[216:217], v8 offset:28672
    ds_read_b64_tr_b16 a[218:219], v8 offset:0
    v_mfma_f32_16x16x32_bf16 v[38:41], a[240:243], a[92:95], v[38:41]
    buffer_load_dwordx4 a[124:127], v17, s[48:51], s3 offen offset:3072 sc1
    v_mfma_f32_16x16x32_bf16 v[42:45], a[244:247], a[88:91], v[42:45]
    ds_read_b64_tr_b16 a[220:221], v8 offset:30720
    v_mfma_f32_16x16x32_bf16 v[46:49], a[244:247], a[92:95], v[46:49]
    ds_read_b64_tr_b16 a[222:223], v8 offset:2048
    v_mfma_f32_16x16x32_bf16 v[68:71], a[248:251], a[88:91], v[68:71]
    ds_read_b64_tr_b16 a[224:225], v11 offset:4096
    v_mfma_f32_16x16x32_bf16 v[72:75], a[248:251], a[92:95], v[72:75]
    ds_read_b64_tr_b16 a[226:227], v11 offset:5120
    v_mfma_f32_16x16x32_bf16 v[76:79], a[252:255], a[88:91], v[76:79]
    ds_read_b64_tr_b16 a[228:229], v11 offset:6144
    ds_read_b64_tr_b16 a[230:231], v11 offset:7168
    v_mfma_f32_16x16x32_bf16 v[80:83], a[252:255], a[92:95], v[80:83]
    s_waitcnt lgkmcnt(4)
    buffer_load_dwordx4 v[26:29], v17, s[48:51], s10 offen sc1
    s_waitcnt vmcnt(7)
    v_mfma_f32_16x16x32_bf16 v[34:37], a[208:211], a[96:99], v[34:37]
    s_add_u32 m0, s66, 118784
    ds_read_b64_tr_b16 a[232:233], v14 offset:4096
    ds_read_b64_tr_b16 a[234:235], v14 offset:5120
    v_mfma_f32_16x16x32_bf16 v[38:41], a[208:211], a[100:103], v[38:41]
    v_mfma_f32_16x16x32_bf16 v[42:45], a[212:215], a[96:99], v[42:45]
    ds_read_b64_tr_b16 a[236:237], v14 offset:6144
    v_mfma_f32_16x16x32_bf16 v[46:49], a[212:215], a[100:103], v[46:49]
    ds_read_b64_tr_b16 a[238:239], v14 offset:7168
    v_mfma_f32_16x16x32_bf16 v[68:71], a[216:219], a[96:99], v[68:71]
    ds_read_b64_tr_b16 a[240:241], v7 offset:8192
    v_mfma_f32_16x16x32_bf16 v[72:75], a[216:219], a[100:103], v[72:75]
    ds_read_b64_tr_b16 a[242:243], v7 offset:12288
    v_mfma_f32_16x16x32_bf16 v[76:79], a[220:223], a[96:99], v[76:79]
    s_add_u32 m0, s66, 122880
    ds_read_b64_tr_b16 a[244:245], v7 offset:10240
    ds_read_b64_tr_b16 a[246:247], v7 offset:14336
    v_mfma_f32_16x16x32_bf16 v[80:83], a[220:223], a[100:103], v[80:83]
    s_waitcnt vmcnt(5) lgkmcnt(4)
    v_mfma_f32_16x16x32_bf16 v[34:37], a[224:227], a[104:107], v[34:37]
    s_add_u32 m0, s66, 126976
    ds_read_b64_tr_b16 a[248:249], v8 offset:8192
    ds_read_b64_tr_b16 a[250:251], v8 offset:12288
    v_mfma_f32_16x16x32_bf16 v[38:41], a[224:227], a[108:111], v[38:41]
    v_mfma_f32_16x16x32_bf16 v[42:45], a[228:231], a[104:107], v[42:45]
    ds_read_b64_tr_b16 a[252:253], v8 offset:10240
    v_mfma_f32_16x16x32_bf16 v[46:49], a[228:231], a[108:111], v[46:49]
    ds_read_b64_tr_b16 a[254:255], v8 offset:14336
    v_mfma_f32_16x16x32_bf16 v[68:71], a[232:235], a[104:107], v[68:71]
    ds_read_b64_tr_b16 a[208:209], v172 offset:28672
    v_mfma_f32_16x16x32_bf16 v[72:75], a[232:235], a[108:111], v[72:75]
    ds_read_b64_tr_b16 a[210:211], v172 offset:29696
    v_mfma_f32_16x16x32_bf16 v[76:79], a[236:239], a[104:107], v[76:79]
    s_add_u32 m0, s66, 131072
    ds_read_b64_tr_b16 a[212:213], v172 offset:30720
    ds_read_b64_tr_b16 a[214:215], v172 offset:31744
    v_mfma_f32_16x16x32_bf16 v[80:83], a[236:239], a[108:111], v[80:83]
    s_waitcnt vmcnt(3) lgkmcnt(4)
    v_mfma_f32_16x16x32_bf16 v[34:37], a[240:243], a[112:115], v[34:37]
    s_add_u32 m0, s66, 135168
    ds_read_b64_tr_b16 a[216:217], v173 offset:28672
    ds_read_b64_tr_b16 a[218:219], v173 offset:29696
    v_mfma_f32_16x16x32_bf16 v[38:41], a[240:243], a[116:119], v[38:41]
    v_mfma_f32_16x16x32_bf16 v[42:45], a[244:247], a[112:115], v[42:45]
    ds_read_b64_tr_b16 a[220:221], v173 offset:30720
    ds_read_b64_tr_b16 a[222:223], v173 offset:31744
    v_mfma_f32_16x16x32_bf16 v[46:49], a[244:247], a[116:119], v[46:49]
    v_add_u32 v174, 65536, v9
    v_mfma_f32_16x16x32_bf16 v[68:71], a[248:251], a[112:115], v[68:71]
    v_mfma_f32_16x16x32_bf16 v[72:75], a[248:251], a[116:119], v[72:75]
    v_mfma_f32_16x16x32_bf16 v[76:79], a[252:255], a[112:115], v[76:79]
    s_add_u32 m0, s66, 139264
    v_mfma_f32_16x16x32_bf16 v[80:83], a[252:255], a[116:119], v[80:83]
    s_waitcnt lgkmcnt(0)
    v_add_u32 v175, 65536, v10
    s_waitcnt vmcnt(1)
    v_mfma_f32_16x16x32_bf16 v[34:37], a[208:211], a[120:123], v[34:37]
    s_add_u32 m0, s66, 143360
    v_mfma_f32_16x16x32_bf16 v[38:41], a[208:211], a[124:127], v[38:41]
    v_mfma_f32_16x16x32_bf16 v[42:45], a[212:215], a[120:123], v[42:45]
    v_mfma_f32_16x16x32_bf16 v[46:49], a[212:215], a[124:127], v[46:49]
    v_mfma_f32_16x16x32_bf16 v[68:71], a[216:219], a[120:123], v[68:71]
    v_mfma_f32_16x16x32_bf16 v[72:75], a[216:219], a[124:127], v[72:75]
    s_waitcnt vmcnt(0)
    v_add_f32 v26, v26, v27
    v_add_f32 v28, v28, v29
    v_mfma_f32_16x16x32_bf16 v[76:79], a[220:223], a[120:123], v[76:79]
    s_add_u32 m0, s66, 147456
    v_mfma_f32_16x16x32_bf16 v[80:83], a[220:223], a[124:127], v[80:83]
    v_permlane32_swap_b32 v26, v28
    v_add_f32 v27, v26, v28
    v_add_f32 v26, v26, v28
    s_add_u32 m0, s66, 151552
    s_nop 0
    v_permlane16_swap_b32 v26, v27
    v_add_f32 v26, v26, v27
    v_fma_f32 v54, v26, s1, v30
    v_fma_f32 v55, v26, s1, v30
    s_add_u32 m0, s66, 155648
    s_nop 0
    v_permlane32_swap_b32 v54, v55
    v_rsq_f32 v26, v54
    v_rsq_f32 v27, v55
    v_mul_f32 v50, 0xc0135761, v26
    s_add_u32 m0, s66, 36864
    v_mul_f32 v26, v26, v26
    v_mul_f32 v51, 0x3d372713, v50
    v_mul_f32 v51, v51, v26
    v_mul_f32 v52, 0xc0135761, v27
    v_mul_f32 v27, v27, v27
    s_add_u32 m0, s66, 49152
    s_lshl1_add_u32 s52, s56, 0xffffdfc0
    v_add_u32 v62, s52, v62
    v_mul_f32 v53, 0x3d372713, v52
    v_mul_f32 v53, v53, v27
    v_pk_mul_f32 v[132:133], v[34:35], v[34:35]
    v_pk_mul_f32 v[134:135], v[36:37], v[36:37]
    v_pk_mul_f32 v[136:137], v[38:39], v[38:39]
    v_pk_mul_f32 v[138:139], v[40:41], v[40:41]
    v_pk_fma_f32 v[132:133], v[132:133], v[50:51], v[50:51] op_sel:[0,1,0] op_sel_hi:[1,1,0]
    v_pk_fma_f32 v[134:135], v[134:135], v[50:51], v[50:51] op_sel:[0,1,0] op_sel_hi:[1,1,0]
    v_pk_fma_f32 v[136:137], v[136:137], v[52:53], v[52:53] op_sel:[0,1,0] op_sel_hi:[1,1,0]
    v_pk_fma_f32 v[138:139], v[138:139], v[52:53], v[52:53] op_sel:[0,1,0] op_sel_hi:[1,1,0]
    v_pk_mul_f32 v[132:133], v[132:133], v[34:35]
    v_pk_mul_f32 v[134:135], v[134:135], v[36:37]
    v_pk_mul_f32 v[136:137], v[136:137], v[38:39]
    v_pk_mul_f32 v[138:139], v[138:139], v[40:41]
    v_exp_f32 v132, v132
    s_add_u32 m0, s66, 61440
    v_exp_f32 v133, v133
    s_barrier
    v_exp_f32 v134, v134
    v_exp_f32 v135, v135
    v_exp_f32 v136, v136
    s_add_u32 m0, s66, 65536
    v_exp_f32 v137, v137
    v_exp_f32 v138, v138
    v_exp_f32 v139, v139
    v_pk_mul_f32 v[42:43], v[34:35], v[42:43]
    v_pk_mul_f32 v[44:45], v[36:37], v[44:45]
    v_pk_mul_f32 v[46:47], v[38:39], v[46:47]
    v_pk_mul_f32 v[48:49], v[40:41], v[48:49]
    v_pk_fma_f32 v[132:133], v[132:133], v[54:55], v[54:55] op_sel:[0,0,0] op_sel_hi:[1,0,0]
    v_pk_fma_f32 v[134:135], v[134:135], v[54:55], v[54:55] op_sel:[0,0,0] op_sel_hi:[1,0,0]
    v_pk_fma_f32 v[136:137], v[136:137], v[54:55], v[54:55] op_sel:[0,1,1] op_sel_hi:[1,1,1]
    v_pk_fma_f32 v[138:139], v[138:139], v[54:55], v[54:55] op_sel:[0,1,1] op_sel_hi:[1,1,1]
    v_rcp_f32 v132, v132
    v_rcp_f32 v133, v133
    s_add_u32 m0, s66, 90112
    v_rcp_f32 v134, v134
    v_rcp_f32 v135, v135
    v_rcp_f32 v136, v136
    v_rcp_f32 v137, v137
    v_rcp_f32 v138, v138
    v_rcp_f32 v139, v139
    v_pk_mul_f32 v[42:43], v[42:43], v[132:133]
    v_pk_mul_f32 v[44:45], v[44:45], v[134:135]
    v_pk_mul_f32 v[46:47], v[46:47], v[136:137]
    v_pk_mul_f32 v[48:49], v[48:49], v[138:139]
    s_add_u32 m0, s66, 32768
    v_cvt_pk_bf16_f32 v56, v42, v43
    v_cvt_pk_bf16_f32 v57, v44, v45
    v_cvt_pk_bf16_f32 v140, v46, v47
    v_cvt_pk_bf16_f32 v141, v48, v49
    v_pk_mul_f32 v[132:133], v[68:69], v[68:69]
    v_pk_mul_f32 v[134:135], v[70:71], v[70:71]
    v_pk_mul_f32 v[136:137], v[72:73], v[72:73]
    v_pk_mul_f32 v[138:139], v[74:75], v[74:75]
    v_pk_fma_f32 v[132:133], v[132:133], v[50:51], v[50:51] op_sel:[0,1,0] op_sel_hi:[1,1,0]
    v_pk_fma_f32 v[134:135], v[134:135], v[50:51], v[50:51] op_sel:[0,1,0] op_sel_hi:[1,1,0]
    v_pk_fma_f32 v[136:137], v[136:137], v[52:53], v[52:53] op_sel:[0,1,0] op_sel_hi:[1,1,0]
    v_pk_fma_f32 v[138:139], v[138:139], v[52:53], v[52:53] op_sel:[0,1,0] op_sel_hi:[1,1,0]
    v_pk_mul_f32 v[132:133], v[132:133], v[68:69]
    v_pk_mul_f32 v[134:135], v[134:135], v[70:71]
    v_pk_mul_f32 v[136:137], v[136:137], v[72:73]
    v_pk_mul_f32 v[138:139], v[138:139], v[74:75]
    s_add_u32 m0, s66, 40960
    v_exp_f32 v132, v132
    v_exp_f32 v133, v133
    v_exp_f32 v134, v134
    v_exp_f32 v135, v135
    s_add_u32 m0, s66, 45056
    v_exp_f32 v136, v136
    s_barrier
    v_exp_f32 v137, v137
    v_add_u32 v176, 131072, v7
    v_exp_f32 v138, v138
    v_exp_f32 v139, v139
    v_pk_mul_f32 v[76:77], v[68:69], v[76:77]
    v_pk_mul_f32 v[78:79], v[70:71], v[78:79]
    v_pk_mul_f32 v[80:81], v[72:73], v[80:81]
    v_pk_mul_f32 v[82:83], v[74:75], v[82:83]
    v_pk_fma_f32 v[132:133], v[132:133], v[54:55], v[54:55] op_sel:[0,0,0] op_sel_hi:[1,0,0]
    v_pk_fma_f32 v[134:135], v[134:135], v[54:55], v[54:55] op_sel:[0,0,0] op_sel_hi:[1,0,0]
    v_pk_fma_f32 v[136:137], v[136:137], v[54:55], v[54:55] op_sel:[0,1,1] op_sel_hi:[1,1,1]
    v_pk_fma_f32 v[138:139], v[138:139], v[54:55], v[54:55] op_sel:[0,1,1] op_sel_hi:[1,1,1]
    s_add_u32 m0, s66, 53248
    v_rcp_f32 v132, v132
    v_rcp_f32 v133, v133
    v_rcp_f32 v134, v134
    v_rcp_f32 v135, v135
    v_rcp_f32 v136, v136
    s_add_u32 m0, s66, 57344
    s_add_u32 s52, s53, 0
    v_add_u32 v65, 16384, v64
    v_add_u32 v66, 196608, v64
    v_add_u32 v67, 212992, v64
    buffer_load_dwordx4 v64, s[40:43], s52 offen lds
    v_rcp_f32 v137, v137
    v_rcp_f32 v138, v138
    v_rcp_f32 v139, v139
    v_pk_mul_f32 v[76:77], v[76:77], v[132:133]
    v_pk_mul_f32 v[78:79], v[78:79], v[134:135]
    v_pk_mul_f32 v[80:81], v[80:81], v[136:137]
    v_pk_mul_f32 v[82:83], v[82:83], v[138:139]
    s_add_u32 m0, s66, 77824
    s_nop 0
    buffer_load_dwordx4 v65, s[40:43], s52 offen lds
    v_cvt_pk_bf16_f32 v58, v76, v77
    v_cvt_pk_bf16_f32 v59, v78, v79
    s_add_u32 m0, s66, 24576
    s_nop 0
    buffer_load_dwordx4 v66, s[40:43], s52 offen lds
    v_cvt_pk_bf16_f32 v142, v80, v81
    v_cvt_pk_bf16_f32 v143, v82, v83
    buffer_store_dwordx4 v[56:59], v17, s[44:47], s11 offen
    buffer_store_dwordx4 v[140:143], v17, s[44:47], s11 offen offset:1024
    v_lshlrev_b32 v34, 16, v144
    v_and_b32 v35, 0xffff0000, v144
    v_lshlrev_b32 v36, 16, v145
    v_and_b32 v37, 0xffff0000, v145
    v_lshlrev_b32 v38, 16, v146
    v_and_b32 v39, 0xffff0000, v146
    v_lshlrev_b32 v40, 16, v147
    v_and_b32 v41, 0xffff0000, v147
    v_lshlrev_b32 v42, 16, v148
    v_and_b32 v43, 0xffff0000, v148
    v_lshlrev_b32 v44, 16, v149
    v_and_b32 v45, 0xffff0000, v149
    v_lshlrev_b32 v46, 16, v150
    v_and_b32 v47, 0xffff0000, v150
    v_lshlrev_b32 v48, 16, v151
    v_and_b32 v49, 0xffff0000, v151
    s_add_u32 m0, s66, 4096
    s_nop 0
    buffer_load_dwordx4 v67, s[40:43], s52 offen lds
    v_add_u32 v177, 131072, v8
    s_add_u32 m0, s66, 94208
    s_add_u32 s52, s53, 393216
    buffer_load_dwordx4 v64, s[40:43], s52 offen lds
    s_add_u32 m0, s66, 16384
    s_nop 0
    buffer_load_dwordx4 v65, s[40:43], s52 offen lds
    s_add_u32 m0, s66, 20480
    s_nop 0
    buffer_load_dwordx4 v66, s[40:43], s52 offen lds
    s_add_u32 m0, s66, 69632
    s_nop 0
    buffer_load_dwordx4 v67, s[40:43], s52 offen lds
    s_add_u32 m0, s66, 73728
    s_add_u32 s52, s53, 786432
    buffer_load_dwordx4 v64, s[40:43], s52 offen lds
    s_add_u32 m0, s66, 81920
    s_nop 0
    buffer_load_dwordx4 v65, s[40:43], s52 offen lds
    s_add_u32 m0, s66, 86016
    s_nop 0
    buffer_load_dwordx4 v66, s[40:43], s52 offen lds
    s_add_u32 m0, s66, 28672
    s_nop 0
    buffer_load_dwordx4 v67, s[40:43], s52 offen lds
    s_waitcnt vmcnt(9)
    s_barrier
    s_add_u32 m0, s66, 0
    s_add_u32 s52, s53, 1179648
    buffer_load_dwordx4 v64, s[40:43], s52 offen lds
    s_add_u32 m0, s66, 8192
    s_nop 0
    buffer_load_dwordx4 v65, s[40:43], s52 offen lds
    s_add_u32 m0, s66, 12288
    s_nop 0
    buffer_load_dwordx4 v66, s[40:43], s52 offen lds
    s_mov_b64 exec, s[4:5]
    buffer_store_dword v2, off, s[48:51], s79 offset:256
    s_mov_b64 exec, -1
    s_mov_b64 exec, s[4:5]
    buffer_store_dword v2, off, s[48:51], s79 offset:384
    s_mov_b64 exec, -1
    v_add_u32 v178, 131072, v9
    v_add_u32 v179, 131072, v10
    s_waitcnt vmcnt(12)
    s_barrier
    s_add_u32 m0, s66, 98304
    s_nop 0
    buffer_load_dwordx4 v67, s[40:43], s52 offen lds
    s_add_u32 m0, s66, 102400
    s_add_u32 s52, s54, 0
    buffer_load_dwordx4 v64, s[40:43], s52 offen lds
    s_add_u32 m0, s66, 106496
    s_nop 0
    buffer_load_dwordx4 v65, s[40:43], s52 offen lds
    s_add_u32 m0, s66, 110592
    s_nop 0
    buffer_load_dwordx4 v66, s[40:43], s52 offen lds
    s_add_u32 m0, s66, 114688
    s_nop 0
    buffer_load_dwordx4 v67, s[40:43], s52 offen lds
    s_add_u32 m0, s66, 118784
    s_add_u32 s52, s54, 393216
    buffer_load_dwordx4 v64, s[40:43], s52 offen lds
    s_add_u32 s13, s12, 262144
    s_waitcnt vmcnt(12)
    s_barrier
    s_add_u32 m0, s66, 122880
    s_nop 0
    buffer_load_dwordx4 v65, s[40:43], s52 offen lds
    s_add_u32 m0, s66, 126976
    s_nop 0
    buffer_load_dwordx4 v66, s[40:43], s52 offen lds
    s_add_u32 m0, s66, 131072
    s_nop 0
    buffer_load_dwordx4 v67, s[40:43], s52 offen lds
    s_mov_b64 exec, s[6:7]
    buffer_load_dword v33, v20, s[48:51], s71 offen offset:256 sc1
    s_mov_b64 exec, -1
    s_add_u32 m0, s66, 135168
    s_add_u32 s52, s54, 786432
    buffer_load_dwordx4 v64, s[40:43], s52 offen lds
    s_add_u32 m0, s66, 139264
    s_nop 0
    buffer_load_dwordx4 v65, s[40:43], s52 offen lds
    s_add_u32 m0, s66, 143360
    s_nop 0
    buffer_load_dwordx4 v66, s[40:43], s52 offen lds
    s_waitcnt vmcnt(11)
    s_barrier
    s_add_u32 m0, s66, 147456
    s_nop 0
    buffer_load_dwordx4 v67, s[40:43], s52 offen lds
    s_add_u32 m0, s66, 151552
    s_add_u32 s52, s54, 1179648
    buffer_load_dwordx4 v64, s[40:43], s52 offen lds
    s_add_u32 m0, s66, 155648
    s_nop 0
    buffer_load_dwordx4 v65, s[40:43], s52 offen lds
    s_add_u32 m0, s66, 36864
    s_add_u32 s52, s55, 0
    buffer_load_dwordx4 v64, s[40:43], s52 offen lds
    s_waitcnt vmcnt(11)
    s_barrier
    s_add_u32 m0, s66, 49152
    s_nop 0
    buffer_load_dwordx4 v65, s[40:43], s52 offen lds
    s_mov_b64 exec, s[4:5]
    s_mov_b64 exec, -1
    s_add_u32 m0, s66, 61440
    s_nop 0
    buffer_load_dwordx4 v66, s[40:43], s52 offen lds
    s_add_u32 m0, s66, 65536
    s_nop 0
    buffer_load_dwordx4 v67, s[40:43], s52 offen lds
    s_waitcnt vmcnt(10)
    v_cmp_eq_u32 vcc, 0, v33
    s_nop 0
    s_and_b64 vcc, vcc, s[6:7]
    s_cbranch_vccnz L_late4_h14
L_back4_h14:
    s_add_u32 m0, s66, 90112
    s_add_u32 s52, s55, 393216
    buffer_load_dwordx4 v64, s[40:43], s52 offen lds
    s_barrier
    s_add_u32 s14, s15, 0
    buffer_load_dwordx4 a[128:131], v21, s[44:47], s14 offen sc1
    v_add_u32 v180, 65536, v15
    ds_read_b64_tr_b16 a[208:209], v15 offset:57344
    ds_read_b64_tr_b16 a[210:211], v180 offset:12288
    v_add_u32 v181, 65536, v16
    ds_read_b64_tr_b16 a[212:213], v16 offset:57344
    ds_read_b64_tr_b16 a[214:215], v181 offset:12288
    buffer_load_dwordx4 a[132:135], v22, s[44:47], s14 offen sc1
    v_add_u32 v182, 65536, v18
    ds_read_b64_tr_b16 a[216:217], v18 offset:57344
    ds_read_b64_tr_b16 a[218:219], v182 offset:12288
    v_add_u32 v183, 65536, v19
    ds_read_b64_tr_b16 a[220:221], v19 offset:57344
    ds_read_b64_tr_b16 a[222:223], v183 offset:12288
    s_add_u32 s14, s15, 4096
    ds_read_b64_tr_b16 a[224:225], v15 offset:24576
    ds_read_b64_tr_b16 a[226:227], v15 offset:4096
    buffer_load_dwordx4 a[136:139], v21, s[44:47], s14 offen sc1
    ds_read_b64_tr_b16 a[228:229], v16 offset:24576
    ds_read_b64_tr_b16 a[230:231], v16 offset:4096
    s_waitcnt lgkmcnt(4)
    buffer_load_dwordx4 a[140:143], v22, s[44:47], s14 offen sc1
    s_add_u32 s14, s15, 8192
    buffer_load_dwordx4 a[144:147], v21, s[44:47], s14 offen sc1
    buffer_load_dwordx4 a[148:151], v22, s[44:47], s14 offen sc1
    s_add_u32 s14, s15, 12288
    buffer_load_dwordx4 a[152:155], v21, s[44:47], s14 offen sc1
    buffer_load_dwordx4 a[156:159], v22, s[44:47], s14 offen sc1
    s_mov_b64 exec, s[6:7]
    buffer_load_dword v25, v20, s[48:51], s71 offen offset:384 sc1
    s_mov_b64 exec, -1
    s_add_u32 s14, s15, 16384
    buffer_load_dwordx4 a[160:163], v21, s[44:47], s14 offen sc1
    buffer_load_dwordx4 a[164:167], v22, s[44:47], s14 offen sc1
    s_add_u32 s14, s15, 20480
    buffer_load_dwordx4 a[168:171], v21, s[44:47], s14 offen sc1
    buffer_load_dwordx4 a[172:175], v22, s[44:47], s14 offen sc1
    s_waitcnt vmcnt(11)
    v_mfma_f32_16x16x32_bf16 v[68:71], a[208:211], a[128:131], 0
    s_add_u32 s14, s15, 24576
    ds_read_b64_tr_b16 a[232:233], v18 offset:24576
    ds_read_b64_tr_b16 a[234:235], v18 offset:4096
    v_mfma_f32_16x16x32_bf16 v[34:37], a[208:211], a[132:135], v[34:37]
    buffer_load_dwordx4 a[176:179], v21, s[44:47], s14 offen sc1
    v_mfma_f32_16x16x32_bf16 v[72:75], a[212:215], a[128:131], 0
    ds_read_b64_tr_b16 a[236:237], v19 offset:24576
    v_mfma_f32_16x16x32_bf16 v[38:41], a[212:215], a[132:135], v[38:41]
    ds_read_b64_tr_b16 a[238:239], v19 offset:4096
    v_mfma_f32_16x16x32_bf16 v[76:79], a[216:219], a[128:131], 0
    ds_read_b64_tr_b16 a[240:241], v180 offset:28672
    ds_read_b64_tr_b16 a[242:243], v15 offset:16384
    v_mfma_f32_16x16x32_bf16 v[42:45], a[216:219], a[132:135], v[42:45]
    buffer_load_dwordx4 a[180:183], v22, s[44:47], s14 offen sc1
    v_mfma_f32_16x16x32_bf16 v[80:83], a[220:223], a[128:131], 0
    ds_read_b64_tr_b16 a[244:245], v181 offset:28672
    ds_read_b64_tr_b16 a[246:247], v16 offset:16384
    v_mfma_f32_16x16x32_bf16 v[46:49], a[220:223], a[132:135], v[46:49]
    s_waitcnt vmcnt(11) lgkmcnt(4)
    v_mfma_f32_16x16x32_bf16 v[68:71], a[224:227], a[136:139], v[68:71]
    ds_read_b64_tr_b16 a[248:249], v182 offset:28672
    ds_read_b64_tr_b16 a[250:251], v18 offset:16384
    v_mfma_f32_16x16x32_bf16 v[34:37], a[224:227], a[140:143], v[34:37]
    buffer_load_dwordx4 a[184:187], v21, s[44:47], s57 offen sc1
    v_mfma_f32_16x16x32_bf16 v[72:75], a[228:231], a[136:139], v[72:75]
    ds_read_b64_tr_b16 a[252:253], v183 offset:28672
    v_mfma_f32_16x16x32_bf16 v[38:41], a[228:231], a[140:143], v[38:41]
    ds_read_b64_tr_b16 a[254:255], v19 offset:16384
    v_mfma_f32_16x16x32_bf16 v[76:79], a[232:235], a[136:139], v[76:79]
    ds_read_b64_tr_b16 a[208:209], v15 offset:20480
    ds_read_b64_tr_b16 a[210:211], v180 offset:4096
    v_mfma_f32_16x16x32_bf16 v[42:45], a[232:235], a[140:143], v[42:45]
    buffer_load_dwordx4 a[188:191], v22, s[44:47], s57 offen sc1
    v_mfma_f32_16x16x32_bf16 v[80:83], a[236:239], a[136:139], v[80:83]
    ds_read_b64_tr_b16 a[212:213], v16 offset:20480
    ds_read_b64_tr_b16 a[214:215], v181 offset:4096
    v_mfma_f32_16x16x32_bf16 v[46:49], a[236:239], a[140:143], v[46:49]
    s_waitcnt vmcnt(11) lgkmcnt(4)
    v_mfma_f32_16x16x32_bf16 v[68:71], a[240:243], a[144:147], v[68:71]
    ds_read_b64_tr_b16 a[216:217], v18 offset:20480
    v_mfma_f32_16x16x32_bf16 v[34:37], a[240:243], a[148:151], v[34:37]
    ds_read_b64_tr_b16 a[218:219], v182 offset:4096
    v_mfma_f32_16x16x32_bf16 v[72:75], a[244:247], a[144:147], v[72:75]
    ds_read_b64_tr_b16 a[220:221], v19 offset:20480
    v_mfma_f32_16x16x32_bf16 v[38:41], a[244:247], a[148:151], v[38:41]
    ds_read_b64_tr_b16 a[222:223], v183 offset:4096
    v_mfma_f32_16x16x32_bf16 v[76:79], a[248:251], a[144:147], v[76:79]
    ds_read_b64_tr_b16 a[224:225], v180 offset:8192
    v_mfma_f32_16x16x32_bf16 v[42:45], a[248:251], a[148:151], v[42:45]
    ds_read_b64_tr_b16 a[226:227], v180 offset:16384
    v_mfma_f32_16x16x32_bf16 v[80:83], a[252:255], a[144:147], v[80:83]
    ds_read_b64_tr_b16 a[228:229], v181 offset:8192
    ds_read_b64_tr_b16 a[230:231], v181 offset:16384
    v_mfma_f32_16x16x32_bf16 v[46:49], a[252:255], a[148:151], v[46:49]
    s_waitcnt vmcnt(8) lgkmcnt(4)
    v_cmp_eq_u32 vcc, 0, v25
    s_nop 0
    s_and_b64 vcc, vcc, s[6:7]
    s_cbranch_vccnz L_late6_h14
L_back6_h14:
    s_barrier
    v_mfma_f32_16x16x32_bf16 v[68:71], a[208:211], a[152:155], v[68:71]
    s_add_u32 s14, s16, 262144
    ds_read_b64_tr_b16 a[232:233], v182 offset:8192
    ds_read_b64_tr_b16 a[234:235], v182 offset:16384
    v_mfma_f32_16x16x32_bf16 v[34:37], a[208:211], a[156:159], v[34:37]
    buffer_load_dwordx4 a[192:195], v21, s[48:51], s14 offen sc1
    v_mfma_f32_16x16x32_bf16 v[72:75], a[212:215], a[152:155], v[72:75]
    ds_read_b64_tr_b16 a[236:237], v183 offset:8192
    ds_read_b64_tr_b16 a[238:239], v183 offset:16384
    v_mfma_f32_16x16x32_bf16 v[38:41], a[212:215], a[156:159], v[38:41]
    buffer_load_dwordx4 a[196:199], v22, s[48:51], s14 offen sc1
    v_mfma_f32_16x16x32_bf16 v[76:79], a[216:219], a[152:155], v[76:79]
    ds_read_b64_tr_b16 a[240:241], v180 offset:20480
    v_mfma_f32_16x16x32_bf16 v[42:45], a[216:219], a[156:159], v[42:45]
    ds_read_b64_tr_b16 a[242:243], v15 offset:28672
    v_mfma_f32_16x16x32_bf16 v[80:83], a[220:223], a[152:155], v[80:83]
    ds_read_b64_tr_b16 a[244:245], v181 offset:20480
    ds_read_b64_tr_b16 a[246:247], v16 offset:28672
    v_mfma_f32_16x16x32_bf16 v[46:49], a[220:223], a[156:159], v[46:49]
    s_waitcnt vmcnt(8) lgkmcnt(4)
    v_mfma_f32_16x16x32_bf16 v[68:71], a[224:227], a[160:163], v[68:71]
    s_add_u32 s14, s16, 266240
    ds_read_b64_tr_b16 a[248:249], v182 offset:20480
    ds_read_b64_tr_b16 a[250:251], v18 offset:28672
    v_mfma_f32_16x16x32_bf16 v[34:37], a[224:227], a[164:167], v[34:37]
    buffer_load_dwordx4 a[200:203], v21, s[48:51], s14 offen sc1
    v_mfma_f32_16x16x32_bf16 v[72:75], a[228:231], a[160:163], v[72:75]
    ds_read_b64_tr_b16 a[252:253], v183 offset:20480
    v_mfma_f32_16x16x32_bf16 v[38:41], a[228:231], a[164:167], v[38:41]
    ds_read_b64_tr_b16 a[254:255], v19 offset:28672
    v_mfma_f32_16x16x32_bf16 v[76:79], a[232:235], a[160:163], v[76:79]
    ds_read_b64_tr_b16 a[208:209], v15 offset:0
    ds_read_b64_tr_b16 a[210:211], v15 offset:8192
    v_mfma_f32_16x16x32_bf16 v[42:45], a[232:235], a[164:167], v[42:45]
    buffer_load_dwordx4 a[204:207], v22, s[48:51], s14 offen sc1
    v_mfma_f32_16x16x32_bf16 v[80:83], a[236:239], a[160:163], v[80:83]
    ds_read_b64_tr_b16 a[212:213], v16 offset:0
    ds_read_b64_tr_b16 a[214:215], v16 offset:8192
    v_mfma_f32_16x16x32_bf16 v[46:49], a[236:239], a[164:167], v[46:49]
    s_waitcnt vmcnt(8) lgkmcnt(4)
    v_mfma_f32_16x16x32_bf16 v[68:71], a[240:243], a[168:171], v[68:71]
    s_add_u32 s14, s16, 270336
    ds_read_b64_tr_b16 a[216:217], v18 offset:0
    ds_read_b64_tr_b16 a[218:219], v18 offset:8192
    v_mfma_f32_16x16x32_bf16 v[34:37], a[240:243], a[172:175], v[34:37]
    buffer_load_dwordx4 a[8:11], v21, s[48:51], s14 offen sc1
    v_mfma_f32_16x16x32_bf16 v[72:75], a[244:247], a[168:171], v[72:75]
    ds_read_b64_tr_b16 a[220:221], v19 offset:0
    v_mfma_f32_16x16x32_bf16 v[38:41], a[244:247], a[172:175], v[38:41]
    ds_read_b64_tr_b16 a[222:223], v19 offset:8192
    v_mfma_f32_16x16x32_bf16 v[76:79], a[248:251], a[168:171], v[76:79]
    ds_read_b64_tr_b16 a[224:225], v15 offset:12288
    ds_read_b64_tr_b16 a[226:227], v180 offset:32768
    v_mfma_f32_16x16x32_bf16 v[42:45], a[248:251], a[172:175], v[42:45]
    buffer_load_dwordx4 a[12:15], v22, s[48:51], s14 offen sc1
    v_mfma_f32_16x16x32_bf16 v[80:83], a[252:255], a[168:171], v[80:83]
    ds_read_b64_tr_b16 a[228:229], v16 offset:12288
    ds_read_b64_tr_b16 a[230:231], v181 offset:32768
    v_mfma_f32_16x16x32_bf16 v[46:49], a[252:255], a[172:175], v[46:49]
    s_waitcnt vmcnt(8) lgkmcnt(4)
    v_mfma_f32_16x16x32_bf16 v[68:71], a[208:211], a[176:179], v[68:71]
    s_add_u32 s14, s16, 274432
    ds_read_b64_tr_b16 a[232:233], v18 offset:12288
    ds_read_b64_tr_b16 a[234:235], v182 offset:32768
    v_mfma_f32_16x16x32_bf16 v[34:37], a[208:211], a[180:183], v[34:37]
    buffer_load_dwordx4 a[24:27], v21, s[48:51], s14 offen sc1
    v_mfma_f32_16x16x32_bf16 v[72:75], a[212:215], a[176:179], v[72:75]
    ds_read_b64_tr_b16 a[236:237], v19 offset:12288
    v_mfma_f32_16x16x32_bf16 v[38:41], a[212:215], a[180:183], v[38:41]
    ds_read_b64_tr_b16 a[238:239], v183 offset:32768
    v_mfma_f32_16x16x32_bf16 v[76:79], a[216:219], a[176:179], v[76:79]
    ds_read_b64_tr_b16 a[240:241], v180 offset:36864
    ds_read_b64_tr_b16 a[242:243], v180 offset:40960
    v_mfma_f32_16x16x32_bf16 v[42:45], a[216:219], a[180:183], v[42:45]
    buffer_load_dwordx4 a[28:31], v22, s[48:51], s14 offen sc1
    s_waitcnt vmcnt(8)
    s_barrier
    v_mfma_f32_16x16x32_bf16 v[80:83], a[220:223], a[176:179], v[80:83]
    ds_read_b64_tr_b16 a[244:245], v181 offset:36864
    ds_read_b64_tr_b16 a[246:247], v181 offset:40960
    v_mfma_f32_16x16x32_bf16 v[46:49], a[220:223], a[180:183], v[46:49]
    s_waitcnt lgkmcnt(4)
    s_mov_b64 exec, s[4:5]
    buffer_store_dword v2, off, s[48:51], s79 offset:512
    s_mov_b64 exec, -1
    v_mfma_f32_16x16x32_bf16 v[68:71], a[224:227], a[184:187], v[68:71]
    s_add_u32 m0, s66, 32768
    ds_read_b64_tr_b16 a[248:249], v182 offset:36864
    ds_read_b64_tr_b16 a[250:251], v182 offset:40960
    v_mfma_f32_16x16x32_bf16 v[34:37], a[224:227], a[188:191], v[34:37]
    buffer_load_dwordx4 v65, s[40:43], s52 offen lds
    v_mfma_f32_16x16x32_bf16 v[72:75], a[228:231], a[184:187], v[72:75]
    ds_read_b64_tr_b16 a[252:253], v183 offset:36864
    v_mfma_f32_16x16x32_bf16 v[38:41], a[228:231], a[188:191], v[38:41]
    ds_read_b64_tr_b16 a[254:255], v183 offset:40960
    v_mfma_f32_16x16x32_bf16 v[76:79], a[232:235], a[184:187], v[76:79]
    s_add_u32 s14, s16, 278528
    ds_read_b64_tr_b16 a[208:209], v180 offset:45056
    ds_read_b64_tr_b16 a[210:211], v180 offset:49152
    v_mfma_f32_16x16x32_bf16 v[42:45], a[232:235], a[188:191], v[42:45]
    buffer_load_dwordx4 a[40:43], v21, s[48:51], s14 offen sc1
    v_mfma_f32_16x16x32_bf16 v[80:83], a[236:239], a[184:187], v[80:83]
    ds_read_b64_tr_b16 a[212:213], v181 offset:45056
    ds_read_b64_tr_b16 a[214:215], v181 offset:49152
    v_mfma_f32_16x16x32_bf16 v[46:49], a[236:239], a[188:191], v[46:49]
    s_waitcnt lgkmcnt(4)
    buffer_load_dwordx4 a[44:47], v22, s[48:51], s14 offen sc1
    s_add_u32 m0, s66, 40960
    s_nop 0
    buffer_load_dwordx4 v66, s[40:43], s52 offen lds
    s_waitcnt vmcnt(11)
    v_mfma_f32_16x16x32_bf16 v[68:71], a[240:243], a[192:195], v[68:71]
    s_add_u32 m0, s66, 45056
    ds_read_b64_tr_b16 a[216:217], v182 offset:45056
    ds_read_b64_tr_b16 a[218:219], v182 offset:49152
    v_mfma_f32_16x16x32_bf16 v[34:37], a[240:243], a[196:199], v[34:37]
    buffer_load_dwordx4 v67, s[40:43], s52 offen lds
    v_mfma_f32_16x16x32_bf16 v[72:75], a[244:247], a[192:195], v[72:75]
    ds_read_b64_tr_b16 a[220:221], v183 offset:45056
    v_mfma_f32_16x16x32_bf16 v[38:41], a[244:247], a[196:199], v[38:41]
    ds_read_b64_tr_b16 a[222:223], v183 offset:49152
    v_mfma_f32_16x16x32_bf16 v[76:79], a[248:251], a[192:195], v[76:79]
    s_add_u32 s14, s16, 282624
    ds_read_b64_tr_b16 a[224:225], v180 offset:53248
    ds_read_b64_tr_b16 a[226:227], v180 offset:57344
    v_mfma_f32_16x16x32_bf16 v[42:45], a[248:251], a[196:199], v[42:45]
    buffer_load_dwordx4 a[56:59], v21, s[48:51], s14 offen sc1
    v_mfma_f32_16x16x32_bf16 v[80:83], a[252:255], a[192:195], v[80:83]
    ds_read_b64_tr_b16 a[228:229], v181 offset:53248
    ds_read_b64_tr_b16 a[230:231], v181 offset:57344
    v_mfma_f32_16x16x32_bf16 v[46:49], a[252:255], a[196:199], v[46:49]
    s_waitcnt vmcnt(11) lgkmcnt(4)
    v_mfma_f32_16x16x32_bf16 v[68:71], a[208:211], a[200:203], v[68:71]
    ds_read_b64_tr_b16 a[232:233], v182 offset:53248
    ds_read_b64_tr_b16 a[234:235], v182 offset:57344
    v_mfma_f32_16x16x32_bf16 v[34:37], a[208:211], a[204:207], v[34:37]
    buffer_load_dwordx4 a[60:63], v22, s[48:51], s14 offen sc1
    v_mfma_f32_16x16x32_bf16 v[72:75], a[212:215], a[200:203], v[72:75]
    ds_read_b64_tr_b16 a[236:237], v183 offset:53248
    ds_read_b64_tr_b16 a[238:239], v183 offset:57344
    v_mfma_f32_16x16x32_bf16 v[38:41], a[212:215], a[204:207], v[38:41]
    v_add_u32 v184, 131072, v15
    v_mfma_f32_16x16x32_bf16 v[76:79], a[216:219], a[200:203], v[76:79]
    s_add_u32 m0, s66, 53248
    s_add_u32 s52, s55, 786432
    ds_read_b64_tr_b16 a[240:241], v180 offset:61440
    ds_read_b64_tr_b16 a[242:243], v184 offset:0
    v_mfma_f32_16x16x32_bf16 v[42:45], a[216:219], a[204:207], v[42:45]
    buffer_load_dwordx4 v64, s[40:43], s52 offen lds
    v_add_u32 v185, 131072, v16
    v_mfma_f32_16x16x32_bf16 v[80:83], a[220:223], a[200:203], v[80:83]
    ds_read_b64_tr_b16 a[244:245], v181 offset:61440
    ds_read_b64_tr_b16 a[246:247], v185 offset:0
    v_mfma_f32_16x16x32_bf16 v[46:49], a[220:223], a[204:207], v[46:49]
    s_waitcnt lgkmcnt(4)
    v_add_u32 v186, 131072, v18
    s_waitcnt vmcnt(11)
    v_mfma_f32_16x16x32_bf16 v[68:71], a[224:227], a[8:11], v[68:71]
    s_add_u32 m0, s66, 57344
    ds_read_b64_tr_b16 a[248:249], v182 offset:61440
    ds_read_b64_tr_b16 a[250:251], v186 offset:0
    v_mfma_f32_16x16x32_bf16 v[34:37], a[224:227], a[12:15], v[34:37]
    buffer_load_dwordx4 v65, s[40:43], s52 offen lds
    v_add_u32 v187, 131072, v19
    v_mfma_f32_16x16x32_bf16 v[72:75], a[228:231], a[8:11], v[72:75]
    ds_read_b64_tr_b16 a[252:253], v183 offset:61440
    v_mfma_f32_16x16x32_bf16 v[38:41], a[228:231], a[12:15], v[38:41]
    ds_read_b64_tr_b16 a[254:255], v187 offset:0
    v_mfma_f32_16x16x32_bf16 v[76:79], a[232:235], a[8:11], v[76:79]
    s_add_u32 s14, s16, 286720
    ds_read_b64_tr_b16 a[208:209], v184 offset:4096
    ds_read_b64_tr_b16 a[210:211], v184 offset:8192
    v_mfma_f32_16x16x32_bf16 v[42:45], a[232:235], a[12:15], v[42:45]
    buffer_load_dwordx4 a[72:75], v21, s[48:51], s14 offen sc1
    v_mfma_f32_16x16x32_bf16 v[80:83], a[236:239], a[8:11], v[80:83]
    ds_read_b64_tr_b16 a[212:213], v185 offset:4096
    ds_read_b64_tr_b16 a[214:215], v185 offset:8192
    v_mfma_f32_16x16x32_bf16 v[46:49], a[236:239], a[12:15], v[46:49]
    s_waitcnt lgkmcnt(4)
    s_mov_b64 exec, s[6:7]
    buffer_load_dword v3, v20, s[48:51], s71 offen offset:512 sc1
    s_mov_b64 exec, -1
    s_waitcnt vmcnt(12)
    v_mfma_f32_16x16x32_bf16 v[68:71], a[240:243], a[24:27], v[68:71]
    ds_read_b64_tr_b16 a[216:217], v186 offset:4096
    ds_read_b64_tr_b16 a[218:219], v186 offset:8192
    v_mfma_f32_16x16x32_bf16 v[34:37], a[240:243], a[28:31], v[34:37]
    buffer_load_dwordx4 a[76:79], v22, s[48:51], s14 offen sc1
    v_mfma_f32_16x16x32_bf16 v[72:75], a[244:247], a[24:27], v[72:75]
    ds_read_b64_tr_b16 a[220:221], v187 offset:4096
    v_mfma_f32_16x16x32_bf16 v[38:41], a[244:247], a[28:31], v[38:41]
    ds_read_b64_tr_b16 a[222:223], v187 offset:8192
    v_mfma_f32_16x16x32_bf16 v[76:79], a[248:251], a[24:27], v[76:79]
    ds_read_b64_tr_b16 a[224:225], v184 offset:12288
    v_mfma_f32_16x16x32_bf16 v[42:45], a[248:251], a[28:31], v[42:45]
    ds_read_b64_tr_b16 a[226:227], v184 offset:16384
    v_mfma_f32_16x16x32_bf16 v[80:83], a[252:255], a[24:27], v[80:83]
    s_add_u32 m0, s66, 77824
    ds_read_b64_tr_b16 a[228:229], v185 offset:12288
    ds_read_b64_tr_b16 a[230:231], v185 offset:16384
    v_mfma_f32_16x16x32_bf16 v[46:49], a[252:255], a[28:31], v[46:49]
    s_waitcnt lgkmcnt(4)
    buffer_load_dwordx4 v66, s[40:43], s52 offen lds
    s_add_u32 m0, s66, 24576
    s_nop 0
    buffer_load_dwordx4 v67, s[40:43], s52 offen lds
    s_waitcnt vmcnt(11)
    v_mfma_f32_16x16x32_bf16 v[68:71], a[208:211], a[40:43], v[68:71]
    s_add_u32 m0, s66, 4096
    s_add_u32 s52, s55, 1179648
    ds_read_b64_tr_b16 a[232:233], v186 offset:12288
    ds_read_b64_tr_b16 a[234:235], v186 offset:16384
    v_mfma_f32_16x16x32_bf16 v[34:37], a[208:211], a[44:47], v[34:37]
    buffer_load_dwordx4 v64, s[40:43], s52 offen lds
    v_mfma_f32_16x16x32_bf16 v[72:75], a[212:215], a[40:43], v[72:75]
    ds_read_b64_tr_b16 a[236:237], v187 offset:12288
    v_mfma_f32_16x16x32_bf16 v[38:41], a[212:215], a[44:47], v[38:41]
    ds_read_b64_tr_b16 a[238:239], v187 offset:16384
    v_mfma_f32_16x16x32_bf16 v[76:79], a[216:219], a[40:43], v[76:79]
    s_add_u32 m0, s66, 94208
    ds_read_b64_tr_b16 a[240:241], v184 offset:20480
    ds_read_b64_tr_b16 a[242:243], v184 offset:24576
    v_mfma_f32_16x16x32_bf16 v[42:45], a[216:219], a[44:47], v[42:45]
    buffer_load_dwordx4 v65, s[40:43], s52 offen lds
    v_mfma_f32_16x16x32_bf16 v[80:83], a[220:223], a[40:43], v[80:83]
    ds_read_b64_tr_b16 a[244:245], v185 offset:20480
    ds_read_b64_tr_b16 a[246:247], v185 offset:24576
    v_mfma_f32_16x16x32_bf16 v[46:49], a[220:223], a[44:47], v[46:49]
    s_waitcnt vmcnt(9) lgkmcnt(4)
    v_mfma_f32_16x16x32_bf16 v[68:71], a[224:227], a[56:59], v[68:71]
    ds_read_b64_tr_b16 a[248:249], v186 offset:20480
    v_mfma_f32_16x16x32_bf16 v[34:37], a[224:227], a[60:63], v[34:37]
    ds_read_b64_tr_b16 a[250:251], v186 offset:24576
    v_mfma_f32_16x16x32_bf16 v[72:75], a[228:231], a[56:59], v[72:75]
    ds_read_b64_tr_b16 a[252:253], v187 offset:20480
    v_mfma_f32_16x16x32_bf16 v[38:41], a[228:231], a[60:63], v[38:41]
    ds_read_b64_tr_b16 a[254:255], v187 offset:24576
    v_mfma_f32_16x16x32_bf16 v[76:79], a[232:235], a[56:59], v[76:79]
    ds_read_b64_tr_b16 a[208:209], v15 offset:36864
    v_mfma_f32_16x16x32_bf16 v[42:45], a[232:235], a[60:63], v[42:45]
    ds_read_b64_tr_b16 a[210:211], v15 offset:49152
    v_mfma_f32_16x16x32_bf16 v[80:83], a[236:239], a[56:59], v[80:83]
    ds_read_b64_tr_b16 a[212:213], v16 offset:36864
    ds_read_b64_tr_b16 a[214:215], v16 offset:49152
    v_mfma_f32_16x16x32_bf16 v[46:49], a[236:239], a[60:63], v[46:49]
    s_waitcnt vmcnt(5) lgkmcnt(4)
    v_cmp_eq_u32 vcc, 0, v3
    s_nop 0
    s_and_b64 vcc, vcc, s[6:7]
    s_cbranch_vccnz L_late8_h14
L_back8_h14:
    s_barrier
    s_add_u32 s14, s16, 0
    buffer_load_dwordx4 a[88:91], v21, s[48:51], s14 offen sc1
    buffer_load_dwordx4 a[92:95], v22, s[48:51], s14 offen sc1
    s_add_u32 s14, s16, 4096
    buffer_load_dwordx4 a[104:107], v21, s[48:51], s14 offen sc1
    buffer_load_dwordx4 a[108:111], v22, s[48:51], s14 offen sc1
    s_lshl2_add_u32 s67, s66, 98304
    v_add_u32 v4, s67, v17
    s_xor_b32 s68, s66, 1024
    s_lshl2_add_u32 s68, s68, 98304
    v_add_u32 v5, s68, v17
    s_add_u32 s67, s76, 114688
    v_add_u32 v171, s67, v17
    v_lshrrev_b32 v63, 1, v32
    v_and_b32 v168, 7, v1
    v_xor_b32 v63, v63, v168
    v_lshlrev_b32 v63, 4, v63
    v_lshl_add_u32 v63, v31, 7, v63
    v_lshrrev_b32 v6, 3, v1
    v_xor_b32 v168, v168, v6
    v_lshlrev_b32 v168, 4, v168
    v_lshl_add_u32 v6, v6, 10, v168
    v_and_b32 v168, 1, v32
    v_lshlrev_b32 v168, 3, v168
    s_waitcnt vmcnt(8)
    v_mfma_f32_16x16x32_bf16 v[68:71], a[240:243], a[72:75], v[68:71]
    s_add_u32 s14, s16, 8192
    ds_read_b64_tr_b16 a[216:217], v18 offset:36864
    ds_read_b64_tr_b16 a[218:219], v18 offset:49152
    v_mfma_f32_16x16x32_bf16 v[34:37], a[240:243], a[76:79], v[34:37]
    buffer_load_dwordx4 a[120:123], v21, s[48:51], s14 offen sc1
    v_add3_u32 v63, v63, v168, s67
    v_mfma_f32_16x16x32_bf16 v[72:75], a[244:247], a[72:75], v[72:75]
    ds_read_b64_tr_b16 a[220:221], v19 offset:36864
    ds_read_b64_tr_b16 a[222:223], v19 offset:49152
    v_mfma_f32_16x16x32_bf16 v[38:41], a[244:247], a[76:79], v[38:41]
    v_xor_b32 v168, 32, v63
    v_xor_b32 v169, 64, v63
    v_mfma_f32_16x16x32_bf16 v[76:79], a[248:251], a[72:75], v[76:79]
    ds_read_b64_tr_b16 a[224:225], v15 offset:61440
    ds_read_b64_tr_b16 a[226:227], v180 offset:0
    v_mfma_f32_16x16x32_bf16 v[42:45], a[248:251], a[76:79], v[42:45]
    buffer_load_dwordx4 a[124:127], v22, s[48:51], s14 offen sc1
    v_xor_b32 v170, 96, v63
    v_mfma_f32_16x16x32_bf16 v[80:83], a[252:255], a[72:75], v[80:83]
    ds_read_b64_tr_b16 a[228:229], v16 offset:61440
    ds_read_b64_tr_b16 a[230:231], v181 offset:0
    v_mfma_f32_16x16x32_bf16 v[46:49], a[252:255], a[76:79], v[46:49]
    s_waitcnt lgkmcnt(4)
    s_lshl2_add_u32 s67, s65, s60
    s_lshl_b32 s67, s67, 14
    s_add_u32 s67, s67, s78
    s_add_u32 s68, s67, 8192
    s_add_u32 s14, s16, 12288
    buffer_load_dwordx4 a[0:3], v21, s[48:51], s14 offen sc1
    buffer_load_dwordx4 a[4:7], v22, s[48:51], s14 offen sc1
    s_add_u32 s14, s16, 16384
    buffer_load_dwordx4 a[16:19], v21, s[48:51], s14 offen sc1
    buffer_load_dwordx4 a[20:23], v22, s[48:51], s14 offen sc1
    s_waitcnt vmcnt(8)
    v_mfma_f32_16x16x32_bf16 v[68:71], a[208:211], a[88:91], v[68:71]
    s_add_u32 s14, s16, 20480
    ds_read_b64_tr_b16 a[232:233], v18 offset:61440
    ds_read_b64_tr_b16 a[234:235], v182 offset:0
    v_mfma_f32_16x16x32_bf16 v[34:37], a[208:211], a[92:95], v[34:37]
    buffer_load_dwordx4 a[32:35], v21, s[48:51], s14 offen sc1
    v_mfma_f32_16x16x32_bf16 v[72:75], a[212:215], a[88:91], v[72:75]
    ds_read_b64_tr_b16 a[236:237], v19 offset:61440
    v_mfma_f32_16x16x32_bf16 v[38:41], a[212:215], a[92:95], v[38:41]
    ds_read_b64_tr_b16 a[238:239], v183 offset:0
    v_mfma_f32_16x16x32_bf16 v[76:79], a[216:219], a[88:91], v[76:79]
    ds_read_b64_tr_b16 a[240:241], v180 offset:24576
    ds_read_b64_tr_b16 a[242:243], v15 offset:32768
    v_mfma_f32_16x16x32_bf16 v[42:45], a[216:219], a[92:95], v[42:45]
    buffer_load_dwordx4 a[36:39], v22, s[48:51], s14 offen sc1
    v_mfma_f32_16x16x32_bf16 v[80:83], a[220:223], a[88:91], v[80:83]
    ds_read_b64_tr_b16 a[244:245], v181 offset:24576
    ds_read_b64_tr_b16 a[246:247], v16 offset:32768
    v_mfma_f32_16x16x32_bf16 v[46:49], a[220:223], a[92:95], v[46:49]
    s_waitcnt vmcnt(8) lgkmcnt(4)
    v_mfma_f32_16x16x32_bf16 v[68:71], a[224:227], a[104:107], v[68:71]
    s_add_u32 s14, s16, 24576
    ds_read_b64_tr_b16 a[248:249], v182 offset:24576
    ds_read_b64_tr_b16 a[250:251], v18 offset:32768
    v_mfma_f32_16x16x32_bf16 v[34:37], a[224:227], a[108:111], v[34:37]
    buffer_load_dwordx4 a[48:51], v21, s[48:51], s14 offen sc1
    v_mfma_f32_16x16x32_bf16 v[72:75], a[228:231], a[104:107], v[72:75]
    ds_read_b64_tr_b16 a[252:253], v183 offset:24576
    v_mfma_f32_16x16x32_bf16 v[38:41], a[228:231], a[108:111], v[38:41]
    ds_read_b64_tr_b16 a[254:255], v19 offset:32768
    v_mfma_f32_16x16x32_bf16 v[76:79], a[232:235], a[104:107], v[76:79]
    ds_read_b64_tr_b16 a[208:209], v15 offset:40960
    ds_read_b64_tr_b16 a[210:211], v15 offset:45056
    v_mfma_f32_16x16x32_bf16 v[42:45], a[232:235], a[108:111], v[42:45]
    buffer_load_dwordx4 a[52:55], v22, s[48:51], s14 offen sc1
    v_mfma_f32_16x16x32_bf16 v[80:83], a[236:239], a[104:107], v[80:83]
    ds_read_b64_tr_b16 a[212:213], v16 offset:40960
    ds_read_b64_tr_b16 a[214:215], v16 offset:45056
    v_mfma_f32_16x16x32_bf16 v[46:49], a[236:239], a[108:111], v[46:49]
    s_waitcnt vmcnt(8) lgkmcnt(4)
    v_mfma_f32_16x16x32_bf16 v[68:71], a[240:243], a[120:123], v[68:71]
    ds_read_b64_tr_b16 a[216:217], v18 offset:40960
    v_mfma_f32_16x16x32_bf16 v[34:37], a[240:243], a[124:127], v[34:37]
    ds_read_b64_tr_b16 a[218:219], v18 offset:45056
    v_mfma_f32_16x16x32_bf16 v[72:75], a[244:247], a[120:123], v[72:75]
    ds_read_b64_tr_b16 a[220:221], v19 offset:40960
    ds_read_b64_tr_b16 a[222:223], v19 offset:45056
    v_mfma_f32_16x16x32_bf16 v[38:41], a[244:247], a[124:127], v[38:41]
    s_barrier
    v_mfma_f32_16x16x32_bf16 v[76:79], a[248:251], a[120:123], v[76:79]
    ds_read_b64_tr_b16 a[224:225], v15 offset:53248
    v_mfma_f32_16x16x32_bf16 v[42:45], a[248:251], a[124:127], v[42:45]
    ds_read_b64_tr_b16 a[226:227], v15 offset:57344
    v_mfma_f32_16x16x32_bf16 v[80:83], a[252:255], a[120:123], v[80:83]
    ds_read_b64_tr_b16 a[228:229], v16 offset:53248
    ds_read_b64_tr_b16 a[230:231], v16 offset:57344
    v_mfma_f32_16x16x32_bf16 v[46:49], a[252:255], a[124:127], v[46:49]
    s_waitcnt vmcnt(6) lgkmcnt(4)
    v_mfma_f32_16x16x32_bf16 v[68:71], a[208:211], a[0:3], v[68:71]
    ds_read_b64_tr_b16 a[232:233], v18 offset:53248
    v_mfma_f32_16x16x32_bf16 v[34:37], a[208:211], a[4:7], v[34:37]
    ds_read_b64_tr_b16 a[234:235], v18 offset:57344
    v_mfma_f32_16x16x32_bf16 v[72:75], a[212:215], a[0:3], v[72:75]
    ds_read_b64_tr_b16 a[236:237], v19 offset:53248
    v_mfma_f32_16x16x32_bf16 v[38:41], a[212:215], a[4:7], v[38:41]
    ds_read_b64_tr_b16 a[238:239], v19 offset:57344
    v_mfma_f32_16x16x32_bf16 v[76:79], a[216:219], a[0:3], v[76:79]
    ds_read_b64_tr_b16 a[240:241], v180 offset:12288
    v_mfma_f32_16x16x32_bf16 v[42:45], a[216:219], a[4:7], v[42:45]
    ds_read_b64_tr_b16 a[242:243], v15 offset:24576
    v_mfma_f32_16x16x32_bf16 v[80:83], a[220:223], a[0:3], v[80:83]
    ds_read_b64_tr_b16 a[244:245], v181 offset:12288
    ds_read_b64_tr_b16 a[246:247], v16 offset:24576
    v_mfma_f32_16x16x32_bf16 v[46:49], a[220:223], a[4:7], v[46:49]
    s_waitcnt vmcnt(4) lgkmcnt(4)
    v_mfma_f32_16x16x32_bf16 v[68:71], a[224:227], a[16:19], v[68:71]
    ds_read_b64_tr_b16 a[248:249], v182 offset:12288
    v_mfma_f32_16x16x32_bf16 v[34:37], a[224:227], a[20:23], v[34:37]
    ds_read_b64_tr_b16 a[250:251], v18 offset:24576
    v_mfma_f32_16x16x32_bf16 v[72:75], a[228:231], a[16:19], v[72:75]
    ds_read_b64_tr_b16 a[252:253], v183 offset:12288
    v_mfma_f32_16x16x32_bf16 v[38:41], a[228:231], a[20:23], v[38:41]
    ds_read_b64_tr_b16 a[254:255], v19 offset:24576
    v_mfma_f32_16x16x32_bf16 v[76:79], a[232:235], a[16:19], v[76:79]
    ds_read_b64_tr_b16 a[208:209], v15 offset:4096
    v_mfma_f32_16x16x32_bf16 v[42:45], a[232:235], a[20:23], v[42:45]
    ds_read_b64_tr_b16 a[210:211], v180 offset:28672
    v_mfma_f32_16x16x32_bf16 v[80:83], a[236:239], a[16:19], v[80:83]
    ds_read_b64_tr_b16 a[212:213], v16 offset:4096
    ds_read_b64_tr_b16 a[214:215], v181 offset:28672
    v_mfma_f32_16x16x32_bf16 v[46:49], a[236:239], a[20:23], v[46:49]
    s_waitcnt vmcnt(3) lgkmcnt(4)
    v_mfma_f32_16x16x32_bf16 v[68:71], a[240:243], a[32:35], v[68:71]
    ds_read_b64_tr_b16 a[216:217], v18 offset:4096
    v_mfma_f32_16x16x32_bf16 v[72:75], a[244:247], a[32:35], v[72:75]
    ds_read_b64_tr_b16 a[218:219], v182 offset:28672
    v_mfma_f32_16x16x32_bf16 v[76:79], a[248:251], a[32:35], v[76:79]
    ds_read_b64_tr_b16 a[220:221], v19 offset:4096
    ds_read_b64_tr_b16 a[222:223], v183 offset:28672
    v_mfma_f32_16x16x32_bf16 v[80:83], a[252:255], a[32:35], v[80:83]
    s_waitcnt vmcnt(1) lgkmcnt(6)
    v_mfma_f32_16x16x32_bf16 v[68:71], a[208:211], a[48:51], v[68:71]
    s_waitcnt lgkmcnt(4)
    v_mfma_f32_16x16x32_bf16 v[72:75], a[212:215], a[48:51], v[72:75]
    s_waitcnt lgkmcnt(2)
    v_mfma_f32_16x16x32_bf16 v[76:79], a[216:219], a[48:51], v[76:79]
    s_waitcnt lgkmcnt(0)
    v_mfma_f32_16x16x32_bf16 v[80:83], a[220:223], a[48:51], v[80:83]
    v_mfma_f32_16x16x32_bf16 v[34:37], a[240:243], a[36:39], v[34:37]
    v_mfma_f32_16x16x32_bf16 v[38:41], a[244:247], a[36:39], v[38:41]
    ds_write_b128 v4, v[68:71] offset:0
    v_mfma_f32_16x16x32_bf16 v[42:45], a[248:251], a[36:39], v[42:45]
    ds_write_b128 v4, v[72:75] offset:1024
    v_mfma_f32_16x16x32_bf16 v[46:49], a[252:255], a[36:39], v[46:49]
    ds_write_b128 v4, v[76:79] offset:2048
    s_waitcnt vmcnt(0)
    v_mfma_f32_16x16x32_bf16 v[34:37], a[208:211], a[52:55], v[34:37]
    ds_write_b128 v4, v[80:83] offset:3072
    v_mfma_f32_16x16x32_bf16 v[38:41], a[212:215], a[52:55], v[38:41]
    v_mfma_f32_16x16x32_bf16 v[42:45], a[216:219], a[52:55], v[42:45]
    v_mfma_f32_16x16x32_bf16 v[46:49], a[220:223], a[52:55], v[46:49]
    s_waitcnt lgkmcnt(0)
    s_barrier
    ds_read_b128 v[84:87], v5 offset:0
    ds_read_b128 v[88:91], v5 offset:1024
    ds_read_b128 v[92:95], v5 offset:2048
    ds_read_b128 v[96:99], v5 offset:3072
    s_waitcnt lgkmcnt(3)
    v_pk_add_f32 v[34:35], v[34:35], v[84:85]
    v_pk_add_f32 v[36:37], v[36:37], v[86:87]
    v_cvt_pk_bf16_f32 v132, v34, v35
    v_cvt_pk_bf16_f32 v133, v36, v37
    ds_write_b64 v63, v[132:133]
    s_waitcnt lgkmcnt(3)
    v_pk_add_f32 v[38:39], v[38:39], v[88:89]
    v_pk_add_f32 v[40:41], v[40:41], v[90:91]
    v_cvt_pk_bf16_f32 v134, v38, v39
    v_cvt_pk_bf16_f32 v135, v40, v41
    ds_write_b64 v168, v[134:135]
    s_waitcnt lgkmcnt(3)
    v_pk_add_f32 v[42:43], v[42:43], v[92:93]
    v_pk_add_f32 v[44:45], v[44:45], v[94:95]
    v_cvt_pk_bf16_f32 v136, v42, v43
    v_cvt_pk_bf16_f32 v137, v44, v45
    ds_write_b64 v169, v[136:137]
    s_waitcnt lgkmcnt(3)
    v_pk_add_f32 v[46:47], v[46:47], v[96:97]
    v_pk_add_f32 v[48:49], v[48:49], v[98:99]
    v_cvt_pk_bf16_f32 v138, v46, v47
    v_cvt_pk_bf16_f32 v139, v48, v49
    ds_write_b64 v170, v[138:139]
    ds_read_b128 v[56:59], v171 offset:0
    ds_read_b128 v[140:143], v171 offset:1024
    s_waitcnt lgkmcnt(1)
    buffer_store_dwordx4 v[56:59], v6, s[44:47], s67 offen nt
    s_waitcnt lgkmcnt(0)
    buffer_store_dwordx4 v[140:143], v6, s[44:47], s68 offen nt
L_main_end_h14:
    s_endpgm
L_late2_h14:
    s_mov_b64 exec, s[6:7]
    s_mov_b32 s70, 0x20000
L_poll3_h14:
    buffer_load_dword v3, v20, s[48:51], s71 offen offset:128 sc1
    s_waitcnt vmcnt(0)
    v_cmp_eq_u32 vcc, 0, v3
    s_sub_u32 s70, s70, 1
    s_cbranch_scc1 L_pd3_h14
    s_cbranch_vccnz L_poll3_h14
L_pd3_h14:
    s_mov_b64 exec, -1
    s_branch L_back2_h14
L_late4_h14:
    s_mov_b64 exec, s[6:7]
    s_mov_b32 s70, 0x20000
L_poll5_h14:
    buffer_load_dword v33, v20, s[48:51], s71 offen offset:256 sc1
    s_waitcnt vmcnt(0)
    v_cmp_eq_u32 vcc, 0, v33
    s_sub_u32 s70, s70, 1
    s_cbranch_scc1 L_pd5_h14
    s_cbranch_vccnz L_poll5_h14
L_pd5_h14:
    s_mov_b64 exec, -1
    s_branch L_back4_h14
L_late6_h14:
    s_mov_b64 exec, s[6:7]
    s_mov_b32 s70, 0x20000
L_poll7_h14:
    buffer_load_dword v25, v20, s[48:51], s71 offen offset:384 sc1
    s_waitcnt vmcnt(0)
    v_cmp_eq_u32 vcc, 0, v25
    s_sub_u32 s70, s70, 1
    s_cbranch_scc1 L_pd7_h14
    s_cbranch_vccnz L_poll7_h14
L_pd7_h14:
    s_mov_b64 exec, -1
    s_branch L_back6_h14
L_late8_h14:
    s_mov_b64 exec, s[6:7]
    s_mov_b32 s70, 0x20000
L_poll9_h14:
    buffer_load_dword v3, v20, s[48:51], s71 offen offset:512 sc1
    s_waitcnt vmcnt(0)
    v_cmp_eq_u32 vcc, 0, v3
    s_sub_u32 s70, s70, 1
    s_cbranch_scc1 L_pd9_h14
    s_cbranch_vccnz L_poll9_h14
L_pd9_h14:
    s_mov_b64 exec, -1
    s_branch L_back8_h14
L_help15:
    s_waitcnt lgkmcnt(0)
    s_mov_b64 exec, s[6:7]
    buffer_load_dword v3, v20, s[48:51], s71 offen offset:128 sc1
    s_mov_b64 exec, -1
    s_add_u32 m0, s66, 102400
    s_add_u32 m0, s66, 106496
    s_add_u32 m0, s66, 110592
    s_add_u32 m0, s66, 114688
    s_waitcnt vmcnt(0)
    v_cmp_eq_u32 vcc, 0, v3
    s_nop 0
    s_and_b64 vcc, vcc, s[6:7]
    s_cbranch_vccnz L_late2_h15
L_back2_h15:
    s_barrier
    s_mov_b64 exec, s[4:5]
    buffer_store_dword v2, off, s[48:51], s79 offset:256
    s_mov_b64 exec, -1
    s_mov_b64 exec, s[4:5]
    buffer_store_dword v2, off, s[48:51], s79 offset:384
    s_mov_b64 exec, -1
    s_lshl2_add_u32 s75, s64, s60
    s_mul_i32 s75, s75, 22016
    buffer_load_dword v24, v12, s[40:43], s75 offen sc1
    s_add_u32 s75, s75, 8192
    buffer_load_dword v24, v12, s[40:43], s75 offen sc1
    s_add_u32 s75, s75, 8192
    s_mov_b32 exec_hi, 0xfff
    buffer_load_dword v24, v12, s[40:43], s75 offen sc1
    s_add_u32 s75, s75, 8192
    s_mov_b32 exec_hi, -1
    s_add_u32 s10, s66, s73
    s_add_u32 s10, s10, 131072
    s_lshl_b32 s68, s60, 15
    s_lshl_b32 s69, s62, 11
    s_add_u32 s69, s69, s68
    s_add_u32 s12, s69, s73
    s_lshl_b32 s15, s64, 17
    s_add_u32 s11, s15, s69
    s_lshr_b32 s68, s60, 1
    s_lshl1_add_u32 s68, s63, s68
    s_lshl_b32 s68, s68, 15
    s_add_u32 s15, s15, s68
    s_add_u32 s16, s73, s68
    s_and_b32 s58, s60, 1
    s_lshl_b32 s57, s58, 30
    s_add_u32 s57, s57, s15
    s_add_u32 s3, s3, 4096
    s_add_u32 s57, s57, 28672
    s_mul_i32 s68, s58, 3072
    v_add_u32 v22, s68, v17
    v_xor_b32 v21, 1024, v22
    v_lshl_add_u32 v15, s58, 11, v7
    v_lshl_add_u32 v16, s58, 11, v8
    v_lshl_add_u32 v18, s58, 11, v9
    v_lshl_add_u32 v19, s58, 11, v10
    s_add_u32 s3, s3, 4096
    s_add_u32 s3, s3, 4096
    s_add_u32 s3, s3, 4096
    v_add_u32 v172, 65536, v11
    s_add_u32 s3, s3, 4096
    v_add_u32 v173, 65536, v14
    s_add_u32 s3, s3, 4096
    s_barrier
    s_add_u32 s3, s3, 4096
    s_add_u32 m0, s66, 118784
    s_add_u32 m0, s66, 122880
    s_add_u32 m0, s66, 126976
    s_add_u32 m0, s66, 131072
    s_add_u32 m0, s66, 135168
    v_add_u32 v174, 65536, v9
    s_add_u32 m0, s66, 139264
    v_add_u32 v175, 65536, v10
    s_add_u32 m0, s66, 143360
    s_add_u32 m0, s66, 147456
    s_add_u32 m0, s66, 151552
    s_add_u32 m0, s66, 155648
    s_add_u32 m0, s66, 36864
    s_add_u32 m0, s66, 49152
    s_lshl1_add_u32 s52, s56, 0xffffdfc0
    v_add_u32 v62, s52, v62
    s_add_u32 m0, s66, 61440
    s_barrier
    s_add_u32 m0, s66, 65536
    s_add_u32 m0, s66, 90112
    s_add_u32 m0, s66, 32768
    s_add_u32 m0, s66, 40960
    s_add_u32 m0, s66, 45056
    s_barrier
    v_add_u32 v176, 131072, v7
    s_add_u32 m0, s66, 53248
    s_add_u32 m0, s66, 57344
    s_add_u32 s52, s53, 0
    v_add_u32 v65, 16384, v64
    v_add_u32 v66, 196608, v64
    v_add_u32 v67, 212992, v64
    buffer_load_dwordx4 v64, s[40:43], s52 offen lds
    s_add_u32 m0, s66, 77824
    s_nop 0
    buffer_load_dwordx4 v65, s[40:43], s52 offen lds
    s_add_u32 m0, s66, 24576
    s_nop 0
    buffer_load_dwordx4 v66, s[40:43], s52 offen lds
    v_lshlrev_b32 v34, 16, v144
    v_and_b32 v35, 0xffff0000, v144
    v_lshlrev_b32 v36, 16, v145
    v_and_b32 v37, 0xffff0000, v145
    v_lshlrev_b32 v38, 16, v146
    v_and_b32 v39, 0xffff0000, v146
    v_lshlrev_b32 v40, 16, v147
    v_and_b32 v41, 0xffff0000, v147
    v_lshlrev_b32 v42, 16, v148
    v_and_b32 v43, 0xffff0000, v148
    v_lshlrev_b32 v44, 16, v149
    v_and_b32 v45, 0xffff0000, v149
    v_lshlrev_b32 v46, 16, v150
    v_and_b32 v47, 0xffff0000, v150
    v_lshlrev_b32 v48, 16, v151
    v_and_b32 v49, 0xffff0000, v151
    s_add_u32 m0, s66, 4096
    s_nop 0
    buffer_load_dwordx4 v67, s[40:43], s52 offen lds
    v_add_u32 v177, 131072, v8
    s_add_u32 m0, s66, 94208
    s_add_u32 s52, s53, 393216
    buffer_load_dwordx4 v64, s[40:43], s52 offen lds
    s_add_u32 m0, s66, 16384
    s_nop 0
    buffer_load_dwordx4 v65, s[40:43], s52 offen lds
    s_add_u32 m0, s66, 20480
    s_nop 0
    buffer_load_dwordx4 v66, s[40:43], s52 offen lds
    s_add_u32 m0, s66, 69632
    s_nop 0
    buffer_load_dwordx4 v67, s[40:43], s52 offen lds
    s_add_u32 m0, s66, 73728
    s_add_u32 s52, s53, 786432
    buffer_load_dwordx4 v64, s[40:43], s52 offen lds
    s_add_u32 m0, s66, 81920
    s_nop 0
    buffer_load_dwordx4 v65, s[40:43], s52 offen lds
    s_add_u32 m0, s66, 86016
    s_nop 0
    buffer_load_dwordx4 v66, s[40:43], s52 offen lds
    s_add_u32 m0, s66, 28672
    s_nop 0
    buffer_load_dwordx4 v67, s[40:43], s52 offen lds
    s_waitcnt vmcnt(9)
    s_barrier
    s_add_u32 m0, s66, 0
    s_add_u32 s52, s53, 1179648
    buffer_load_dwordx4 v64, s[40:43], s52 offen lds
    s_add_u32 m0, s66, 8192
    s_nop 0
    buffer_load_dwordx4 v65, s[40:43], s52 offen lds
    s_add_u32 m0, s66, 12288
    s_nop 0
    buffer_load_dwordx4 v66, s[40:43], s52 offen lds
    s_mov_b64 exec, s[4:5]
    s_mov_b64 exec, -1
    v_add_u32 v178, 131072, v9
    v_add_u32 v179, 131072, v10
    s_waitcnt vmcnt(10)
    s_barrier
    s_add_u32 m0, s66, 98304
    s_nop 0
    buffer_load_dwordx4 v67, s[40:43], s52 offen lds
    s_add_u32 m0, s66, 102400
    s_add_u32 s52, s54, 0
    buffer_load_dwordx4 v64, s[40:43], s52 offen lds
    s_add_u32 m0, s66, 106496
    s_nop 0
    buffer_load_dwordx4 v65, s[40:43], s52 offen lds
    s_add_u32 m0, s66, 110592
    s_nop 0
    buffer_load_dwordx4 v66, s[40:43], s52 offen lds
    s_add_u32 m0, s66, 114688
    s_nop 0
    buffer_load_dwordx4 v67, s[40:43], s52 offen lds
    s_add_u32 m0, s66, 118784
    s_add_u32 s52, s54, 393216
    buffer_load_dwordx4 v64, s[40:43], s52 offen lds
    s_add_u32 s13, s12, 262144
    s_waitcnt vmcnt(10)
    s_barrier
    s_add_u32 m0, s66, 122880
    s_nop 0
    buffer_load_dwordx4 v65, s[40:43], s52 offen lds
    s_add_u32 m0, s66, 126976
    s_nop 0
    buffer_load_dwordx4 v66, s[40:43], s52 offen lds
    s_add_u32 m0, s66, 131072
    s_nop 0
    buffer_load_dwordx4 v67, s[40:43], s52 offen lds
    s_mov_b64 exec, s[6:7]
    buffer_load_dword v33, v20, s[48:51], s71 offen offset:256 sc1
    s_mov_b64 exec, -1
    s_add_u32 m0, s66, 135168
    s_add_u32 s52, s54, 786432
    buffer_load_dwordx4 v64, s[40:43], s52 offen lds
    s_add_u32 m0, s66, 139264
    s_nop 0
    buffer_load_dwordx4 v65, s[40:43], s52 offen lds
    s_add_u32 m0, s66, 143360
    s_nop 0
    buffer_load_dwordx4 v66, s[40:43], s52 offen lds
    s_waitcnt vmcnt(11)
    s_barrier
    s_add_u32 m0, s66, 147456
    s_nop 0
    buffer_load_dwordx4 v67, s[40:43], s52 offen lds
    s_add_u32 m0, s66, 151552
    s_add_u32 s52, s54, 1179648
    buffer_load_dwordx4 v64, s[40:43], s52 offen lds
    s_add_u32 m0, s66, 155648
    s_nop 0
    buffer_load_dwordx4 v65, s[40:43], s52 offen lds
    s_add_u32 m0, s66, 36864
    s_add_u32 s52, s55, 0
    buffer_load_dwordx4 v64, s[40:43], s52 offen lds
    s_waitcnt vmcnt(11)
    s_barrier
    s_add_u32 m0, s66, 49152
    s_nop 0
    buffer_load_dwordx4 v65, s[40:43], s52 offen lds
    s_mov_b64 exec, s[4:5]
    s_mov_b64 exec, -1
    s_add_u32 m0, s66, 61440
    s_nop 0
    buffer_load_dwordx4 v66, s[40:43], s52 offen lds
    s_add_u32 m0, s66, 65536
    s_nop 0
    buffer_load_dwordx4 v67, s[40:43], s52 offen lds
    s_waitcnt vmcnt(10)
    v_cmp_eq_u32 vcc, 0, v33
    s_nop 0
    s_and_b64 vcc, vcc, s[6:7]
    s_cbranch_vccnz L_late4_h15
L_back4_h15:
    s_add_u32 m0, s66, 90112
    s_add_u32 s52, s55, 393216
    buffer_load_dwordx4 v64, s[40:43], s52 offen lds
    s_barrier
    s_add_u32 s14, s15, 0
    buffer_load_dwordx4 a[128:131], v21, s[44:47], s14 offen sc1
    v_add_u32 v180, 65536, v15
    ds_read_b64_tr_b16 a[208:209], v15 offset:57344
    ds_read_b64_tr_b16 a[210:211], v180 offset:12288
    v_add_u32 v181, 65536, v16
    ds_read_b64_tr_b16 a[212:213], v16 offset:57344
    ds_read_b64_tr_b16 a[214:215], v181 offset:12288
    buffer_load_dwordx4 a[132:135], v22, s[44:47], s14 offen sc1
    v_add_u32 v182, 65536, v18
    ds_read_b64_tr_b16 a[216:217], v18 offset:57344
    ds_read_b64_tr_b16 a[218:219], v182 offset:12288
    v_add_u32 v183, 65536, v19
    ds_read_b64_tr_b16 a[220:221], v19 offset:57344
    ds_read_b64_tr_b16 a[222:223], v183 offset:12288
    s_add_u32 s14, s15, 4096
    ds_read_b64_tr_b16 a[224:225], v15 offset:24576
    ds_read_b64_tr_b16 a[226:227], v15 offset:4096
    buffer_load_dwordx4 a[136:139], v21, s[44:47], s14 offen sc1
    ds_read_b64_tr_b16 a[228:229], v16 offset:24576
    ds_read_b64_tr_b16 a[230:231], v16 offset:4096
    s_waitcnt lgkmcnt(4)
    buffer_load_dwordx4 a[140:143], v22, s[44:47], s14 offen sc1
    s_add_u32 s14, s15, 8192
    buffer_load_dwordx4 a[144:147], v21, s[44:47], s14 offen sc1
    buffer_load_dwordx4 a[148:151], v22, s[44:47], s14 offen sc1
    s_add_u32 s14, s15, 12288
    buffer_load_dwordx4 a[152:155], v21, s[44:47], s14 offen sc1
    buffer_load_dwordx4 a[156:159], v22, s[44:47], s14 offen sc1
    s_mov_b64 exec, s[6:7]
    buffer_load_dword v25, v20, s[48:51], s71 offen offset:384 sc1
    s_mov_b64 exec, -1
    s_add_u32 s14, s15, 16384
    buffer_load_dwordx4 a[160:163], v21, s[44:47], s14 offen sc1
    buffer_load_dwordx4 a[164:167], v22, s[44:47], s14 offen sc1
    s_add_u32 s14, s15, 20480
    buffer_load_dwordx4 a[168:171], v21, s[44:47], s14 offen sc1
    buffer_load_dwordx4 a[172:175], v22, s[44:47], s14 offen sc1
    s_waitcnt vmcnt(11)
    v_mfma_f32_16x16x32_bf16 v[68:71], a[208:211], a[128:131], 0
    s_add_u32 s14, s15, 24576
    ds_read_b64_tr_b16 a[232:233], v18 offset:24576
    ds_read_b64_tr_b16 a[234:235], v18 offset:4096
    v_mfma_f32_16x16x32_bf16 v[34:37], a[208:211], a[132:135], v[34:37]
    buffer_load_dwordx4 a[176:179], v21, s[44:47], s14 offen sc1
    v_mfma_f32_16x16x32_bf16 v[72:75], a[212:215], a[128:131], 0
    ds_read_b64_tr_b16 a[236:237], v19 offset:24576
    v_mfma_f32_16x16x32_bf16 v[38:41], a[212:215], a[132:135], v[38:41]
    ds_read_b64_tr_b16 a[238:239], v19 offset:4096
    v_mfma_f32_16x16x32_bf16 v[76:79], a[216:219], a[128:131], 0
    ds_read_b64_tr_b16 a[240:241], v180 offset:28672
    ds_read_b64_tr_b16 a[242:243], v15 offset:16384
    v_mfma_f32_16x16x32_bf16 v[42:45], a[216:219], a[132:135], v[42:45]
    buffer_load_dwordx4 a[180:183], v22, s[44:47], s14 offen sc1
    v_mfma_f32_16x16x32_bf16 v[80:83], a[220:223], a[128:131], 0
    ds_read_b64_tr_b16 a[244:245], v181 offset:28672
    ds_read_b64_tr_b16 a[246:247], v16 offset:16384
    v_mfma_f32_16x16x32_bf16 v[46:49], a[220:223], a[132:135], v[46:49]
    s_waitcnt vmcnt(11) lgkmcnt(4)
    v_mfma_f32_16x16x32_bf16 v[68:71], a[224:227], a[136:139], v[68:71]
    ds_read_b64_tr_b16 a[248:249], v182 offset:28672
    ds_read_b64_tr_b16 a[250:251], v18 offset:16384
    v_mfma_f32_16x16x32_bf16 v[34:37], a[224:227], a[140:143], v[34:37]
    buffer_load_dwordx4 a[184:187], v21, s[44:47], s57 offen sc1
    v_mfma_f32_16x16x32_bf16 v[72:75], a[228:231], a[136:139], v[72:75]
    ds_read_b64_tr_b16 a[252:253], v183 offset:28672
    v_mfma_f32_16x16x32_bf16 v[38:41], a[228:231], a[140:143], v[38:41]
    ds_read_b64_tr_b16 a[254:255], v19 offset:16384
    v_mfma_f32_16x16x32_bf16 v[76:79], a[232:235], a[136:139], v[76:79]
    ds_read_b64_tr_b16 a[208:209], v15 offset:20480
    ds_read_b64_tr_b16 a[210:211], v180 offset:4096
    v_mfma_f32_16x16x32_bf16 v[42:45], a[232:235], a[140:143], v[42:45]
    buffer_load_dwordx4 a[188:191], v22, s[44:47], s57 offen sc1
    v_mfma_f32_16x16x32_bf16 v[80:83], a[236:239], a[136:139], v[80:83]
    ds_read_b64_tr_b16 a[212:213], v16 offset:20480
    ds_read_b64_tr_b16 a[214:215], v181 offset:4096
    v_mfma_f32_16x16x32_bf16 v[46:49], a[236:239], a[140:143], v[46:49]
    s_waitcnt vmcnt(11) lgkmcnt(4)
    v_mfma_f32_16x16x32_bf16 v[68:71], a[240:243], a[144:147], v[68:71]
    ds_read_b64_tr_b16 a[216:217], v18 offset:20480
    v_mfma_f32_16x16x32_bf16 v[34:37], a[240:243], a[148:151], v[34:37]
    ds_read_b64_tr_b16 a[218:219], v182 offset:4096
    v_mfma_f32_16x16x32_bf16 v[72:75], a[244:247], a[144:147], v[72:75]
    ds_read_b64_tr_b16 a[220:221], v19 offset:20480
    v_mfma_f32_16x16x32_bf16 v[38:41], a[244:247], a[148:151], v[38:41]
    ds_read_b64_tr_b16 a[222:223], v183 offset:4096
    v_mfma_f32_16x16x32_bf16 v[76:79], a[248:251], a[144:147], v[76:79]
    ds_read_b64_tr_b16 a[224:225], v180 offset:8192
    v_mfma_f32_16x16x32_bf16 v[42:45], a[248:251], a[148:151], v[42:45]
    ds_read_b64_tr_b16 a[226:227], v180 offset:16384
    v_mfma_f32_16x16x32_bf16 v[80:83], a[252:255], a[144:147], v[80:83]
    ds_read_b64_tr_b16 a[228:229], v181 offset:8192
    ds_read_b64_tr_b16 a[230:231], v181 offset:16384
    v_mfma_f32_16x16x32_bf16 v[46:49], a[252:255], a[148:151], v[46:49]
    s_waitcnt vmcnt(8) lgkmcnt(4)
    v_cmp_eq_u32 vcc, 0, v25
    s_nop 0
    s_and_b64 vcc, vcc, s[6:7]
    s_cbranch_vccnz L_late6_h15
L_back6_h15:
    s_barrier
    v_mfma_f32_16x16x32_bf16 v[68:71], a[208:211], a[152:155], v[68:71]
    s_add_u32 s14, s16, 262144
    ds_read_b64_tr_b16 a[232:233], v182 offset:8192
    ds_read_b64_tr_b16 a[234:235], v182 offset:16384
    v_mfma_f32_16x16x32_bf16 v[34:37], a[208:211], a[156:159], v[34:37]
    buffer_load_dwordx4 a[192:195], v21, s[48:51], s14 offen sc1
    v_mfma_f32_16x16x32_bf16 v[72:75], a[212:215], a[152:155], v[72:75]
    ds_read_b64_tr_b16 a[236:237], v183 offset:8192
    ds_read_b64_tr_b16 a[238:239], v183 offset:16384
    v_mfma_f32_16x16x32_bf16 v[38:41], a[212:215], a[156:159], v[38:41]
    buffer_load_dwordx4 a[196:199], v22, s[48:51], s14 offen sc1
    v_mfma_f32_16x16x32_bf16 v[76:79], a[216:219], a[152:155], v[76:79]
    ds_read_b64_tr_b16 a[240:241], v180 offset:20480
    v_mfma_f32_16x16x32_bf16 v[42:45], a[216:219], a[156:159], v[42:45]
    ds_read_b64_tr_b16 a[242:243], v15 offset:28672
    v_mfma_f32_16x16x32_bf16 v[80:83], a[220:223], a[152:155], v[80:83]
    ds_read_b64_tr_b16 a[244:245], v181 offset:20480
    ds_read_b64_tr_b16 a[246:247], v16 offset:28672
    v_mfma_f32_16x16x32_bf16 v[46:49], a[220:223], a[156:159], v[46:49]
    s_waitcnt vmcnt(8) lgkmcnt(4)
    v_mfma_f32_16x16x32_bf16 v[68:71], a[224:227], a[160:163], v[68:71]
    s_add_u32 s14, s16, 266240
    ds_read_b64_tr_b16 a[248:249], v182 offset:20480
    ds_read_b64_tr_b16 a[250:251], v18 offset:28672
    v_mfma_f32_16x16x32_bf16 v[34:37], a[224:227], a[164:167], v[34:37]
    buffer_load_dwordx4 a[200:203], v21, s[48:51], s14 offen sc1
    v_mfma_f32_16x16x32_bf16 v[72:75], a[228:231], a[160:163], v[72:75]
    ds_read_b64_tr_b16 a[252:253], v183 offset:20480
    v_mfma_f32_16x16x32_bf16 v[38:41], a[228:231], a[164:167], v[38:41]
    ds_read_b64_tr_b16 a[254:255], v19 offset:28672
    v_mfma_f32_16x16x32_bf16 v[76:79], a[232:235], a[160:163], v[76:79]
    ds_read_b64_tr_b16 a[208:209], v15 offset:0
    ds_read_b64_tr_b16 a[210:211], v15 offset:8192
    v_mfma_f32_16x16x32_bf16 v[42:45], a[232:235], a[164:167], v[42:45]
    buffer_load_dwordx4 a[204:207], v22, s[48:51], s14 offen sc1
    v_mfma_f32_16x16x32_bf16 v[80:83], a[236:239], a[160:163], v[80:83]
    ds_read_b64_tr_b16 a[212:213], v16 offset:0
    ds_read_b64_tr_b16 a[214:215], v16 offset:8192
    v_mfma_f32_16x16x32_bf16 v[46:49], a[236:239], a[164:167], v[46:49]
    s_waitcnt vmcnt(8) lgkmcnt(4)
    v_mfma_f32_16x16x32_bf16 v[68:71], a[240:243], a[168:171], v[68:71]
    s_add_u32 s14, s16, 270336
    ds_read_b64_tr_b16 a[216:217], v18 offset:0
    ds_read_b64_tr_b16 a[218:219], v18 offset:8192
    v_mfma_f32_16x16x32_bf16 v[34:37], a[240:243], a[172:175], v[34:37]
    buffer_load_dwordx4 a[8:11], v21, s[48:51], s14 offen sc1
    v_mfma_f32_16x16x32_bf16 v[72:75], a[244:247], a[168:171], v[72:75]
    ds_read_b64_tr_b16 a[220:221], v19 offset:0
    v_mfma_f32_16x16x32_bf16 v[38:41], a[244:247], a[172:175], v[38:41]
    ds_read_b64_tr_b16 a[222:223], v19 offset:8192
    v_mfma_f32_16x16x32_bf16 v[76:79], a[248:251], a[168:171], v[76:79]
    ds_read_b64_tr_b16 a[224:225], v15 offset:12288
    ds_read_b64_tr_b16 a[226:227], v180 offset:32768
    v_mfma_f32_16x16x32_bf16 v[42:45], a[248:251], a[172:175], v[42:45]
    buffer_load_dwordx4 a[12:15], v22, s[48:51], s14 offen sc1
    v_mfma_f32_16x16x32_bf16 v[80:83], a[252:255], a[168:171], v[80:83]
    ds_read_b64_tr_b16 a[228:229], v16 offset:12288
    ds_read_b64_tr_b16 a[230:231], v181 offset:32768
    v_mfma_f32_16x16x32_bf16 v[46:49], a[252:255], a[172:175], v[46:49]
    s_waitcnt vmcnt(8) lgkmcnt(4)
    v_mfma_f32_16x16x32_bf16 v[68:71], a[208:211], a[176:179], v[68:71]
    s_add_u32 s14, s16, 274432
    ds_read_b64_tr_b16 a[232:233], v18 offset:12288
    ds_read_b64_tr_b16 a[234:235], v182 offset:32768
    v_mfma_f32_16x16x32_bf16 v[34:37], a[208:211], a[180:183], v[34:37]
    buffer_load_dwordx4 a[24:27], v21, s[48:51], s14 offen sc1
    v_mfma_f32_16x16x32_bf16 v[72:75], a[212:215], a[176:179], v[72:75]
    ds_read_b64_tr_b16 a[236:237], v19 offset:12288
    v_mfma_f32_16x16x32_bf16 v[38:41], a[212:215], a[180:183], v[38:41]
    ds_read_b64_tr_b16 a[238:239], v183 offset:32768
    v_mfma_f32_16x16x32_bf16 v[76:79], a[216:219], a[176:179], v[76:79]
    ds_read_b64_tr_b16 a[240:241], v180 offset:36864
    ds_read_b64_tr_b16 a[242:243], v180 offset:40960
    v_mfma_f32_16x16x32_bf16 v[42:45], a[216:219], a[180:183], v[42:45]
    buffer_load_dwordx4 a[28:31], v22, s[48:51], s14 offen sc1
    s_waitcnt vmcnt(8)
    s_barrier
    v_mfma_f32_16x16x32_bf16 v[80:83], a[220:223], a[176:179], v[80:83]
    ds_read_b64_tr_b16 a[244:245], v181 offset:36864
    ds_read_b64_tr_b16 a[246:247], v181 offset:40960
    v_mfma_f32_16x16x32_bf16 v[46:49], a[220:223], a[180:183], v[46:49]
    s_waitcnt lgkmcnt(4)
    s_mov_b64 exec, s[4:5]
    buffer_store_dword v2, off, s[48:51], s79 offset:512
    s_mov_b64 exec, -1
    v_mfma_f32_16x16x32_bf16 v[68:71], a[224:227], a[184:187], v[68:71]
    s_add_u32 m0, s66, 32768
    ds_read_b64_tr_b16 a[248:249], v182 offset:36864
    ds_read_b64_tr_b16 a[250:251], v182 offset:40960
    v_mfma_f32_16x16x32_bf16 v[34:37], a[224:227], a[188:191], v[34:37]
    buffer_load_dwordx4 v65, s[40:43], s52 offen lds
    v_mfma_f32_16x16x32_bf16 v[72:75], a[228:231], a[184:187], v[72:75]
    ds_read_b64_tr_b16 a[252:253], v183 offset:36864
    v_mfma_f32_16x16x32_bf16 v[38:41], a[228:231], a[188:191], v[38:41]
    ds_read_b64_tr_b16 a[254:255], v183 offset:40960
    v_mfma_f32_16x16x32_bf16 v[76:79], a[232:235], a[184:187], v[76:79]
    s_add_u32 s14, s16, 278528
    ds_read_b64_tr_b16 a[208:209], v180 offset:45056
    ds_read_b64_tr_b16 a[210:211], v180 offset:49152
    v_mfma_f32_16x16x32_bf16 v[42:45], a[232:235], a[188:191], v[42:45]
    buffer_load_dwordx4 a[40:43], v21, s[48:51], s14 offen sc1
    v_mfma_f32_16x16x32_bf16 v[80:83], a[236:239], a[184:187], v[80:83]
    ds_read_b64_tr_b16 a[212:213], v181 offset:45056
    ds_read_b64_tr_b16 a[214:215], v181 offset:49152
    v_mfma_f32_16x16x32_bf16 v[46:49], a[236:239], a[188:191], v[46:49]
    s_waitcnt lgkmcnt(4)
    buffer_load_dwordx4 a[44:47], v22, s[48:51], s14 offen sc1
    s_add_u32 m0, s66, 40960
    s_nop 0
    buffer_load_dwordx4 v66, s[40:43], s52 offen lds
    s_waitcnt vmcnt(11)
    v_mfma_f32_16x16x32_bf16 v[68:71], a[240:243], a[192:195], v[68:71]
    s_add_u32 m0, s66, 45056
    ds_read_b64_tr_b16 a[216:217], v182 offset:45056
    ds_read_b64_tr_b16 a[218:219], v182 offset:49152
    v_mfma_f32_16x16x32_bf16 v[34:37], a[240:243], a[196:199], v[34:37]
    buffer_load_dwordx4 v67, s[40:43], s52 offen lds
    v_mfma_f32_16x16x32_bf16 v[72:75], a[244:247], a[192:195], v[72:75]
    ds_read_b64_tr_b16 a[220:221], v183 offset:45056
    v_mfma_f32_16x16x32_bf16 v[38:41], a[244:247], a[196:199], v[38:41]
    ds_read_b64_tr_b16 a[222:223], v183 offset:49152
    v_mfma_f32_16x16x32_bf16 v[76:79], a[248:251], a[192:195], v[76:79]
    s_add_u32 s14, s16, 282624
    ds_read_b64_tr_b16 a[224:225], v180 offset:53248
    ds_read_b64_tr_b16 a[226:227], v180 offset:57344
    v_mfma_f32_16x16x32_bf16 v[42:45], a[248:251], a[196:199], v[42:45]
    buffer_load_dwordx4 a[56:59], v21, s[48:51], s14 offen sc1
    v_mfma_f32_16x16x32_bf16 v[80:83], a[252:255], a[192:195], v[80:83]
    ds_read_b64_tr_b16 a[228:229], v181 offset:53248
    ds_read_b64_tr_b16 a[230:231], v181 offset:57344
    v_mfma_f32_16x16x32_bf16 v[46:49], a[252:255], a[196:199], v[46:49]
    s_waitcnt vmcnt(11) lgkmcnt(4)
    v_mfma_f32_16x16x32_bf16 v[68:71], a[208:211], a[200:203], v[68:71]
    ds_read_b64_tr_b16 a[232:233], v182 offset:53248
    ds_read_b64_tr_b16 a[234:235], v182 offset:57344
    v_mfma_f32_16x16x32_bf16 v[34:37], a[208:211], a[204:207], v[34:37]
    buffer_load_dwordx4 a[60:63], v22, s[48:51], s14 offen sc1
    v_mfma_f32_16x16x32_bf16 v[72:75], a[212:215], a[200:203], v[72:75]
    ds_read_b64_tr_b16 a[236:237], v183 offset:53248
    ds_read_b64_tr_b16 a[238:239], v183 offset:57344
    v_mfma_f32_16x16x32_bf16 v[38:41], a[212:215], a[204:207], v[38:41]
    v_add_u32 v184, 131072, v15
    v_mfma_f32_16x16x32_bf16 v[76:79], a[216:219], a[200:203], v[76:79]
    s_add_u32 m0, s66, 53248
    s_add_u32 s52, s55, 786432
    ds_read_b64_tr_b16 a[240:241], v180 offset:61440
    ds_read_b64_tr_b16 a[242:243], v184 offset:0
    v_mfma_f32_16x16x32_bf16 v[42:45], a[216:219], a[204:207], v[42:45]
    buffer_load_dwordx4 v64, s[40:43], s52 offen lds
    v_add_u32 v185, 131072, v16
    v_mfma_f32_16x16x32_bf16 v[80:83], a[220:223], a[200:203], v[80:83]
    ds_read_b64_tr_b16 a[244:245], v181 offset:61440
    ds_read_b64_tr_b16 a[246:247], v185 offset:0
    v_mfma_f32_16x16x32_bf16 v[46:49], a[220:223], a[204:207], v[46:49]
    s_waitcnt lgkmcnt(4)
    v_add_u32 v186, 131072, v18
    s_waitcnt vmcnt(11)
    v_mfma_f32_16x16x32_bf16 v[68:71], a[224:227], a[8:11], v[68:71]
    s_add_u32 m0, s66, 57344
    ds_read_b64_tr_b16 a[248:249], v182 offset:61440
    ds_read_b64_tr_b16 a[250:251], v186 offset:0
    v_mfma_f32_16x16x32_bf16 v[34:37], a[224:227], a[12:15], v[34:37]
    buffer_load_dwordx4 v65, s[40:43], s52 offen lds
    v_add_u32 v187, 131072, v19
    v_mfma_f32_16x16x32_bf16 v[72:75], a[228:231], a[8:11], v[72:75]
    ds_read_b64_tr_b16 a[252:253], v183 offset:61440
    v_mfma_f32_16x16x32_bf16 v[38:41], a[228:231], a[12:15], v[38:41]
    ds_read_b64_tr_b16 a[254:255], v187 offset:0
    v_mfma_f32_16x16x32_bf16 v[76:79], a[232:235], a[8:11], v[76:79]
    s_add_u32 s14, s16, 286720
    ds_read_b64_tr_b16 a[208:209], v184 offset:4096
    ds_read_b64_tr_b16 a[210:211], v184 offset:8192
    v_mfma_f32_16x16x32_bf16 v[42:45], a[232:235], a[12:15], v[42:45]
    buffer_load_dwordx4 a[72:75], v21, s[48:51], s14 offen sc1
    v_mfma_f32_16x16x32_bf16 v[80:83], a[236:239], a[8:11], v[80:83]
    ds_read_b64_tr_b16 a[212:213], v185 offset:4096
    ds_read_b64_tr_b16 a[214:215], v185 offset:8192
    v_mfma_f32_16x16x32_bf16 v[46:49], a[236:239], a[12:15], v[46:49]
    s_waitcnt lgkmcnt(4)
    s_mov_b64 exec, s[6:7]
    buffer_load_dword v3, v20, s[48:51], s71 offen offset:512 sc1
    s_mov_b64 exec, -1
    s_waitcnt vmcnt(12)
    v_mfma_f32_16x16x32_bf16 v[68:71], a[240:243], a[24:27], v[68:71]
    ds_read_b64_tr_b16 a[216:217], v186 offset:4096
    ds_read_b64_tr_b16 a[218:219], v186 offset:8192
    v_mfma_f32_16x16x32_bf16 v[34:37], a[240:243], a[28:31], v[34:37]
    buffer_load_dwordx4 a[76:79], v22, s[48:51], s14 offen sc1
    v_mfma_f32_16x16x32_bf16 v[72:75], a[244:247], a[24:27], v[72:75]
    ds_read_b64_tr_b16 a[220:221], v187 offset:4096
    v_mfma_f32_16x16x32_bf16 v[38:41], a[244:247], a[28:31], v[38:41]
    ds_read_b64_tr_b16 a[222:223], v187 offset:8192
    v_mfma_f32_16x16x32_bf16 v[76:79], a[248:251], a[24:27], v[76:79]
    ds_read_b64_tr_b16 a[224:225], v184 offset:12288
    v_mfma_f32_16x16x32_bf16 v[42:45], a[248:251], a[28:31], v[42:45]
    ds_read_b64_tr_b16 a[226:227], v184 offset:16384
    v_mfma_f32_16x16x32_bf16 v[80:83], a[252:255], a[24:27], v[80:83]
    s_add_u32 m0, s66, 77824
    ds_read_b64_tr_b16 a[228:229], v185 offset:12288
    ds_read_b64_tr_b16 a[230:231], v185 offset:16384
    v_mfma_f32_16x16x32_bf16 v[46:49], a[252:255], a[28:31], v[46:49]
    s_waitcnt lgkmcnt(4)
    buffer_load_dwordx4 v66, s[40:43], s52 offen lds
    s_add_u32 m0, s66, 24576
    s_nop 0
    buffer_load_dwordx4 v67, s[40:43], s52 offen lds
    s_waitcnt vmcnt(11)
    v_mfma_f32_16x16x32_bf16 v[68:71], a[208:211], a[40:43], v[68:71]
    s_add_u32 m0, s66, 4096
    s_add_u32 s52, s55, 1179648
    ds_read_b64_tr_b16 a[232:233], v186 offset:12288
    ds_read_b64_tr_b16 a[234:235], v186 offset:16384
    v_mfma_f32_16x16x32_bf16 v[34:37], a[208:211], a[44:47], v[34:37]
    buffer_load_dwordx4 v64, s[40:43], s52 offen lds
    v_mfma_f32_16x16x32_bf16 v[72:75], a[212:215], a[40:43], v[72:75]
    ds_read_b64_tr_b16 a[236:237], v187 offset:12288
    v_mfma_f32_16x16x32_bf16 v[38:41], a[212:215], a[44:47], v[38:41]
    ds_read_b64_tr_b16 a[238:239], v187 offset:16384
    v_mfma_f32_16x16x32_bf16 v[76:79], a[216:219], a[40:43], v[76:79]
    s_add_u32 m0, s66, 94208
    ds_read_b64_tr_b16 a[240:241], v184 offset:20480
    ds_read_b64_tr_b16 a[242:243], v184 offset:24576
    v_mfma_f32_16x16x32_bf16 v[42:45], a[216:219], a[44:47], v[42:45]
    buffer_load_dwordx4 v65, s[40:43], s52 offen lds
    v_mfma_f32_16x16x32_bf16 v[80:83], a[220:223], a[40:43], v[80:83]
    ds_read_b64_tr_b16 a[244:245], v185 offset:20480
    ds_read_b64_tr_b16 a[246:247], v185 offset:24576
    v_mfma_f32_16x16x32_bf16 v[46:49], a[220:223], a[44:47], v[46:49]
    s_waitcnt vmcnt(9) lgkmcnt(4)
    v_mfma_f32_16x16x32_bf16 v[68:71], a[224:227], a[56:59], v[68:71]
    ds_read_b64_tr_b16 a[248:249], v186 offset:20480
    v_mfma_f32_16x16x32_bf16 v[34:37], a[224:227], a[60:63], v[34:37]
    ds_read_b64_tr_b16 a[250:251], v186 offset:24576
    v_mfma_f32_16x16x32_bf16 v[72:75], a[228:231], a[56:59], v[72:75]
    ds_read_b64_tr_b16 a[252:253], v187 offset:20480
    v_mfma_f32_16x16x32_bf16 v[38:41], a[228:231], a[60:63], v[38:41]
    ds_read_b64_tr_b16 a[254:255], v187 offset:24576
    v_mfma_f32_16x16x32_bf16 v[76:79], a[232:235], a[56:59], v[76:79]
    ds_read_b64_tr_b16 a[208:209], v15 offset:36864
    v_mfma_f32_16x16x32_bf16 v[42:45], a[232:235], a[60:63], v[42:45]
    ds_read_b64_tr_b16 a[210:211], v15 offset:49152
    v_mfma_f32_16x16x32_bf16 v[80:83], a[236:239], a[56:59], v[80:83]
    ds_read_b64_tr_b16 a[212:213], v16 offset:36864
    ds_read_b64_tr_b16 a[214:215], v16 offset:49152
    v_mfma_f32_16x16x32_bf16 v[46:49], a[236:239], a[60:63], v[46:49]
    s_waitcnt vmcnt(5) lgkmcnt(4)
    v_cmp_eq_u32 vcc, 0, v3
    s_nop 0
    s_and_b64 vcc, vcc, s[6:7]
    s_cbranch_vccnz L_late8_h15
L_back8_h15:
    s_barrier
    s_add_u32 s14, s16, 0
    buffer_load_dwordx4 a[88:91], v21, s[48:51], s14 offen sc1
    buffer_load_dwordx4 a[92:95], v22, s[48:51], s14 offen sc1
    s_add_u32 s14, s16, 4096
    buffer_load_dwordx4 a[104:107], v21, s[48:51], s14 offen sc1
    buffer_load_dwordx4 a[108:111], v22, s[48:51], s14 offen sc1
    s_lshl2_add_u32 s67, s66, 98304
    v_add_u32 v4, s67, v17
    s_xor_b32 s68, s66, 1024
    s_lshl2_add_u32 s68, s68, 98304
    v_add_u32 v5, s68, v17
    s_add_u32 s67, s76, 114688
    v_add_u32 v171, s67, v17
    v_lshrrev_b32 v63, 1, v32
    v_and_b32 v168, 7, v1
    v_xor_b32 v63, v63, v168
    v_lshlrev_b32 v63, 4, v63
    v_lshl_add_u32 v63, v31, 7, v63
    v_lshrrev_b32 v6, 3, v1
    v_xor_b32 v168, v168, v6
    v_lshlrev_b32 v168, 4, v168
    v_lshl_add_u32 v6, v6, 10, v168
    v_and_b32 v168, 1, v32
    v_lshlrev_b32 v168, 3, v168
    s_waitcnt vmcnt(8)
    v_mfma_f32_16x16x32_bf16 v[68:71], a[240:243], a[72:75], v[68:71]
    s_add_u32 s14, s16, 8192
    ds_read_b64_tr_b16 a[216:217], v18 offset:36864
    ds_read_b64_tr_b16 a[218:219], v18 offset:49152
    v_mfma_f32_16x16x32_bf16 v[34:37], a[240:243], a[76:79], v[34:37]
    buffer_load_dwordx4 a[120:123], v21, s[48:51], s14 offen sc1
    v_add3_u32 v63, v63, v168, s67
    v_mfma_f32_16x16x32_bf16 v[72:75], a[244:247], a[72:75], v[72:75]
    ds_read_b64_tr_b16 a[220:221], v19 offset:36864
    ds_read_b64_tr_b16 a[222:223], v19 offset:49152
    v_mfma_f32_16x16x32_bf16 v[38:41], a[244:247], a[76:79], v[38:41]
    v_xor_b32 v168, 32, v63
    v_xor_b32 v169, 64, v63
    v_mfma_f32_16x16x32_bf16 v[76:79], a[248:251], a[72:75], v[76:79]
    ds_read_b64_tr_b16 a[224:225], v15 offset:61440
    ds_read_b64_tr_b16 a[226:227], v180 offset:0
    v_mfma_f32_16x16x32_bf16 v[42:45], a[248:251], a[76:79], v[42:45]
    buffer_load_dwordx4 a[124:127], v22, s[48:51], s14 offen sc1
    v_xor_b32 v170, 96, v63
    v_mfma_f32_16x16x32_bf16 v[80:83], a[252:255], a[72:75], v[80:83]
    ds_read_b64_tr_b16 a[228:229], v16 offset:61440
    ds_read_b64_tr_b16 a[230:231], v181 offset:0
    v_mfma_f32_16x16x32_bf16 v[46:49], a[252:255], a[76:79], v[46:49]
    s_waitcnt lgkmcnt(4)
    s_lshl2_add_u32 s67, s65, s60
    s_lshl_b32 s67, s67, 14
    s_add_u32 s67, s67, s78
    s_add_u32 s68, s67, 8192
    s_add_u32 s14, s16, 12288
    buffer_load_dwordx4 a[0:3], v21, s[48:51], s14 offen sc1
    buffer_load_dwordx4 a[4:7], v22, s[48:51], s14 offen sc1
    s_add_u32 s14, s16, 16384
    buffer_load_dwordx4 a[16:19], v21, s[48:51], s14 offen sc1
    buffer_load_dwordx4 a[20:23], v22, s[48:51], s14 offen sc1
    s_waitcnt vmcnt(8)
    v_mfma_f32_16x16x32_bf16 v[68:71], a[208:211], a[88:91], v[68:71]
    s_add_u32 s14, s16, 20480
    ds_read_b64_tr_b16 a[232:233], v18 offset:61440
    ds_read_b64_tr_b16 a[234:235], v182 offset:0
    v_mfma_f32_16x16x32_bf16 v[34:37], a[208:211], a[92:95], v[34:37]
    buffer_load_dwordx4 a[32:35], v21, s[48:51], s14 offen sc1
    v_mfma_f32_16x16x32_bf16 v[72:75], a[212:215], a[88:91], v[72:75]
    ds_read_b64_tr_b16 a[236:237], v19 offset:61440
    v_mfma_f32_16x16x32_bf16 v[38:41], a[212:215], a[92:95], v[38:41]
    ds_read_b64_tr_b16 a[238:239], v183 offset:0
    v_mfma_f32_16x16x32_bf16 v[76:79], a[216:219], a[88:91], v[76:79]
    ds_read_b64_tr_b16 a[240:241], v180 offset:24576
    ds_read_b64_tr_b16 a[242:243], v15 offset:32768
    v_mfma_f32_16x16x32_bf16 v[42:45], a[216:219], a[92:95], v[42:45]
    buffer_load_dwordx4 a[36:39], v22, s[48:51], s14 offen sc1
    v_mfma_f32_16x16x32_bf16 v[80:83], a[220:223], a[88:91], v[80:83]
    ds_read_b64_tr_b16 a[244:245], v181 offset:24576
    ds_read_b64_tr_b16 a[246:247], v16 offset:32768
    v_mfma_f32_16x16x32_bf16 v[46:49], a[220:223], a[92:95], v[46:49]
    s_waitcnt vmcnt(8) lgkmcnt(4)
    v_mfma_f32_16x16x32_bf16 v[68:71], a[224:227], a[104:107], v[68:71]
    s_add_u32 s14, s16, 24576
    ds_read_b64_tr_b16 a[248:249], v182 offset:24576
    ds_read_b64_tr_b16 a[250:251], v18 offset:32768
    v_mfma_f32_16x16x32_bf16 v[34:37], a[224:227], a[108:111], v[34:37]
    buffer_load_dwordx4 a[48:51], v21, s[48:51], s14 offen sc1
    v_mfma_f32_16x16x32_bf16 v[72:75], a[228:231], a[104:107], v[72:75]
    ds_read_b64_tr_b16 a[252:253], v183 offset:24576
    v_mfma_f32_16x16x32_bf16 v[38:41], a[228:231], a[108:111], v[38:41]
    ds_read_b64_tr_b16 a[254:255], v19 offset:32768
    v_mfma_f32_16x16x32_bf16 v[76:79], a[232:235], a[104:107], v[76:79]
    ds_read_b64_tr_b16 a[208:209], v15 offset:40960
    ds_read_b64_tr_b16 a[210:211], v15 offset:45056
    v_mfma_f32_16x16x32_bf16 v[42:45], a[232:235], a[108:111], v[42:45]
    buffer_load_dwordx4 a[52:55], v22, s[48:51], s14 offen sc1
    v_mfma_f32_16x16x32_bf16 v[80:83], a[236:239], a[104:107], v[80:83]
    ds_read_b64_tr_b16 a[212:213], v16 offset:40960
    ds_read_b64_tr_b16 a[214:215], v16 offset:45056
    v_mfma_f32_16x16x32_bf16 v[46:49], a[236:239], a[108:111], v[46:49]
    s_waitcnt vmcnt(8) lgkmcnt(4)
    v_mfma_f32_16x16x32_bf16 v[68:71], a[240:243], a[120:123], v[68:71]
    ds_read_b64_tr_b16 a[216:217], v18 offset:40960
    v_mfma_f32_16x16x32_bf16 v[34:37], a[240:243], a[124:127], v[34:37]
    ds_read_b64_tr_b16 a[218:219], v18 offset:45056
    v_mfma_f32_16x16x32_bf16 v[72:75], a[244:247], a[120:123], v[72:75]
    ds_read_b64_tr_b16 a[220:221], v19 offset:40960
    ds_read_b64_tr_b16 a[222:223], v19 offset:45056
    v_mfma_f32_16x16x32_bf16 v[38:41], a[244:247], a[124:127], v[38:41]
    s_barrier
    v_mfma_f32_16x16x32_bf16 v[76:79], a[248:251], a[120:123], v[76:79]
    ds_read_b64_tr_b16 a[224:225], v15 offset:53248
    v_mfma_f32_16x16x32_bf16 v[42:45], a[248:251], a[124:127], v[42:45]
    ds_read_b64_tr_b16 a[226:227], v15 offset:57344
    v_mfma_f32_16x16x32_bf16 v[80:83], a[252:255], a[120:123], v[80:83]
    ds_read_b64_tr_b16 a[228:229], v16 offset:53248
    ds_read_b64_tr_b16 a[230:231], v16 offset:57344
    v_mfma_f32_16x16x32_bf16 v[46:49], a[252:255], a[124:127], v[46:49]
    s_waitcnt vmcnt(6) lgkmcnt(4)
    v_mfma_f32_16x16x32_bf16 v[68:71], a[208:211], a[0:3], v[68:71]
    ds_read_b64_tr_b16 a[232:233], v18 offset:53248
    v_mfma_f32_16x16x32_bf16 v[34:37], a[208:211], a[4:7], v[34:37]
    ds_read_b64_tr_b16 a[234:235], v18 offset:57344
    v_mfma_f32_16x16x32_bf16 v[72:75], a[212:215], a[0:3], v[72:75]
    ds_read_b64_tr_b16 a[236:237], v19 offset:53248
    v_mfma_f32_16x16x32_bf16 v[38:41], a[212:215], a[4:7], v[38:41]
    ds_read_b64_tr_b16 a[238:239], v19 offset:57344
    v_mfma_f32_16x16x32_bf16 v[76:79], a[216:219], a[0:3], v[76:79]
    ds_read_b64_tr_b16 a[240:241], v180 offset:12288
    v_mfma_f32_16x16x32_bf16 v[42:45], a[216:219], a[4:7], v[42:45]
    ds_read_b64_tr_b16 a[242:243], v15 offset:24576
    v_mfma_f32_16x16x32_bf16 v[80:83], a[220:223], a[0:3], v[80:83]
    ds_read_b64_tr_b16 a[244:245], v181 offset:12288
    ds_read_b64_tr_b16 a[246:247], v16 offset:24576
    v_mfma_f32_16x16x32_bf16 v[46:49], a[220:223], a[4:7], v[46:49]
    s_waitcnt vmcnt(4) lgkmcnt(4)
    v_mfma_f32_16x16x32_bf16 v[68:71], a[224:227], a[16:19], v[68:71]
    ds_read_b64_tr_b16 a[248:249], v182 offset:12288
    v_mfma_f32_16x16x32_bf16 v[34:37], a[224:227], a[20:23], v[34:37]
    ds_read_b64_tr_b16 a[250:251], v18 offset:24576
    v_mfma_f32_16x16x32_bf16 v[72:75], a[228:231], a[16:19], v[72:75]
    ds_read_b64_tr_b16 a[252:253], v183 offset:12288
    v_mfma_f32_16x16x32_bf16 v[38:41], a[228:231], a[20:23], v[38:41]
    ds_read_b64_tr_b16 a[254:255], v19 offset:24576
    v_mfma_f32_16x16x32_bf16 v[76:79], a[232:235], a[16:19], v[76:79]
    ds_read_b64_tr_b16 a[208:209], v15 offset:4096
    v_mfma_f32_16x16x32_bf16 v[42:45], a[232:235], a[20:23], v[42:45]
    ds_read_b64_tr_b16 a[210:211], v180 offset:28672
    v_mfma_f32_16x16x32_bf16 v[80:83], a[236:239], a[16:19], v[80:83]
    ds_read_b64_tr_b16 a[212:213], v16 offset:4096
    ds_read_b64_tr_b16 a[214:215], v181 offset:28672
    v_mfma_f32_16x16x32_bf16 v[46:49], a[236:239], a[20:23], v[46:49]
    s_waitcnt vmcnt(3) lgkmcnt(4)
    v_mfma_f32_16x16x32_bf16 v[68:71], a[240:243], a[32:35], v[68:71]
    ds_read_b64_tr_b16 a[216:217], v18 offset:4096
    v_mfma_f32_16x16x32_bf16 v[72:75], a[244:247], a[32:35], v[72:75]
    ds_read_b64_tr_b16 a[218:219], v182 offset:28672
    v_mfma_f32_16x16x32_bf16 v[76:79], a[248:251], a[32:35], v[76:79]
    ds_read_b64_tr_b16 a[220:221], v19 offset:4096
    ds_read_b64_tr_b16 a[222:223], v183 offset:28672
    v_mfma_f32_16x16x32_bf16 v[80:83], a[252:255], a[32:35], v[80:83]
    s_waitcnt vmcnt(1) lgkmcnt(6)
    v_mfma_f32_16x16x32_bf16 v[68:71], a[208:211], a[48:51], v[68:71]
    s_waitcnt lgkmcnt(4)
    v_mfma_f32_16x16x32_bf16 v[72:75], a[212:215], a[48:51], v[72:75]
    s_waitcnt lgkmcnt(2)
    v_mfma_f32_16x16x32_bf16 v[76:79], a[216:219], a[48:51], v[76:79]
    s_waitcnt lgkmcnt(0)
    v_mfma_f32_16x16x32_bf16 v[80:83], a[220:223], a[48:51], v[80:83]
    v_mfma_f32_16x16x32_bf16 v[34:37], a[240:243], a[36:39], v[34:37]
    v_mfma_f32_16x16x32_bf16 v[38:41], a[244:247], a[36:39], v[38:41]
    ds_write_b128 v4, v[68:71] offset:0
    v_mfma_f32_16x16x32_bf16 v[42:45], a[248:251], a[36:39], v[42:45]
    ds_write_b128 v4, v[72:75] offset:1024
    v_mfma_f32_16x16x32_bf16 v[46:49], a[252:255], a[36:39], v[46:49]
    ds_write_b128 v4, v[76:79] offset:2048
    s_waitcnt vmcnt(0)
    v_mfma_f32_16x16x32_bf16 v[34:37], a[208:211], a[52:55], v[34:37]
    ds_write_b128 v4, v[80:83] offset:3072
    v_mfma_f32_16x16x32_bf16 v[38:41], a[212:215], a[52:55], v[38:41]
    v_mfma_f32_16x16x32_bf16 v[42:45], a[216:219], a[52:55], v[42:45]
    v_mfma_f32_16x16x32_bf16 v[46:49], a[220:223], a[52:55], v[46:49]
    s_waitcnt lgkmcnt(0)
    s_barrier
    ds_read_b128 v[84:87], v5 offset:0
    ds_read_b128 v[88:91], v5 offset:1024
    ds_read_b128 v[92:95], v5 offset:2048
    ds_read_b128 v[96:99], v5 offset:3072
    s_waitcnt lgkmcnt(3)
    v_pk_add_f32 v[34:35], v[34:35], v[84:85]
    v_pk_add_f32 v[36:37], v[36:37], v[86:87]
    v_cvt_pk_bf16_f32 v132, v34, v35
    v_cvt_pk_bf16_f32 v133, v36, v37
    ds_write_b64 v63, v[132:133]
    s_waitcnt lgkmcnt(3)
    v_pk_add_f32 v[38:39], v[38:39], v[88:89]
    v_pk_add_f32 v[40:41], v[40:41], v[90:91]
    v_cvt_pk_bf16_f32 v134, v38, v39
    v_cvt_pk_bf16_f32 v135, v40, v41
    ds_write_b64 v168, v[134:135]
    s_waitcnt lgkmcnt(3)
    v_pk_add_f32 v[42:43], v[42:43], v[92:93]
    v_pk_add_f32 v[44:45], v[44:45], v[94:95]
    v_cvt_pk_bf16_f32 v136, v42, v43
    v_cvt_pk_bf16_f32 v137, v44, v45
    ds_write_b64 v169, v[136:137]
    s_waitcnt lgkmcnt(3)
    v_pk_add_f32 v[46:47], v[46:47], v[96:97]
    v_pk_add_f32 v[48:49], v[48:49], v[98:99]
    v_cvt_pk_bf16_f32 v138, v46, v47
    v_cvt_pk_bf16_f32 v139, v48, v49
    ds_write_b64 v170, v[138:139]
    ds_read_b128 v[56:59], v171 offset:0
    ds_read_b128 v[140:143], v171 offset:1024
    s_waitcnt lgkmcnt(1)
    buffer_store_dwordx4 v[56:59], v6, s[44:47], s67 offen nt
    s_waitcnt lgkmcnt(0)
    buffer_store_dwordx4 v[140:143], v6, s[44:47], s68 offen nt
L_main_end_h15:
    s_endpgm
L_late2_h15:
    s_mov_b64 exec, s[6:7]
    s_mov_b32 s70, 0x20000
L_poll3_h15:
    buffer_load_dword v3, v20, s[48:51], s71 offen offset:128 sc1
    s_waitcnt vmcnt(0)
    v_cmp_eq_u32 vcc, 0, v3
    s_sub_u32 s70, s70, 1
    s_cbranch_scc1 L_pd3_h15
    s_cbranch_vccnz L_poll3_h15
L_pd3_h15:
    s_mov_b64 exec, -1
    s_branch L_back2_h15
L_late4_h15:
    s_mov_b64 exec, s[6:7]
    s_mov_b32 s70, 0x20000
L_poll5_h15:
    buffer_load_dword v33, v20, s[48:51], s71 offen offset:256 sc1
    s_waitcnt vmcnt(0)
    v_cmp_eq_u32 vcc, 0, v33
    s_sub_u32 s70, s70, 1
    s_cbranch_scc1 L_pd5_h15
    s_cbranch_vccnz L_poll5_h15
L_pd5_h15:
    s_mov_b64 exec, -1
    s_branch L_back4_h15
L_late6_h15:
    s_mov_b64 exec, s[6:7]
    s_mov_b32 s70, 0x20000
L_poll7_h15:
    buffer_load_dword v25, v20, s[48:51], s71 offen offset:384 sc1
    s_waitcnt vmcnt(0)
    v_cmp_eq_u32 vcc, 0, v25
    s_sub_u32 s70, s70, 1
    s_cbranch_scc1 L_pd7_h15
    s_cbranch_vccnz L_poll7_h15
L_pd7_h15:
    s_mov_b64 exec, -1
    s_branch L_back6_h15
L_late8_h15:
    s_mov_b64 exec, s[6:7]
    s_mov_b32 s70, 0x20000
L_poll9_h15:
    buffer_load_dword v3, v20, s[48:51], s71 offen offset:512 sc1
    s_waitcnt vmcnt(0)
    v_cmp_eq_u32 vcc, 0, v3
    s_sub_u32 s70, s70, 1
    s_cbranch_scc1 L_pd9_h15
    s_cbranch_vccnz L_poll9_h15
L_pd9_h15:
    s_mov_b64 exec, -1
    s_branch L_back8_h15
L_code_end:
L_slow_body:
    s_mov_b32 m0, s22
    s_mov_b32 exec_hi, 0
    buffer_load_dwordx4 v17, s[48:51], s23 offen sc1 lds
    s_mov_b32 exec_hi, -1
    v_perm_b32 v98, v154, v154, v58
    v_perm_b32 v99, v154, v154, v59
    v_perm_b32 v100, v200, v200, v56
    v_perm_b32 v101, v200, v200, v57
    v_mfma_f32_16x16x32_bf16 v[76:79], v[194:197], v[96:99], 0
    v_perm_b32 v102, v200, v200, v58
    v_perm_b32 v103, v200, v200, v59
    v_cvt_pk_bf16_f32 v108, v68, v69
    v_cvt_pk_bf16_f32 v109, v70, v71
    v_mfma_f32_16x16x32_bf16 v[80:83], v[196:199], v[100:103], 0
    s_add_u32 s67, s87, 32768
    v_cvt_pk_bf16_f32 v110, v72, v73
    v_cvt_pk_bf16_f32 v111, v74, v75
    v_cvt_pk_bf16_f32 v112, v76, v77
    v_cvt_pk_bf16_f32 v113, v78, v79
    v_permlane16_swap_b32 v108, v110
    v_permlane16_swap_b32 v109, v111
    s_nop 0
    v_cvt_pk_bf16_f32 v114, v80, v81
    v_cvt_pk_bf16_f32 v115, v82, v83
    buffer_store_dwordx4 v[108:111], v17, s[44:47], s87 offen sc1
    v_permlane16_swap_b32 v112, v114
    v_permlane16_swap_b32 v113, v115
    buffer_store_dwordx4 v[112:115], v17, s[44:47], s67 offen sc1
    s_add_u32 m0, s66, 90112
    s_mov_b32 s38, s8
    buffer_load_dwordx4 v60, s[36:39], 0 offen lds
    v_lshl_add_u32 v4, v32, 10, v45
    v_add_u32 v4, 94208, v4
    v_xor_b32 v5, 0, v44
    v_add_u32 v7, v4, v5
    v_xor_b32 v5, 32, v44
    v_add_u32 v8, v4, v5
    v_xor_b32 v5, 64, v44
    v_add_u32 v9, v4, v5
    s_add_u32 m0, s66, 32768
    v_xor_b32 v5, 96, v44
    buffer_load_dwordx4 v61, s[36:39], 0 offen lds
    v_add_u32 v10, v4, v5
    s_lshl_b32 s67, s63, 5
    v_and_b32 v4, 7, v1
    v_lshl_add_u32 v18, v4, 2, s67
    v_mov_b32 v2, 1
    s_lshr_b32 s67, s60, 1
    s_lshl_b32 s67, s67, 10
    s_and_b32 s68, s60, 1
    s_add_u32 m0, s66, 36864
    s_nop 0
    buffer_load_dwordx4 v62, s[36:39], 0 offen lds
    s_lshl_b32 s68, s68, 8
    v_lshlrev_b32 v21, 4, v31
    v_and_b32 v4, 1, v32
    v_lshl_add_u32 v4, v4, 9, v21
    v_add_u32 v4, s68, v4
    v_lshrrev_b32 v5, 1, v32
    v_lshl_add_u32 v20, v5, 11, v4
    v_lshl_add_u32 v19, v5, 10, v4
    s_add_u32 m0, s66, 40960
    s_mov_b32 s17, 176128
    buffer_load_dwordx4 v60, s[36:39], s17 offen lds
    s_lshl_b32 s3, s65, 16
    s_lshl_b32 s69, s67, 5
    s_add_u32 s3, s3, s69
    v_lshlrev_b32 v34, 16, v144
    v_and_b32 v35, 0xffff0000, v144
    v_lshlrev_b32 v36, 16, v145
    v_and_b32 v37, 0xffff0000, v145
    v_lshlrev_b32 v38, 16, v146
    v_and_b32 v39, 0xffff0000, v146
    v_lshlrev_b32 v40, 16, v147
    v_and_b32 v41, 0xffff0000, v147
    v_lshlrev_b32 v46, 16, v148
    v_and_b32 v47, 0xffff0000, v148
    v_lshlrev_b32 v48, 16, v149
    v_and_b32 v49, 0xffff0000, v149
    v_lshlrev_b32 v54, 16, v150
    v_and_b32 v55, 0xffff0000, v150
    v_lshlrev_b32 v56, 16, v151
    v_and_b32 v57, 0xffff0000, v151
    s_lshl_b32 s16, s63, 11
    s_add_u32 s16, s16, s67
    s_lshr_b32 s67, s68, 5
    s_add_u32 s16, s16, s67
    s_lshl2_add_u32 s88, s68, s88
    s_and_b32 s67, s61, 6
    s_lshl_b32 s67, s67, 7
    s_add_u32 s16, s16, s67
    s_and_b32 s67, s61, 1
    s_lshl2_add_u32 s16, s67, s16
    s_add_u32 s16, s16, s73
    s_add_u32 s16, s16, 131072
    v_and_b32 v4, 1, v31
    v_mul_u32_u24 v4, 1088, v4
    v_lshl_add_u32 v4, v32, 4, v4
    v_add_u32 v23, 161536, v4
    v_mov_b32 v133, 0
    s_waitcnt vmcnt(4)
    s_barrier
    s_mov_b64 exec, s[4:5]
    buffer_store_dword v2, off, s[48:51], s79 sc1
    s_mov_b64 exec, -1
    s_add_u32 m0, s66, 45056
    ds_read_b64_tr_b16 a[0:1], v7 offset:20480
    buffer_load_dwordx4 v61, s[36:39], s17 offen lds
    ds_read_b64_tr_b16 a[2:3], v7 offset:20992
    ds_read_b64_tr_b16 a[4:5], v8 offset:20480
    ds_read_b64_tr_b16 a[6:7], v8 offset:20992
    ds_read_b64_tr_b16 a[8:9], v9 offset:20480
    ds_read_b64_tr_b16 a[10:11], v9 offset:20992
    ds_read_b64_tr_b16 a[12:13], v10 offset:20480
    ds_read_b64_tr_b16 a[14:15], v10 offset:20992
    ds_read_b128 v[68:71], v23 offset:0
    s_add_u32 m0, s66, 49152
    ds_read_b64_tr_b16 a[16:17], v7 offset:24576
    buffer_load_dwordx4 v62, s[36:39], s17 offen lds
    ds_read_b64_tr_b16 a[18:19], v7 offset:25088
    ds_read_b64_tr_b16 a[20:21], v8 offset:24576
    ds_read_b64_tr_b16 a[22:23], v8 offset:25088
    ds_read_b64_tr_b16 a[24:25], v9 offset:24576
    ds_read_b64_tr_b16 a[26:27], v9 offset:25088
    ds_read_b64_tr_b16 a[28:29], v10 offset:24576
    ds_read_b64_tr_b16 a[30:31], v10 offset:25088
    ds_read_b128 v[72:75], v23 offset:64
    s_add_u32 m0, s66, 53248
    s_mov_b32 s18, 352256
    buffer_load_dwordx4 v60, s[36:39], s18 offen lds
    ds_read_b64_tr_b16 a[32:33], v7 offset:28672
    ds_read_b64_tr_b16 a[34:35], v7 offset:29184
    ds_read_b64_tr_b16 a[36:37], v8 offset:28672
    ds_read_b64_tr_b16 a[38:39], v8 offset:29184
    ds_read_b64_tr_b16 a[40:41], v9 offset:28672
    ds_read_b64_tr_b16 a[42:43], v9 offset:29184
    ds_read_b64_tr_b16 a[44:45], v10 offset:28672
    ds_read_b64_tr_b16 a[46:47], v10 offset:29184
    s_add_u32 m0, s66, 57344
    ds_read_b128 v[76:79], v23 offset:128
    buffer_load_dwordx4 v61, s[36:39], s18 offen lds
    ds_read_b64_tr_b16 a[48:49], v7 offset:32768
    ds_read_b64_tr_b16 a[50:51], v7 offset:33280
    ds_read_b64_tr_b16 a[52:53], v8 offset:32768
    ds_read_b64_tr_b16 a[54:55], v8 offset:33280
    ds_read_b64_tr_b16 a[56:57], v9 offset:32768
    ds_read_b64_tr_b16 a[58:59], v9 offset:33280
    ds_read_b64_tr_b16 a[60:61], v10 offset:32768
    ds_read_b64_tr_b16 a[62:63], v10 offset:33280
    ds_read_b128 v[80:83], v23 offset:192
    s_mov_b64 exec, 0
    s_cmp_eq_u32 s60, 0
    s_nop 0
    s_cmp_eq_u32 s60, 1
    s_nop 0
    s_cmp_eq_u32 s60, 2
    s_nop 0
    s_cmp_eq_u32 s60, 3
    s_nop 0
L_ret_v1_w:
    s_mov_b64 exec, -1
    s_mov_b64 exec, s[6:7]
    buffer_load_dword v3, v18, s[48:51], s71 offen offset:0 sc1
    s_mov_b64 exec, -1
    s_add_u32 m0, s66, 61440
    ds_read_b64_tr_b16 a[64:65], v7 offset:36864
    buffer_load_dwordx4 v62, s[36:39], s18 offen lds
    ds_read_b64_tr_b16 a[66:67], v7 offset:37376
    ds_read_b64_tr_b16 a[68:69], v8 offset:36864
    ds_read_b64_tr_b16 a[70:71], v8 offset:37376
    ds_read_b64_tr_b16 a[72:73], v9 offset:36864
    ds_read_b64_tr_b16 a[74:75], v9 offset:37376
    ds_read_b64_tr_b16 a[76:77], v10 offset:36864
    ds_read_b64_tr_b16 a[78:79], v10 offset:37376
    ds_read_b128 v[84:87], v23 offset:256
    s_add_u32 m0, s66, 16384
    s_mov_b32 s19, 528384
    buffer_load_dwordx4 v60, s[36:39], s19 offen lds
    ds_read_b64_tr_b16 a[80:81], v7 offset:40960
    ds_read_b64_tr_b16 a[82:83], v7 offset:41472
    ds_read_b64_tr_b16 a[84:85], v8 offset:40960
    ds_read_b64_tr_b16 a[86:87], v8 offset:41472
    ds_read_b64_tr_b16 a[88:89], v9 offset:40960
    ds_read_b64_tr_b16 a[90:91], v9 offset:41472
    ds_read_b64_tr_b16 a[92:93], v10 offset:40960
    ds_read_b64_tr_b16 a[94:95], v10 offset:41472
    s_add_u32 m0, s66, 20480
    ds_read_b128 v[88:91], v23 offset:320
    buffer_load_dwordx4 v61, s[36:39], s19 offen lds
    ds_read_b64_tr_b16 a[96:97], v7 offset:45056
    ds_read_b64_tr_b16 a[98:99], v7 offset:45568
    ds_read_b64_tr_b16 a[100:101], v8 offset:45056
    ds_read_b64_tr_b16 a[102:103], v8 offset:45568
    ds_read_b64_tr_b16 a[104:105], v9 offset:45056
    ds_read_b64_tr_b16 a[106:107], v9 offset:45568
    ds_read_b64_tr_b16 a[108:109], v10 offset:45056
    ds_read_b64_tr_b16 a[110:111], v10 offset:45568
    ds_read_b128 v[92:95], v23 offset:384
    s_waitcnt vmcnt(3)
    v_cmp_eq_u32 vcc, 0, v3
    s_nop 0
    s_and_b64 vcc, vcc, s[6:7]
    s_cbranch_vccnz L_late0_w
L_back0_w:
    s_barrier
    buffer_load_dwordx4 v[136:139], v19, s[44:47], s3 offen offset:0 sc1
    ds_read_b64_tr_b16 a[112:113], v7 offset:49152
    ds_read_b64_tr_b16 a[114:115], v7 offset:49664
    ds_read_b64_tr_b16 a[116:117], v8 offset:49152
    ds_read_b64_tr_b16 a[118:119], v8 offset:49664
    ds_read_b64_tr_b16 a[120:121], v9 offset:49152
    buffer_load_dwordx4 v[140:143], v19, s[44:47], s3 offen offset:2048 sc1
    ds_read_b64_tr_b16 a[122:123], v9 offset:49664
    ds_read_b64_tr_b16 a[124:125], v10 offset:49152
    ds_read_b64_tr_b16 a[126:127], v10 offset:49664
    ds_read_b128 v[96:99], v23 offset:448
    ds_read_b64_tr_b16 a[128:129], v7 offset:53248
    s_add_u32 s3, s3, 4096
    buffer_load_dwordx4 v[152:155], v19, s[44:47], s3 offen offset:0 sc1
    ds_read_b64_tr_b16 a[130:131], v7 offset:53760
    ds_read_b64_tr_b16 a[132:133], v8 offset:53248
    ds_read_b64_tr_b16 a[134:135], v8 offset:53760
    ds_read_b64_tr_b16 a[136:137], v9 offset:53248
    ds_read_b64_tr_b16 a[138:139], v9 offset:53760
    buffer_load_dwordx4 v[156:159], v19, s[44:47], s3 offen offset:2048 sc1
    ds_read_b64_tr_b16 a[140:141], v10 offset:53248
    ds_read_b64_tr_b16 a[142:143], v10 offset:53760
    ds_read_b128 v[100:103], v23 offset:512
    ds_read_b64_tr_b16 a[144:145], v7 offset:57344
    ds_read_b64_tr_b16 a[146:147], v7 offset:57856
    s_add_u32 s3, s3, 4096
    buffer_load_dwordx4 v[160:163], v19, s[44:47], s3 offen offset:0 sc1
    ds_read_b64_tr_b16 a[148:149], v8 offset:57344
    ds_read_b64_tr_b16 a[150:151], v8 offset:57856
    ds_read_b64_tr_b16 a[152:153], v9 offset:57344
    ds_read_b64_tr_b16 a[154:155], v9 offset:57856
    ds_read_b64_tr_b16 a[156:157], v10 offset:57344
    s_waitcnt vmcnt(4) lgkmcnt(14)
    v_mfma_f32_16x16x32_bf16 v[132:135], v[68:71], v[136:139], v[132:135]
    ds_read_b64_tr_b16 a[158:159], v10 offset:57856
    buffer_load_dwordx4 v[164:167], v19, s[44:47], s3 offen offset:2048 sc1
    v_mfma_f32_16x16x32_bf16 v[34:37], a[0:3], v[136:139], v[34:37]
    s_add_u32 s3, s3, 4096
    ds_read_b128 v[104:107], v23 offset:576
    v_mfma_f32_16x16x32_bf16 v[38:41], a[4:7], v[136:139], v[38:41]
    ds_read_b64_tr_b16 a[160:161], v7 offset:61440
    v_mfma_f32_16x16x32_bf16 v[46:49], a[8:11], v[136:139], v[46:49]
    ds_read_b64_tr_b16 a[162:163], v7 offset:61952
    v_mfma_f32_16x16x32_bf16 v[54:57], a[12:15], v[136:139], v[54:57]
    ds_read_b64_tr_b16 a[164:165], v8 offset:61440
    buffer_load_dwordx4 v[168:171], v19, s[44:47], s3 offen offset:0 sc1
    s_waitcnt vmcnt(5)
    v_mfma_f32_16x16x32_bf16 v[132:135], v[72:75], v[140:143], v[132:135]
    ds_read_b64_tr_b16 a[166:167], v8 offset:61952
    v_mfma_f32_16x16x32_bf16 v[34:37], a[16:19], v[140:143], v[34:37]
    ds_read_b64_tr_b16 a[168:169], v9 offset:61440
    v_mfma_f32_16x16x32_bf16 v[38:41], a[20:23], v[140:143], v[38:41]
    ds_read_b64_tr_b16 a[170:171], v9 offset:61952
    v_mfma_f32_16x16x32_bf16 v[46:49], a[24:27], v[140:143], v[46:49]
    ds_read_b64_tr_b16 a[172:173], v10 offset:61440
    buffer_load_dwordx4 v[172:175], v19, s[44:47], s3 offen offset:2048 sc1
    v_mfma_f32_16x16x32_bf16 v[54:57], a[28:31], v[140:143], v[54:57]
    s_add_u32 s3, s3, 4096
    ds_read_b64_tr_b16 a[174:175], v10 offset:61952
    s_waitcnt vmcnt(5)
    v_mfma_f32_16x16x32_bf16 v[132:135], v[76:79], v[152:155], v[132:135]
    ds_read_b128 v[108:111], v23 offset:640
    v_mfma_f32_16x16x32_bf16 v[34:37], a[32:35], v[152:155], v[34:37]
    ds_read_b64_tr_b16 a[176:177], v7 offset:0
    v_mfma_f32_16x16x32_bf16 v[38:41], a[36:39], v[152:155], v[38:41]
    ds_read_b64_tr_b16 a[178:179], v7 offset:512
    buffer_load_dwordx4 v[176:179], v19, s[44:47], s3 offen offset:0 sc1
    v_mfma_f32_16x16x32_bf16 v[46:49], a[40:43], v[152:155], v[46:49]
    ds_read_b64_tr_b16 a[180:181], v8 offset:0
    v_mfma_f32_16x16x32_bf16 v[54:57], a[44:47], v[152:155], v[54:57]
    ds_read_b64_tr_b16 a[182:183], v8 offset:512
    s_waitcnt vmcnt(5)
    v_mfma_f32_16x16x32_bf16 v[132:135], v[80:83], v[156:159], v[132:135]
    ds_read_b64_tr_b16 a[184:185], v9 offset:0
    v_mfma_f32_16x16x32_bf16 v[34:37], a[48:51], v[156:159], v[34:37]
    ds_read_b64_tr_b16 a[186:187], v9 offset:512
    buffer_load_dwordx4 v[180:183], v19, s[44:47], s3 offen offset:2048 sc1
    v_mfma_f32_16x16x32_bf16 v[38:41], a[52:55], v[156:159], v[38:41]
    s_add_u32 s3, s3, 4096
    ds_read_b64_tr_b16 a[188:189], v10 offset:0
    v_mfma_f32_16x16x32_bf16 v[46:49], a[56:59], v[156:159], v[46:49]
    ds_read_b64_tr_b16 a[190:191], v10 offset:512
    v_mfma_f32_16x16x32_bf16 v[54:57], a[60:63], v[156:159], v[54:57]
    ds_read_b128 v[112:115], v23 offset:704
    s_waitcnt vmcnt(5)
    v_mfma_f32_16x16x32_bf16 v[132:135], v[84:87], v[160:163], v[132:135]
    ds_read_b64_tr_b16 a[192:193], v7 offset:4096
    buffer_load_dwordx4 v[184:187], v19, s[44:47], s3 offen offset:0 sc1
    v_mfma_f32_16x16x32_bf16 v[34:37], a[64:67], v[160:163], v[34:37]
    ds_read_b64_tr_b16 a[194:195], v7 offset:4608
    v_mfma_f32_16x16x32_bf16 v[38:41], a[68:71], v[160:163], v[38:41]
    ds_read_b64_tr_b16 a[196:197], v8 offset:4096
    v_mfma_f32_16x16x32_bf16 v[46:49], a[72:75], v[160:163], v[46:49]
    ds_read_b64_tr_b16 a[198:199], v8 offset:4608
    v_mfma_f32_16x16x32_bf16 v[54:57], a[76:79], v[160:163], v[54:57]
    ds_read_b64_tr_b16 a[200:201], v9 offset:4096
    buffer_load_dwordx4 v[188:191], v19, s[44:47], s3 offen offset:2048 sc1
    s_waitcnt vmcnt(6)
    v_mfma_f32_16x16x32_bf16 v[132:135], v[88:91], v[164:167], v[132:135]
    s_add_u32 s3, s3, 4096
    ds_read_b64_tr_b16 a[202:203], v9 offset:4608
    v_mfma_f32_16x16x32_bf16 v[34:37], a[80:83], v[164:167], v[34:37]
    ds_read_b64_tr_b16 a[204:205], v10 offset:4096
    v_mfma_f32_16x16x32_bf16 v[38:41], a[84:87], v[164:167], v[38:41]
    ds_read_b64_tr_b16 a[206:207], v10 offset:4608
    v_mfma_f32_16x16x32_bf16 v[46:49], a[88:91], v[164:167], v[46:49]
    ds_read_b128 v[116:119], v23 offset:768
    buffer_load_dwordx4 v[192:195], v19, s[44:47], s3 offen offset:0 sc1
    v_mfma_f32_16x16x32_bf16 v[54:57], a[92:95], v[164:167], v[54:57]
    ds_read_b64_tr_b16 a[208:209], v7 offset:8192
    s_waitcnt vmcnt(6)
    v_mfma_f32_16x16x32_bf16 v[132:135], v[92:95], v[168:171], v[132:135]
    ds_read_b64_tr_b16 a[210:211], v7 offset:8704
    v_mfma_f32_16x16x32_bf16 v[34:37], a[96:99], v[168:171], v[34:37]
    ds_read_b64_tr_b16 a[212:213], v8 offset:8192
    v_mfma_f32_16x16x32_bf16 v[38:41], a[100:103], v[168:171], v[38:41]
    ds_read_b64_tr_b16 a[214:215], v8 offset:8704
    buffer_load_dwordx4 v[196:199], v19, s[44:47], s3 offen offset:2048 sc1
    v_mfma_f32_16x16x32_bf16 v[46:49], a[104:107], v[168:171], v[46:49]
    s_add_u32 s3, s3, 4096
    ds_read_b64_tr_b16 a[216:217], v9 offset:8192
    v_mfma_f32_16x16x32_bf16 v[54:57], a[108:111], v[168:171], v[54:57]
    ds_read_b64_tr_b16 a[218:219], v9 offset:8704
    s_waitcnt vmcnt(6)
    v_mfma_f32_16x16x32_bf16 v[132:135], v[96:99], v[172:175], v[132:135]
    ds_read_b64_tr_b16 a[220:221], v10 offset:8192
    v_mfma_f32_16x16x32_bf16 v[34:37], a[112:115], v[172:175], v[34:37]
    ds_read_b64_tr_b16 a[222:223], v10 offset:8704
    buffer_load_dwordx4 v[200:203], v19, s[44:47], s3 offen offset:0 sc1
    v_mfma_f32_16x16x32_bf16 v[38:41], a[116:119], v[172:175], v[38:41]
    ds_read_b128 v[120:123], v23 offset:832
    v_mfma_f32_16x16x32_bf16 v[46:49], a[120:123], v[172:175], v[46:49]
    ds_read_b64_tr_b16 a[224:225], v7 offset:12288
    v_mfma_f32_16x16x32_bf16 v[54:57], a[124:127], v[172:175], v[54:57]
    ds_read_b64_tr_b16 a[226:227], v7 offset:12800
    s_waitcnt vmcnt(6) lgkmcnt(14)
    v_mfma_f32_16x16x32_bf16 v[132:135], v[100:103], v[176:179], v[132:135]
    ds_read_b64_tr_b16 a[228:229], v8 offset:12288
    buffer_load_dwordx4 v[204:207], v19, s[44:47], s3 offen offset:2048 sc1
    v_mfma_f32_16x16x32_bf16 v[34:37], a[128:131], v[176:179], v[34:37]
    s_add_u32 m0, s66, 65536
    ds_read_b64_tr_b16 a[230:231], v8 offset:12800
    v_mfma_f32_16x16x32_bf16 v[38:41], a[132:135], v[176:179], v[38:41]
    ds_read_b64_tr_b16 a[232:233], v9 offset:12288
    v_mfma_f32_16x16x32_bf16 v[46:49], a[136:139], v[176:179], v[46:49]
    ds_read_b64_tr_b16 a[234:235], v9 offset:12800
    v_mfma_f32_16x16x32_bf16 v[54:57], a[140:143], v[176:179], v[54:57]
    ds_read_b64_tr_b16 a[236:237], v10 offset:12288
    buffer_load_dwordx4 v62, s[36:39], s19 offen lds
    s_waitcnt vmcnt(7)
    v_mfma_f32_16x16x32_bf16 v[132:135], v[104:107], v[180:183], v[132:135]
    s_add_u32 m0, s66, 69632
    ds_read_b64_tr_b16 a[238:239], v10 offset:12800
    v_mfma_f32_16x16x32_bf16 v[34:37], a[144:147], v[180:183], v[34:37]
    s_mov_b32 s22, 704512
    ds_read_b128 v[124:127], v23 offset:896
    v_mfma_f32_16x16x32_bf16 v[38:41], a[148:151], v[180:183], v[38:41]
    ds_read_b64_tr_b16 a[240:241], v7 offset:16384
    v_mfma_f32_16x16x32_bf16 v[46:49], a[152:155], v[180:183], v[46:49]
    ds_read_b64_tr_b16 a[242:243], v7 offset:16896
    buffer_load_dwordx4 v60, s[36:39], s22 offen lds
    v_mfma_f32_16x16x32_bf16 v[54:57], a[156:159], v[180:183], v[54:57]
    s_add_u32 m0, s66, 73728
    ds_read_b64_tr_b16 a[244:245], v8 offset:16384
    s_waitcnt vmcnt(7)
    v_mfma_f32_16x16x32_bf16 v[132:135], v[108:111], v[184:187], v[132:135]
    ds_read_b64_tr_b16 a[246:247], v8 offset:16896
    v_mfma_f32_16x16x32_bf16 v[34:37], a[160:163], v[184:187], v[34:37]
    ds_read_b64_tr_b16 a[248:249], v9 offset:16384
    v_mfma_f32_16x16x32_bf16 v[38:41], a[164:167], v[184:187], v[38:41]
    ds_read_b64_tr_b16 a[250:251], v9 offset:16896
    buffer_load_dwordx4 v61, s[36:39], s22 offen lds
    v_mfma_f32_16x16x32_bf16 v[46:49], a[168:171], v[184:187], v[46:49]
    s_add_u32 m0, s66, 77824
    ds_read_b64_tr_b16 a[252:253], v10 offset:16384
    v_mfma_f32_16x16x32_bf16 v[54:57], a[172:175], v[184:187], v[54:57]
    ds_read_b64_tr_b16 a[254:255], v10 offset:16896
    s_waitcnt vmcnt(7)
    v_mfma_f32_16x16x32_bf16 v[132:135], v[112:115], v[188:191], v[132:135]
    ds_read_b128 v[128:131], v23 offset:960
    v_mfma_f32_16x16x32_bf16 v[34:37], a[176:179], v[188:191], v[34:37]
    buffer_load_dwordx4 v62, s[36:39], s22 offen lds
    s_add_u32 m0, s66, 81920
    v_mfma_f32_16x16x32_bf16 v[38:41], a[180:183], v[188:191], v[38:41]
    s_mov_b32 s23, 880640
    v_mfma_f32_16x16x32_bf16 v[46:49], a[184:187], v[188:191], v[46:49]
    v_mfma_f32_16x16x32_bf16 v[54:57], a[188:191], v[188:191], v[54:57]
    s_waitcnt vmcnt(7) lgkmcnt(14)
    v_mfma_f32_16x16x32_bf16 v[132:135], v[116:119], v[192:195], v[132:135]
    buffer_load_dwordx4 v60, s[36:39], s23 offen lds
    v_mfma_f32_16x16x32_bf16 v[34:37], a[192:195], v[192:195], v[34:37]
    v_mfma_f32_16x16x32_bf16 v[38:41], a[196:199], v[192:195], v[38:41]
    v_mfma_f32_16x16x32_bf16 v[46:49], a[200:203], v[192:195], v[46:49]
    v_mfma_f32_16x16x32_bf16 v[54:57], a[204:207], v[192:195], v[54:57]
    s_waitcnt vmcnt(7)
    v_mfma_f32_16x16x32_bf16 v[132:135], v[120:123], v[196:199], v[132:135]
    v_mfma_f32_16x16x32_bf16 v[34:37], a[208:211], v[196:199], v[34:37]
    v_mfma_f32_16x16x32_bf16 v[38:41], a[212:215], v[196:199], v[38:41]
    v_mfma_f32_16x16x32_bf16 v[46:49], a[216:219], v[196:199], v[46:49]
    v_mfma_f32_16x16x32_bf16 v[54:57], a[220:223], v[196:199], v[54:57]
    s_waitcnt vmcnt(6) lgkmcnt(9)
    v_mfma_f32_16x16x32_bf16 v[132:135], v[124:127], v[200:203], v[132:135]
    v_mfma_f32_16x16x32_bf16 v[34:37], a[224:227], v[200:203], v[34:37]
    v_mfma_f32_16x16x32_bf16 v[38:41], a[228:231], v[200:203], v[38:41]
    v_mfma_f32_16x16x32_bf16 v[46:49], a[232:235], v[200:203], v[46:49]
    v_mfma_f32_16x16x32_bf16 v[54:57], a[236:239], v[200:203], v[54:57]
    s_waitcnt vmcnt(5) lgkmcnt(0)
    v_mfma_f32_16x16x32_bf16 v[132:135], v[128:131], v[204:207], v[132:135]
    v_mfma_f32_16x16x32_bf16 v[34:37], a[240:243], v[204:207], v[34:37]
    v_mfma_f32_16x16x32_bf16 v[38:41], a[244:247], v[204:207], v[38:41]
    v_mfma_f32_16x16x32_bf16 v[46:49], a[248:251], v[204:207], v[46:49]
    v_mfma_f32_16x16x32_bf16 v[54:57], a[252:255], v[204:207], v[54:57]
    s_barrier
    s_nop 2
    v_add_f32 v132, v132, v133
    v_pk_add_f32 v[168:169], v[34:35], v[132:133] op_sel_hi:[1,0]
    v_pk_add_f32 v[170:171], v[36:37], v[132:133] op_sel_hi:[1,0]
    v_pk_add_f32 v[172:173], v[38:39], v[132:133] op_sel_hi:[1,0]
    v_pk_add_f32 v[174:175], v[40:41], v[132:133] op_sel_hi:[1,0]
    v_pk_add_f32 v[176:177], v[46:47], v[132:133] op_sel_hi:[1,0]
    v_pk_add_f32 v[178:179], v[48:49], v[132:133] op_sel_hi:[1,0]
    v_pk_add_f32 v[180:181], v[54:55], v[132:133] op_sel_hi:[1,0]
    v_pk_add_f32 v[182:183], v[56:57], v[132:133] op_sel_hi:[1,0]
    v_cvt_pk_bf16_f32 v136, v168, v170
    v_cvt_pk_bf16_f32 v137, v172, v174
    v_cvt_pk_bf16_f32 v138, v176, v178
    v_cvt_pk_bf16_f32 v139, v180, v182
    v_cvt_pk_bf16_f32 v140, v169, v171
    v_cvt_pk_bf16_f32 v141, v173, v175
    v_cvt_pk_bf16_f32 v142, v177, v179
    v_cvt_pk_bf16_f32 v143, v181, v183
    v_mfma_f32_16x16x32_bf16 v[152:155], v[136:139], v[136:139], 0
    buffer_store_dwordx4 v[136:139], v17, s[48:51], s88 offen sc1
    v_mfma_f32_16x16x32_bf16 v[152:155], v[140:143], v[140:143], v[152:155]
    buffer_store_dwordx4 v[140:143], v17, s[48:51], s88 offen offset:2048 sc1
    v_cvt_pk_bf16_f32 v144, v34, v35
    v_cvt_pk_bf16_f32 v145, v36, v37
    v_cvt_pk_bf16_f32 v146, v38, v39
    v_cvt_pk_bf16_f32 v147, v40, v41
    v_cvt_pk_bf16_f32 v148, v46, v47
    v_cvt_pk_bf16_f32 v149, v48, v49
    v_cvt_pk_bf16_f32 v150, v54, v55
    v_cndmask_b32 v152, v152, v153, s[10:11]
    v_cndmask_b32 v154, v154, v155, s[10:11]
    v_cndmask_b32 v157, v152, v154, s[12:13]
    s_mov_b64 exec, s[14:15]
    buffer_store_dword v157, v21, s[48:51], s16 offen sc1
    s_mov_b64 exec, -1
    v_cvt_pk_bf16_f32 v151, v56, v57
    s_add_u32 m0, s66, 86016
    v_lshlrev_b32 v4, 9, v32
    buffer_load_dwordx4 v61, s[36:39], s23 offen lds
    v_add3_u32 v7, v4, v45, v44
    v_xor_b32 v8, 32, v7
    v_xor_b32 v9, 64, v7
    v_xor_b32 v10, 96, v7
    s_add_u32 m0, s66, 24576
    v_lshrrev_b32 v4, 2, v1
    buffer_load_dwordx4 v62, s[36:39], s23 offen lds
    v_and_b32 v5, 3, v1
    v_lshlrev_b32 v5, 3, v5
    v_lshl_add_u32 v4, v4, 6, v5
    v_and_b32 v5, 1, v32
    s_add_u32 m0, s66, 28672
    s_mov_b32 s59, 1056768
    buffer_load_dwordx4 v60, s[36:39], s59 offen lds
    v_lshl_add_u32 v11, v5, 5, v4
    v_xor_b32 v14, 32, v11
    v_lshlrev_b32 v20, 2, v31
    s_lshl_b32 s70, s60, 15
    s_add_u32 m0, s66, 0
    s_nop 0
    buffer_load_dwordx4 v61, s[36:39], s59 offen lds
    s_add_u32 s3, s70, s73
    s_waitcnt vmcnt(4)
    s_barrier
    s_mov_b64 exec, s[4:5]
    buffer_store_dword v2, off, s[48:51], s79 offset:128 sc1
    s_mov_b64 exec, -1
    s_add_u32 m0, s66, 4096
    v_add_u32 v13, 65536, v7
    buffer_load_dwordx4 v62, s[36:39], s59 offen lds
    ds_read_b64_tr_b16 a[208:209], v13 offset:24576
    ds_read_b64_tr_b16 a[210:211], v7 offset:32768
    ds_read_b64_tr_b16 a[212:213], v13 offset:26624
    ds_read_b64_tr_b16 a[214:215], v7 offset:34816
    v_add_u32 v23, 65536, v8
    ds_read_b64_tr_b16 a[216:217], v23 offset:24576
    s_add_u32 m0, s66, 8192
    s_mov_b32 s74, 1232896
    buffer_load_dwordx4 v60, s[36:39], s74 offen lds
    ds_read_b64_tr_b16 a[218:219], v8 offset:32768
    ds_read_b64_tr_b16 a[220:221], v23 offset:26624
    ds_read_b64_tr_b16 a[222:223], v8 offset:34816
    ds_read_b64_tr_b16 a[224:225], v11 offset:36864
    ds_read_b64_tr_b16 a[226:227], v11 offset:37888
    ds_read_b64_tr_b16 a[228:229], v11 offset:38912
    s_add_u32 m0, s66, 12288
    ds_read_b64_tr_b16 a[230:231], v11 offset:39936
    buffer_load_dwordx4 v61, s[36:39], s74 offen lds
    s_add_u32 m0, s66, 94208
    s_nop 0
    buffer_load_dwordx4 v62, s[36:39], s74 offen lds
    s_add_u32 m0, s66, 98304
    s_mov_b32 s38, s9
    v_add_u32 v60, s56, v60
    v_add_u32 v61, s56, v61
    buffer_load_dwordx4 v60, s[36:39], 0 offen lds
    s_cmp_ge_u32 s62, 14
    s_nop 0
    s_mov_b64 exec, s[6:7]
    buffer_load_dword v3, v20, s[48:51], s71 offen offset:128 sc1
    s_mov_b64 exec, -1
    s_add_u32 m0, s66, 102400
    s_nop 0
    buffer_load_dwordx4 v61, s[36:39], 0 offen lds
    s_add_u32 m0, s66, 106496
    s_nop 0
    buffer_load_dwordx4 v60, s[36:39], s17 offen lds
    s_add_u32 m0, s66, 110592
    s_nop 0
    buffer_load_dwordx4 v61, s[36:39], s17 offen lds
    s_add_u32 m0, s66, 114688
    s_nop 0
    buffer_load_dwordx4 v60, s[36:39], s18 offen lds
    s_waitcnt vmcnt(4)
    v_cmp_eq_u32 vcc, 0, v3
    s_nop 0
    s_and_b64 vcc, vcc, s[6:7]
    s_cbranch_vccnz L_late2_w
L_back2_w:
    s_barrier
    buffer_load_dwordx4 a[0:3], v17, s[48:51], s3 offen offset:0 sc1
    buffer_load_dwordx4 a[4:7], v17, s[48:51], s3 offen offset:1024 sc1
    buffer_load_dwordx4 a[8:11], v17, s[48:51], s3 offen offset:2048 sc1
    buffer_load_dwordx4 a[12:15], v17, s[48:51], s3 offen offset:3072 sc1
    s_add_u32 s10, s66, s73
    s_add_u32 s10, s10, 131072
    s_lshl_b32 s68, s60, 15
    s_lshl_b32 s69, s62, 11
    s_add_u32 s69, s69, s68
    s_add_u32 s12, s69, s73
    s_lshl_b32 s15, s64, 17
    s_add_u32 s11, s15, s69
    s_lshr_b32 s68, s60, 1
    s_lshl1_add_u32 s68, s63, s68
    s_lshl_b32 s68, s68, 15
    s_add_u32 s15, s15, s68
    s_add_u32 s16, s73, s68
    s_and_b32 s58, s60, 1
    s_lshl_b32 s57, s58, 30
    s_add_u32 s57, s57, s15
    s_add_u32 s3, s3, 4096
    s_add_u32 s57, s57, 28672
    buffer_load_dwordx4 a[16:19], v17, s[48:51], s3 offen offset:0 sc1
    s_mul_i32 s68, s58, 3072
    v_add_u32 v22, s68, v17
    v_xor_b32 v21, 1024, v22
    v_lshl_add_u32 v15, s58, 11, v7
    v_lshl_add_u32 v16, s58, 11, v8
    v_lshl_add_u32 v18, s58, 11, v9
    v_lshl_add_u32 v19, s58, 11, v10
    buffer_load_dwordx4 a[20:23], v17, s[48:51], s3 offen offset:1024 sc1
    buffer_load_dwordx4 a[24:27], v17, s[48:51], s3 offen offset:2048 sc1
    buffer_load_dwordx4 a[28:31], v17, s[48:51], s3 offen offset:3072 sc1
    s_add_u32 s3, s3, 4096
    buffer_load_dwordx4 a[32:35], v17, s[48:51], s3 offen offset:0 sc1
    s_waitcnt vmcnt(7) lgkmcnt(10)
    v_mfma_f32_16x16x32_bf16 v[34:37], a[208:211], a[0:3], 0
    ds_read_b64_tr_b16 a[232:233], v14 offset:36864
    ds_read_b64_tr_b16 a[234:235], v14 offset:37888
    v_mfma_f32_16x16x32_bf16 v[38:41], a[208:211], a[4:7], 0
    buffer_load_dwordx4 a[36:39], v17, s[48:51], s3 offen offset:1024 sc1
    s_waitcnt lgkmcnt(10)
    v_mfma_f32_16x16x32_bf16 v[42:45], a[212:215], a[0:3], 0
    ds_read_b64_tr_b16 a[236:237], v14 offset:38912
    v_mfma_f32_16x16x32_bf16 v[46:49], a[212:215], a[4:7], 0
    ds_read_b64_tr_b16 a[238:239], v14 offset:39936
    s_waitcnt lgkmcnt(10)
    v_mfma_f32_16x16x32_bf16 v[68:71], a[216:219], a[0:3], 0
    ds_read_b64_tr_b16 a[240:241], v7 offset:40960
    v_mfma_f32_16x16x32_bf16 v[72:75], a[216:219], a[4:7], 0
    ds_read_b64_tr_b16 a[242:243], v7 offset:45056
    s_waitcnt lgkmcnt(10)
    v_mfma_f32_16x16x32_bf16 v[76:79], a[220:223], a[0:3], 0
    ds_read_b64_tr_b16 a[244:245], v7 offset:43008
    ds_read_b64_tr_b16 a[246:247], v7 offset:47104
    v_mfma_f32_16x16x32_bf16 v[80:83], a[220:223], a[4:7], 0
    s_waitcnt lgkmcnt(4)
    buffer_load_dwordx4 a[40:43], v17, s[48:51], s3 offen offset:2048 sc1
    s_waitcnt vmcnt(7)
    v_mfma_f32_16x16x32_bf16 v[34:37], a[224:227], a[8:11], v[34:37]
    ds_read_b64_tr_b16 a[248:249], v8 offset:40960
    ds_read_b64_tr_b16 a[250:251], v8 offset:45056
    v_mfma_f32_16x16x32_bf16 v[38:41], a[224:227], a[12:15], v[38:41]
    buffer_load_dwordx4 a[44:47], v17, s[48:51], s3 offen offset:3072 sc1
    v_mfma_f32_16x16x32_bf16 v[42:45], a[228:231], a[8:11], v[42:45]
    ds_read_b64_tr_b16 a[252:253], v8 offset:43008
    v_mfma_f32_16x16x32_bf16 v[46:49], a[228:231], a[12:15], v[46:49]
    ds_read_b64_tr_b16 a[254:255], v8 offset:47104
    v_mfma_f32_16x16x32_bf16 v[68:71], a[232:235], a[8:11], v[68:71]
    ds_read_b64_tr_b16 a[208:209], v11 offset:49152
    v_mfma_f32_16x16x32_bf16 v[72:75], a[232:235], a[12:15], v[72:75]
    ds_read_b64_tr_b16 a[210:211], v11 offset:50176
    v_mfma_f32_16x16x32_bf16 v[76:79], a[236:239], a[8:11], v[76:79]
    s_add_u32 s3, s3, 4096
    ds_read_b64_tr_b16 a[212:213], v11 offset:51200
    ds_read_b64_tr_b16 a[214:215], v11 offset:52224
    v_mfma_f32_16x16x32_bf16 v[80:83], a[236:239], a[12:15], v[80:83]
    s_waitcnt lgkmcnt(4)
    buffer_load_dwordx4 a[48:51], v17, s[48:51], s3 offen offset:0 sc1
    s_waitcnt vmcnt(7)
    v_mfma_f32_16x16x32_bf16 v[34:37], a[240:243], a[16:19], v[34:37]
    ds_read_b64_tr_b16 a[216:217], v14 offset:49152
    ds_read_b64_tr_b16 a[218:219], v14 offset:50176
    v_mfma_f32_16x16x32_bf16 v[38:41], a[240:243], a[20:23], v[38:41]
    buffer_load_dwordx4 a[52:55], v17, s[48:51], s3 offen offset:1024 sc1
    v_mfma_f32_16x16x32_bf16 v[42:45], a[244:247], a[16:19], v[42:45]
    ds_read_b64_tr_b16 a[220:221], v14 offset:51200
    v_mfma_f32_16x16x32_bf16 v[46:49], a[244:247], a[20:23], v[46:49]
    ds_read_b64_tr_b16 a[222:223], v14 offset:52224
    v_mfma_f32_16x16x32_bf16 v[68:71], a[248:251], a[16:19], v[68:71]
    ds_read_b64_tr_b16 a[224:225], v7 offset:53248
    v_mfma_f32_16x16x32_bf16 v[72:75], a[248:251], a[20:23], v[72:75]
    ds_read_b64_tr_b16 a[226:227], v7 offset:57344
    v_mfma_f32_16x16x32_bf16 v[76:79], a[252:255], a[16:19], v[76:79]
    ds_read_b64_tr_b16 a[228:229], v7 offset:55296
    ds_read_b64_tr_b16 a[230:231], v7 offset:59392
    v_mfma_f32_16x16x32_bf16 v[80:83], a[252:255], a[20:23], v[80:83]
    s_waitcnt lgkmcnt(4)
    buffer_load_dwordx4 a[56:59], v17, s[48:51], s3 offen offset:2048 sc1
    s_waitcnt vmcnt(7)
    v_mfma_f32_16x16x32_bf16 v[34:37], a[208:211], a[24:27], v[34:37]
    ds_read_b64_tr_b16 a[232:233], v8 offset:53248
    ds_read_b64_tr_b16 a[234:235], v8 offset:57344
    v_mfma_f32_16x16x32_bf16 v[38:41], a[208:211], a[28:31], v[38:41]
    buffer_load_dwordx4 a[60:63], v17, s[48:51], s3 offen offset:3072 sc1
    v_mfma_f32_16x16x32_bf16 v[42:45], a[212:215], a[24:27], v[42:45]
    ds_read_b64_tr_b16 a[236:237], v8 offset:55296
    v_mfma_f32_16x16x32_bf16 v[46:49], a[212:215], a[28:31], v[46:49]
    ds_read_b64_tr_b16 a[238:239], v8 offset:59392
    v_mfma_f32_16x16x32_bf16 v[68:71], a[216:219], a[24:27], v[68:71]
    ds_read_b64_tr_b16 a[240:241], v11 offset:61440
    v_mfma_f32_16x16x32_bf16 v[72:75], a[216:219], a[28:31], v[72:75]
    ds_read_b64_tr_b16 a[242:243], v11 offset:62464
    v_mfma_f32_16x16x32_bf16 v[76:79], a[220:223], a[24:27], v[76:79]
    s_add_u32 s3, s3, 4096
    ds_read_b64_tr_b16 a[244:245], v11 offset:63488
    ds_read_b64_tr_b16 a[246:247], v11 offset:64512
    v_mfma_f32_16x16x32_bf16 v[80:83], a[220:223], a[28:31], v[80:83]
    s_waitcnt lgkmcnt(4)
    buffer_load_dwordx4 a[64:67], v17, s[48:51], s3 offen offset:0 sc1
    s_waitcnt vmcnt(7)
    v_mfma_f32_16x16x32_bf16 v[34:37], a[224:227], a[32:35], v[34:37]
    ds_read_b64_tr_b16 a[248:249], v14 offset:61440
    ds_read_b64_tr_b16 a[250:251], v14 offset:62464
    v_mfma_f32_16x16x32_bf16 v[38:41], a[224:227], a[36:39], v[38:41]
    buffer_load_dwordx4 a[68:71], v17, s[48:51], s3 offen offset:1024 sc1
    v_mfma_f32_16x16x32_bf16 v[42:45], a[228:231], a[32:35], v[42:45]
    ds_read_b64_tr_b16 a[252:253], v14 offset:63488
    v_mfma_f32_16x16x32_bf16 v[46:49], a[228:231], a[36:39], v[46:49]
    ds_read_b64_tr_b16 a[254:255], v14 offset:64512
    v_mfma_f32_16x16x32_bf16 v[68:71], a[232:235], a[32:35], v[68:71]
    ds_read_b64_tr_b16 a[208:209], v7 offset:16384
    v_mfma_f32_16x16x32_bf16 v[72:75], a[232:235], a[36:39], v[72:75]
    ds_read_b64_tr_b16 a[210:211], v7 offset:20480
    v_mfma_f32_16x16x32_bf16 v[76:79], a[236:239], a[32:35], v[76:79]
    ds_read_b64_tr_b16 a[212:213], v7 offset:18432
    ds_read_b64_tr_b16 a[214:215], v7 offset:22528
    v_mfma_f32_16x16x32_bf16 v[80:83], a[236:239], a[36:39], v[80:83]
    s_waitcnt lgkmcnt(4)
    buffer_load_dwordx4 a[72:75], v17, s[48:51], s3 offen offset:2048 sc1
    s_waitcnt vmcnt(7)
    v_mfma_f32_16x16x32_bf16 v[34:37], a[240:243], a[40:43], v[34:37]
    ds_read_b64_tr_b16 a[216:217], v8 offset:16384
    ds_read_b64_tr_b16 a[218:219], v8 offset:20480
    v_mfma_f32_16x16x32_bf16 v[38:41], a[240:243], a[44:47], v[38:41]
    buffer_load_dwordx4 a[76:79], v17, s[48:51], s3 offen offset:3072 sc1
    v_mfma_f32_16x16x32_bf16 v[42:45], a[244:247], a[40:43], v[42:45]
    ds_read_b64_tr_b16 a[220:221], v8 offset:18432
    ds_read_b64_tr_b16 a[222:223], v8 offset:22528
    v_mfma_f32_16x16x32_bf16 v[46:49], a[244:247], a[44:47], v[46:49]
    v_add_u32 v172, 65536, v11
    v_mfma_f32_16x16x32_bf16 v[68:71], a[248:251], a[40:43], v[68:71]
    ds_read_b64_tr_b16 a[224:225], v172 offset:0
    v_mfma_f32_16x16x32_bf16 v[72:75], a[248:251], a[44:47], v[72:75]
    ds_read_b64_tr_b16 a[226:227], v172 offset:1024
    v_mfma_f32_16x16x32_bf16 v[76:79], a[252:255], a[40:43], v[76:79]
    s_add_u32 s3, s3, 4096
    ds_read_b64_tr_b16 a[228:229], v172 offset:2048
    ds_read_b64_tr_b16 a[230:231], v172 offset:3072
    v_mfma_f32_16x16x32_bf16 v[80:83], a[252:255], a[44:47], v[80:83]
    s_waitcnt lgkmcnt(4)
    buffer_load_dwordx4 a[80:83], v17, s[48:51], s3 offen offset:0 sc1
    v_add_u32 v173, 65536, v14
    s_waitcnt vmcnt(7)
    v_mfma_f32_16x16x32_bf16 v[34:37], a[208:211], a[48:51], v[34:37]
    ds_read_b64_tr_b16 a[232:233], v173 offset:0
    ds_read_b64_tr_b16 a[234:235], v173 offset:1024
    v_mfma_f32_16x16x32_bf16 v[38:41], a[208:211], a[52:55], v[38:41]
    buffer_load_dwordx4 a[84:87], v17, s[48:51], s3 offen offset:1024 sc1
    v_mfma_f32_16x16x32_bf16 v[42:45], a[212:215], a[48:51], v[42:45]
    ds_read_b64_tr_b16 a[236:237], v173 offset:2048
    v_mfma_f32_16x16x32_bf16 v[46:49], a[212:215], a[52:55], v[46:49]
    ds_read_b64_tr_b16 a[238:239], v173 offset:3072
    v_mfma_f32_16x16x32_bf16 v[68:71], a[216:219], a[48:51], v[68:71]
    ds_read_b64_tr_b16 a[240:241], v13 offset:4096
    v_mfma_f32_16x16x32_bf16 v[72:75], a[216:219], a[52:55], v[72:75]
    ds_read_b64_tr_b16 a[242:243], v13 offset:8192
    v_mfma_f32_16x16x32_bf16 v[76:79], a[220:223], a[48:51], v[76:79]
    ds_read_b64_tr_b16 a[244:245], v13 offset:6144
    ds_read_b64_tr_b16 a[246:247], v13 offset:10240
    v_mfma_f32_16x16x32_bf16 v[80:83], a[220:223], a[52:55], v[80:83]
    s_waitcnt lgkmcnt(4)
    buffer_load_dwordx4 a[88:91], v17, s[48:51], s3 offen offset:2048 sc1
    s_waitcnt vmcnt(7)
    v_mfma_f32_16x16x32_bf16 v[34:37], a[224:227], a[56:59], v[34:37]
    ds_read_b64_tr_b16 a[248:249], v23 offset:4096
    ds_read_b64_tr_b16 a[250:251], v23 offset:8192
    v_mfma_f32_16x16x32_bf16 v[38:41], a[224:227], a[60:63], v[38:41]
    buffer_load_dwordx4 a[92:95], v17, s[48:51], s3 offen offset:3072 sc1
    v_mfma_f32_16x16x32_bf16 v[42:45], a[228:231], a[56:59], v[42:45]
    ds_read_b64_tr_b16 a[252:253], v23 offset:6144
    v_mfma_f32_16x16x32_bf16 v[46:49], a[228:231], a[60:63], v[46:49]
    ds_read_b64_tr_b16 a[254:255], v23 offset:10240
    v_mfma_f32_16x16x32_bf16 v[68:71], a[232:235], a[56:59], v[68:71]
    ds_read_b64_tr_b16 a[208:209], v172 offset:12288
    v_mfma_f32_16x16x32_bf16 v[72:75], a[232:235], a[60:63], v[72:75]
    ds_read_b64_tr_b16 a[210:211], v172 offset:13312
    v_mfma_f32_16x16x32_bf16 v[76:79], a[236:239], a[56:59], v[76:79]
    s_add_u32 s3, s3, 4096
    ds_read_b64_tr_b16 a[212:213], v172 offset:14336
    ds_read_b64_tr_b16 a[214:215], v172 offset:15360
    v_mfma_f32_16x16x32_bf16 v[80:83], a[236:239], a[60:63], v[80:83]
    s_waitcnt lgkmcnt(4)
    buffer_load_dwordx4 a[96:99], v17, s[48:51], s3 offen offset:0 sc1
    s_waitcnt vmcnt(7)
    v_mfma_f32_16x16x32_bf16 v[34:37], a[240:243], a[64:67], v[34:37]
    ds_read_b64_tr_b16 a[216:217], v173 offset:12288
    ds_read_b64_tr_b16 a[218:219], v173 offset:13312
    v_mfma_f32_16x16x32_bf16 v[38:41], a[240:243], a[68:71], v[38:41]
    buffer_load_dwordx4 a[100:103], v17, s[48:51], s3 offen offset:1024 sc1
    v_mfma_f32_16x16x32_bf16 v[42:45], a[244:247], a[64:67], v[42:45]
    ds_read_b64_tr_b16 a[220:221], v173 offset:14336
    ds_read_b64_tr_b16 a[222:223], v173 offset:15360
    v_mfma_f32_16x16x32_bf16 v[46:49], a[244:247], a[68:71], v[46:49]
    s_barrier
    v_mfma_f32_16x16x32_bf16 v[68:71], a[248:251], a[64:67], v[68:71]
    ds_read_b64_tr_b16 a[224:225], v13 offset:16384
    ds_read_b64_tr_b16 a[226:227], v13 offset:20480
    v_mfma_f32_16x16x32_bf16 v[72:75], a[248:251], a[68:71], v[72:75]
    buffer_load_dwordx4 a[104:107], v17, s[48:51], s3 offen offset:2048 sc1
    v_mfma_f32_16x16x32_bf16 v[76:79], a[252:255], a[64:67], v[76:79]
    ds_read_b64_tr_b16 a[228:229], v13 offset:18432
    ds_read_b64_tr_b16 a[230:231], v13 offset:22528
    v_mfma_f32_16x16x32_bf16 v[80:83], a[252:255], a[68:71], v[80:83]
    s_waitcnt vmcnt(7) lgkmcnt(4)
    v_mfma_f32_16x16x32_bf16 v[34:37], a[208:211], a[72:75], v[34:37]
    ds_read_b64_tr_b16 a[232:233], v23 offset:16384
    ds_read_b64_tr_b16 a[234:235], v23 offset:20480
    v_mfma_f32_16x16x32_bf16 v[38:41], a[208:211], a[76:79], v[38:41]
    buffer_load_dwordx4 a[108:111], v17, s[48:51], s3 offen offset:3072 sc1
    v_mfma_f32_16x16x32_bf16 v[42:45], a[212:215], a[72:75], v[42:45]
    ds_read_b64_tr_b16 a[236:237], v23 offset:18432
    v_mfma_f32_16x16x32_bf16 v[46:49], a[212:215], a[76:79], v[46:49]
    ds_read_b64_tr_b16 a[238:239], v23 offset:22528
    v_mfma_f32_16x16x32_bf16 v[68:71], a[216:219], a[72:75], v[68:71]
    ds_read_b64_tr_b16 a[240:241], v11 offset:24576
    v_mfma_f32_16x16x32_bf16 v[72:75], a[216:219], a[76:79], v[72:75]
    ds_read_b64_tr_b16 a[242:243], v11 offset:25600
    v_mfma_f32_16x16x32_bf16 v[76:79], a[220:223], a[72:75], v[76:79]
    s_add_u32 s3, s3, 4096
    ds_read_b64_tr_b16 a[244:245], v11 offset:26624
    ds_read_b64_tr_b16 a[246:247], v11 offset:27648
    v_mfma_f32_16x16x32_bf16 v[80:83], a[220:223], a[76:79], v[80:83]
    s_waitcnt lgkmcnt(4)
    buffer_load_dwordx4 a[112:115], v17, s[48:51], s3 offen offset:0 sc1
    s_waitcnt vmcnt(7)
    v_mfma_f32_16x16x32_bf16 v[34:37], a[224:227], a[80:83], v[34:37]
    ds_read_b64_tr_b16 a[248:249], v14 offset:24576
    ds_read_b64_tr_b16 a[250:251], v14 offset:25600
    v_mfma_f32_16x16x32_bf16 v[38:41], a[224:227], a[84:87], v[38:41]
    buffer_load_dwordx4 a[116:119], v17, s[48:51], s3 offen offset:1024 sc1
    v_mfma_f32_16x16x32_bf16 v[42:45], a[228:231], a[80:83], v[42:45]
    ds_read_b64_tr_b16 a[252:253], v14 offset:26624
    v_mfma_f32_16x16x32_bf16 v[46:49], a[228:231], a[84:87], v[46:49]
    ds_read_b64_tr_b16 a[254:255], v14 offset:27648
    v_mfma_f32_16x16x32_bf16 v[68:71], a[232:235], a[80:83], v[68:71]
    ds_read_b64_tr_b16 a[208:209], v7 offset:28672
    v_mfma_f32_16x16x32_bf16 v[72:75], a[232:235], a[84:87], v[72:75]
    ds_read_b64_tr_b16 a[210:211], v7 offset:0
    v_mfma_f32_16x16x32_bf16 v[76:79], a[236:239], a[80:83], v[76:79]
    ds_read_b64_tr_b16 a[212:213], v7 offset:30720
    ds_read_b64_tr_b16 a[214:215], v7 offset:2048
    v_mfma_f32_16x16x32_bf16 v[80:83], a[236:239], a[84:87], v[80:83]
    s_waitcnt lgkmcnt(4)
    buffer_load_dwordx4 a[120:123], v17, s[48:51], s3 offen offset:2048 sc1
    s_waitcnt vmcnt(7)
    v_mfma_f32_16x16x32_bf16 v[34:37], a[240:243], a[88:91], v[34:37]
    ds_read_b64_tr_b16 a[216:217], v8 offset:28672
    ds_read_b64_tr_b16 a[218:219], v8 offset:0
    v_mfma_f32_16x16x32_bf16 v[38:41], a[240:243], a[92:95], v[38:41]
    buffer_load_dwordx4 a[124:127], v17, s[48:51], s3 offen offset:3072 sc1
    v_mfma_f32_16x16x32_bf16 v[42:45], a[244:247], a[88:91], v[42:45]
    ds_read_b64_tr_b16 a[220:221], v8 offset:30720
    v_mfma_f32_16x16x32_bf16 v[46:49], a[244:247], a[92:95], v[46:49]
    ds_read_b64_tr_b16 a[222:223], v8 offset:2048
    v_mfma_f32_16x16x32_bf16 v[68:71], a[248:251], a[88:91], v[68:71]
    ds_read_b64_tr_b16 a[224:225], v11 offset:4096
    v_mfma_f32_16x16x32_bf16 v[72:75], a[248:251], a[92:95], v[72:75]
    ds_read_b64_tr_b16 a[226:227], v11 offset:5120
    v_mfma_f32_16x16x32_bf16 v[76:79], a[252:255], a[88:91], v[76:79]
    ds_read_b64_tr_b16 a[228:229], v11 offset:6144
    ds_read_b64_tr_b16 a[230:231], v11 offset:7168
    v_mfma_f32_16x16x32_bf16 v[80:83], a[252:255], a[92:95], v[80:83]
    s_waitcnt lgkmcnt(4)
    buffer_load_dwordx4 v[26:29], v17, s[48:51], s10 offen sc1
    s_waitcnt vmcnt(7)
    v_mfma_f32_16x16x32_bf16 v[34:37], a[208:211], a[96:99], v[34:37]
    s_add_u32 m0, s66, 118784
    ds_read_b64_tr_b16 a[232:233], v14 offset:4096
    ds_read_b64_tr_b16 a[234:235], v14 offset:5120
    v_mfma_f32_16x16x32_bf16 v[38:41], a[208:211], a[100:103], v[38:41]
    buffer_load_dwordx4 v61, s[36:39], s18 offen lds
    v_mfma_f32_16x16x32_bf16 v[42:45], a[212:215], a[96:99], v[42:45]
    ds_read_b64_tr_b16 a[236:237], v14 offset:6144
    v_mfma_f32_16x16x32_bf16 v[46:49], a[212:215], a[100:103], v[46:49]
    ds_read_b64_tr_b16 a[238:239], v14 offset:7168
    v_mfma_f32_16x16x32_bf16 v[68:71], a[216:219], a[96:99], v[68:71]
    ds_read_b64_tr_b16 a[240:241], v7 offset:8192
    v_mfma_f32_16x16x32_bf16 v[72:75], a[216:219], a[100:103], v[72:75]
    ds_read_b64_tr_b16 a[242:243], v7 offset:12288
    v_mfma_f32_16x16x32_bf16 v[76:79], a[220:223], a[96:99], v[76:79]
    s_add_u32 m0, s66, 122880
    ds_read_b64_tr_b16 a[244:245], v7 offset:10240
    ds_read_b64_tr_b16 a[246:247], v7 offset:14336
    v_mfma_f32_16x16x32_bf16 v[80:83], a[220:223], a[100:103], v[80:83]
    s_waitcnt lgkmcnt(4)
    buffer_load_dwordx4 v60, s[36:39], s19 offen lds
    s_waitcnt vmcnt(7)
    v_mfma_f32_16x16x32_bf16 v[34:37], a[224:227], a[104:107], v[34:37]
    s_add_u32 m0, s66, 126976
    ds_read_b64_tr_b16 a[248:249], v8 offset:8192
    ds_read_b64_tr_b16 a[250:251], v8 offset:12288
    v_mfma_f32_16x16x32_bf16 v[38:41], a[224:227], a[108:111], v[38:41]
    buffer_load_dwordx4 v61, s[36:39], s19 offen lds
    v_mfma_f32_16x16x32_bf16 v[42:45], a[228:231], a[104:107], v[42:45]
    ds_read_b64_tr_b16 a[252:253], v8 offset:10240
    v_mfma_f32_16x16x32_bf16 v[46:49], a[228:231], a[108:111], v[46:49]
    ds_read_b64_tr_b16 a[254:255], v8 offset:14336
    v_mfma_f32_16x16x32_bf16 v[68:71], a[232:235], a[104:107], v[68:71]
    ds_read_b64_tr_b16 a[208:209], v172 offset:28672
    v_mfma_f32_16x16x32_bf16 v[72:75], a[232:235], a[108:111], v[72:75]
    ds_read_b64_tr_b16 a[210:211], v172 offset:29696
    v_mfma_f32_16x16x32_bf16 v[76:79], a[236:239], a[104:107], v[76:79]
    s_add_u32 m0, s66, 131072
    ds_read_b64_tr_b16 a[212:213], v172 offset:30720
    ds_read_b64_tr_b16 a[214:215], v172 offset:31744
    v_mfma_f32_16x16x32_bf16 v[80:83], a[236:239], a[108:111], v[80:83]
    s_waitcnt lgkmcnt(4)
    buffer_load_dwordx4 v60, s[36:39], s22 offen lds
    s_waitcnt vmcnt(7)
    v_mfma_f32_16x16x32_bf16 v[34:37], a[240:243], a[112:115], v[34:37]
    s_add_u32 m0, s66, 135168
    ds_read_b64_tr_b16 a[216:217], v173 offset:28672
    ds_read_b64_tr_b16 a[218:219], v173 offset:29696
    v_mfma_f32_16x16x32_bf16 v[38:41], a[240:243], a[116:119], v[38:41]
    buffer_load_dwordx4 v61, s[36:39], s22 offen lds
    v_mfma_f32_16x16x32_bf16 v[42:45], a[244:247], a[112:115], v[42:45]
    ds_read_b64_tr_b16 a[220:221], v173 offset:30720
    ds_read_b64_tr_b16 a[222:223], v173 offset:31744
    v_mfma_f32_16x16x32_bf16 v[46:49], a[244:247], a[116:119], v[46:49]
    v_add_u32 v174, 65536, v9
    v_mfma_f32_16x16x32_bf16 v[68:71], a[248:251], a[112:115], v[68:71]
    ds_read_b64_tr_b16 a[224:225], v174 offset:24576
    v_mfma_f32_16x16x32_bf16 v[72:75], a[248:251], a[116:119], v[72:75]
    ds_read_b64_tr_b16 a[226:227], v9 offset:32768
    v_mfma_f32_16x16x32_bf16 v[76:79], a[252:255], a[112:115], v[76:79]
    s_add_u32 m0, s66, 139264
    ds_read_b64_tr_b16 a[228:229], v174 offset:26624
    ds_read_b64_tr_b16 a[230:231], v9 offset:34816
    v_mfma_f32_16x16x32_bf16 v[80:83], a[252:255], a[116:119], v[80:83]
    s_waitcnt lgkmcnt(4)
    buffer_load_dwordx4 v60, s[36:39], s23 offen lds
    v_add_u32 v175, 65536, v10
    s_waitcnt vmcnt(7)
    v_mfma_f32_16x16x32_bf16 v[34:37], a[208:211], a[120:123], v[34:37]
    s_add_u32 m0, s66, 143360
    ds_read_b64_tr_b16 a[232:233], v175 offset:24576
    ds_read_b64_tr_b16 a[234:235], v10 offset:32768
    v_mfma_f32_16x16x32_bf16 v[38:41], a[208:211], a[124:127], v[38:41]
    buffer_load_dwordx4 v61, s[36:39], s23 offen lds
    v_mfma_f32_16x16x32_bf16 v[42:45], a[212:215], a[120:123], v[42:45]
    ds_read_b64_tr_b16 a[236:237], v175 offset:26624
    v_mfma_f32_16x16x32_bf16 v[46:49], a[212:215], a[124:127], v[46:49]
    ds_read_b64_tr_b16 a[238:239], v10 offset:34816
    v_mfma_f32_16x16x32_bf16 v[68:71], a[216:219], a[120:123], v[68:71]
    ds_read_b64_tr_b16 a[240:241], v9 offset:40960
    ds_read_b64_tr_b16 a[242:243], v9 offset:45056
    v_mfma_f32_16x16x32_bf16 v[72:75], a[216:219], a[124:127], v[72:75]
    s_waitcnt vmcnt(7)
    v_add_f32 v26, v26, v27
    v_add_f32 v28, v28, v29
    v_mfma_f32_16x16x32_bf16 v[76:79], a[220:223], a[120:123], v[76:79]
    s_add_u32 m0, s66, 147456
    ds_read_b64_tr_b16 a[244:245], v9 offset:43008
    ds_read_b64_tr_b16 a[246:247], v9 offset:47104
    v_mfma_f32_16x16x32_bf16 v[80:83], a[220:223], a[124:127], v[80:83]
    s_waitcnt lgkmcnt(4)
    buffer_load_dwordx4 v60, s[36:39], s59 offen lds
    v_permlane32_swap_b32 v26, v28
    v_mfma_f32_16x16x32_bf16 v[84:87], a[224:227], a[0:3], 0
    ds_read_b64_tr_b16 a[248:249], v10 offset:40960
    ds_read_b64_tr_b16 a[250:251], v10 offset:45056
    v_mfma_f32_16x16x32_bf16 v[88:91], a[224:227], a[4:7], 0
    v_add_f32 v27, v26, v28
    v_add_f32 v26, v26, v28
    v_mfma_f32_16x16x32_bf16 v[92:95], a[228:231], a[0:3], 0
    s_add_u32 m0, s66, 151552
    ds_read_b64_tr_b16 a[252:253], v10 offset:43008
    ds_read_b64_tr_b16 a[254:255], v10 offset:47104
    v_mfma_f32_16x16x32_bf16 v[96:99], a[228:231], a[4:7], 0
    buffer_load_dwordx4 v61, s[36:39], s59 offen lds
    v_permlane16_swap_b32 v26, v27
    v_mfma_f32_16x16x32_bf16 v[100:103], a[232:235], a[0:3], 0
    ds_read_b64_tr_b16 a[208:209], v9 offset:53248
    ds_read_b64_tr_b16 a[210:211], v9 offset:57344
    v_mfma_f32_16x16x32_bf16 v[104:107], a[232:235], a[4:7], 0
    v_add_f32 v26, v26, v27
    v_fma_f32 v54, v26, s1, v30
    v_fma_f32 v55, v26, s1, v30
    v_mfma_f32_16x16x32_bf16 v[108:111], a[236:239], a[0:3], 0
    s_add_u32 m0, s66, 155648
    ds_read_b64_tr_b16 a[212:213], v9 offset:55296
    ds_read_b64_tr_b16 a[214:215], v9 offset:59392
    v_mfma_f32_16x16x32_bf16 v[112:115], a[236:239], a[4:7], 0
    s_waitcnt lgkmcnt(4)
    buffer_load_dwordx4 v60, s[36:39], s74 offen lds
    v_permlane32_swap_b32 v54, v55
    v_mfma_f32_16x16x32_bf16 v[84:87], a[240:243], a[16:19], v[84:87]
    ds_read_b64_tr_b16 a[216:217], v10 offset:53248
    ds_read_b64_tr_b16 a[218:219], v10 offset:57344
    v_mfma_f32_16x16x32_bf16 v[88:91], a[240:243], a[20:23], v[88:91]
    v_rsq_f32 v26, v54
    v_mfma_f32_16x16x32_bf16 v[92:95], a[244:247], a[16:19], v[92:95]
    ds_read_b64_tr_b16 a[220:221], v10 offset:55296
    ds_read_b64_tr_b16 a[222:223], v10 offset:59392
    v_mfma_f32_16x16x32_bf16 v[96:99], a[244:247], a[20:23], v[96:99]
    v_rsq_f32 v27, v55
    v_mul_f32 v50, 0xc0135761, v26
    v_mfma_f32_16x16x32_bf16 v[100:103], a[248:251], a[16:19], v[100:103]
    s_add_u32 m0, s66, 36864
    ds_read_b64_tr_b16 a[224:225], v9 offset:16384
    ds_read_b64_tr_b16 a[226:227], v9 offset:20480
    v_mfma_f32_16x16x32_bf16 v[104:107], a[248:251], a[20:23], v[104:107]
    buffer_load_dwordx4 v61, s[36:39], s74 offen lds
    v_mul_f32 v26, v26, v26
    v_mul_f32 v51, 0x3d372713, v50
    v_mfma_f32_16x16x32_bf16 v[108:111], a[252:255], a[16:19], v[108:111]
    ds_read_b64_tr_b16 a[228:229], v9 offset:18432
    ds_read_b64_tr_b16 a[230:231], v9 offset:22528
    v_mfma_f32_16x16x32_bf16 v[112:115], a[252:255], a[20:23], v[112:115]
    s_waitcnt lgkmcnt(4)
    v_mul_f32 v51, v51, v26
    v_mul_f32 v52, 0xc0135761, v27
    v_mul_f32 v27, v27, v27
    v_mfma_f32_16x16x32_bf16 v[84:87], a[208:211], a[32:35], v[84:87]
    s_add_u32 m0, s66, 49152
    s_lshl1_add_u32 s52, s56, 0xffffdfc0
    v_add_u32 v62, s52, v62
    ds_read_b64_tr_b16 a[232:233], v10 offset:16384
    ds_read_b64_tr_b16 a[234:235], v10 offset:20480
    v_mfma_f32_16x16x32_bf16 v[88:91], a[208:211], a[36:39], v[88:91]
    buffer_load_dwordx4 v62, s[36:39], 0 offen lds
    v_mul_f32 v53, 0x3d372713, v52
    v_mul_f32 v53, v53, v27
    v_mfma_f32_16x16x32_bf16 v[92:95], a[212:215], a[32:35], v[92:95]
    ds_read_b64_tr_b16 a[236:237], v10 offset:18432
    ds_read_b64_tr_b16 a[238:239], v10 offset:22528
    v_mfma_f32_16x16x32_bf16 v[96:99], a[212:215], a[36:39], v[96:99]
    v_pk_mul_f32 v[132:133], v[34:35], v[34:35]
    v_pk_mul_f32 v[134:135], v[36:37], v[36:37]
    v_pk_mul_f32 v[136:137], v[38:39], v[38:39]
    v_pk_mul_f32 v[138:139], v[40:41], v[40:41]
    v_pk_fma_f32 v[132:133], v[132:133], v[50:51], v[50:51] op_sel:[0,1,0] op_sel_hi:[1,1,0]
    v_pk_fma_f32 v[134:135], v[134:135], v[50:51], v[50:51] op_sel:[0,1,0] op_sel_hi:[1,1,0]
    v_pk_fma_f32 v[136:137], v[136:137], v[52:53], v[52:53] op_sel:[0,1,0] op_sel_hi:[1,1,0]
    v_pk_fma_f32 v[138:139], v[138:139], v[52:53], v[52:53] op_sel:[0,1,0] op_sel_hi:[1,1,0]
    v_pk_mul_f32 v[132:133], v[132:133], v[34:35]
    v_pk_mul_f32 v[134:135], v[134:135], v[36:37]
    v_pk_mul_f32 v[136:137], v[136:137], v[38:39]
    v_pk_mul_f32 v[138:139], v[138:139], v[40:41]
    v_mfma_f32_16x16x32_bf16 v[100:103], a[216:219], a[32:35], v[100:103]
    ds_read_b64_tr_b16 a[240:241], v174 offset:4096
    ds_read_b64_tr_b16 a[242:243], v174 offset:8192
    v_mfma_f32_16x16x32_bf16 v[104:107], a[216:219], a[36:39], v[104:107]
    v_exp_f32 v132, v132
    v_mfma_f32_16x16x32_bf16 v[108:111], a[220:223], a[32:35], v[108:111]
    s_add_u32 m0, s66, 61440
    ds_read_b64_tr_b16 a[244:245], v174 offset:6144
    ds_read_b64_tr_b16 a[246:247], v174 offset:10240
    v_mfma_f32_16x16x32_bf16 v[112:115], a[220:223], a[36:39], v[112:115]
    s_waitcnt lgkmcnt(4)
    buffer_load_dwordx4 v62, s[36:39], s17 offen lds
    v_exp_f32 v133, v133
    s_waitcnt vmcnt(12)
    s_barrier
    v_mfma_f32_16x16x32_bf16 v[84:87], a[224:227], a[48:51], v[84:87]
    ds_read_b64_tr_b16 a[248:249], v175 offset:4096
    ds_read_b64_tr_b16 a[250:251], v175 offset:8192
    v_mfma_f32_16x16x32_bf16 v[88:91], a[224:227], a[52:55], v[88:91]
    v_exp_f32 v134, v134
    v_mfma_f32_16x16x32_bf16 v[92:95], a[228:231], a[48:51], v[92:95]
    ds_read_b64_tr_b16 a[252:253], v175 offset:6144
    ds_read_b64_tr_b16 a[254:255], v175 offset:10240
    v_mfma_f32_16x16x32_bf16 v[96:99], a[228:231], a[52:55], v[96:99]
    v_exp_f32 v135, v135
    v_mfma_f32_16x16x32_bf16 v[100:103], a[232:235], a[48:51], v[100:103]
    ds_read_b64_tr_b16 a[208:209], v174 offset:16384
    ds_read_b64_tr_b16 a[210:211], v174 offset:20480
    v_mfma_f32_16x16x32_bf16 v[104:107], a[232:235], a[52:55], v[104:107]
    v_exp_f32 v136, v136
    v_mfma_f32_16x16x32_bf16 v[108:111], a[236:239], a[48:51], v[108:111]
    s_add_u32 m0, s66, 65536
    ds_read_b64_tr_b16 a[212:213], v174 offset:18432
    ds_read_b64_tr_b16 a[214:215], v174 offset:22528
    v_mfma_f32_16x16x32_bf16 v[112:115], a[236:239], a[52:55], v[112:115]
    s_waitcnt lgkmcnt(4)
    buffer_load_dwordx4 v62, s[36:39], s18 offen lds
    v_exp_f32 v137, v137
    v_mfma_f32_16x16x32_bf16 v[84:87], a[240:243], a[64:67], v[84:87]
    ds_read_b64_tr_b16 a[216:217], v175 offset:16384
    ds_read_b64_tr_b16 a[218:219], v175 offset:20480
    v_mfma_f32_16x16x32_bf16 v[88:91], a[240:243], a[68:71], v[88:91]
    v_exp_f32 v138, v138
    v_exp_f32 v139, v139
    v_pk_mul_f32 v[42:43], v[34:35], v[42:43]
    v_pk_mul_f32 v[44:45], v[36:37], v[44:45]
    v_pk_mul_f32 v[46:47], v[38:39], v[46:47]
    v_pk_mul_f32 v[48:49], v[40:41], v[48:49]
    v_pk_fma_f32 v[132:133], v[132:133], v[54:55], v[54:55] op_sel:[0,0,0] op_sel_hi:[1,0,0]
    v_pk_fma_f32 v[134:135], v[134:135], v[54:55], v[54:55] op_sel:[0,0,0] op_sel_hi:[1,0,0]
    v_pk_fma_f32 v[136:137], v[136:137], v[54:55], v[54:55] op_sel:[0,1,1] op_sel_hi:[1,1,1]
    v_pk_fma_f32 v[138:139], v[138:139], v[54:55], v[54:55] op_sel:[0,1,1] op_sel_hi:[1,1,1]
    v_mfma_f32_16x16x32_bf16 v[92:95], a[244:247], a[64:67], v[92:95]
    ds_read_b64_tr_b16 a[220:221], v175 offset:18432
    ds_read_b64_tr_b16 a[222:223], v175 offset:22528
    v_mfma_f32_16x16x32_bf16 v[96:99], a[244:247], a[68:71], v[96:99]
    v_rcp_f32 v132, v132
    v_mfma_f32_16x16x32_bf16 v[100:103], a[248:251], a[64:67], v[100:103]
    ds_read_b64_tr_b16 a[224:225], v9 offset:28672
    ds_read_b64_tr_b16 a[226:227], v9 offset:0
    v_mfma_f32_16x16x32_bf16 v[104:107], a[248:251], a[68:71], v[104:107]
    v_rcp_f32 v133, v133
    v_mfma_f32_16x16x32_bf16 v[108:111], a[252:255], a[64:67], v[108:111]
    s_add_u32 m0, s66, 90112
    ds_read_b64_tr_b16 a[228:229], v9 offset:30720
    ds_read_b64_tr_b16 a[230:231], v9 offset:2048
    v_mfma_f32_16x16x32_bf16 v[112:115], a[252:255], a[68:71], v[112:115]
    s_waitcnt lgkmcnt(4)
    buffer_load_dwordx4 v62, s[36:39], s19 offen lds
    v_rcp_f32 v134, v134
    v_mfma_f32_16x16x32_bf16 v[84:87], a[208:211], a[80:83], v[84:87]
    ds_read_b64_tr_b16 a[232:233], v10 offset:28672
    ds_read_b64_tr_b16 a[234:235], v10 offset:0
    v_mfma_f32_16x16x32_bf16 v[88:91], a[208:211], a[84:87], v[88:91]
    v_rcp_f32 v135, v135
    v_mfma_f32_16x16x32_bf16 v[92:95], a[212:215], a[80:83], v[92:95]
    ds_read_b64_tr_b16 a[236:237], v10 offset:30720
    ds_read_b64_tr_b16 a[238:239], v10 offset:2048
    v_mfma_f32_16x16x32_bf16 v[96:99], a[212:215], a[84:87], v[96:99]
    v_rcp_f32 v136, v136
    v_mfma_f32_16x16x32_bf16 v[100:103], a[216:219], a[80:83], v[100:103]
    ds_read_b64_tr_b16 a[240:241], v9 offset:8192
    ds_read_b64_tr_b16 a[242:243], v9 offset:12288
    v_mfma_f32_16x16x32_bf16 v[104:107], a[216:219], a[84:87], v[104:107]
    v_rcp_f32 v137, v137
    v_mfma_f32_16x16x32_bf16 v[108:111], a[220:223], a[80:83], v[108:111]
    ds_read_b64_tr_b16 a[244:245], v9 offset:10240
    ds_read_b64_tr_b16 a[246:247], v9 offset:14336
    v_mfma_f32_16x16x32_bf16 v[112:115], a[220:223], a[84:87], v[112:115]
    s_waitcnt lgkmcnt(4)
    v_rcp_f32 v138, v138
    v_rcp_f32 v139, v139
    v_pk_mul_f32 v[42:43], v[42:43], v[132:133]
    v_pk_mul_f32 v[44:45], v[44:45], v[134:135]
    v_pk_mul_f32 v[46:47], v[46:47], v[136:137]
    v_pk_mul_f32 v[48:49], v[48:49], v[138:139]
    v_mfma_f32_16x16x32_bf16 v[84:87], a[224:227], a[96:99], v[84:87]
    s_add_u32 m0, s66, 32768
    ds_read_b64_tr_b16 a[248:249], v10 offset:8192
    ds_read_b64_tr_b16 a[250:251], v10 offset:12288
    v_mfma_f32_16x16x32_bf16 v[88:91], a[224:227], a[100:103], v[88:91]
    buffer_load_dwordx4 v62, s[36:39], s22 offen lds
    v_cvt_pk_bf16_f32 v56, v42, v43
    v_cvt_pk_bf16_f32 v57, v44, v45
    v_mfma_f32_16x16x32_bf16 v[92:95], a[228:231], a[96:99], v[92:95]
    ds_read_b64_tr_b16 a[252:253], v10 offset:10240
    ds_read_b64_tr_b16 a[254:255], v10 offset:14336
    v_mfma_f32_16x16x32_bf16 v[96:99], a[228:231], a[100:103], v[96:99]
    v_cvt_pk_bf16_f32 v140, v46, v47
    v_cvt_pk_bf16_f32 v141, v48, v49
    v_mfma_f32_16x16x32_bf16 v[100:103], a[232:235], a[96:99], v[100:103]
    ds_read_b64_tr_b16 a[208:209], v13 offset:32768
    ds_read_b64_tr_b16 a[210:211], v13 offset:36864
    v_mfma_f32_16x16x32_bf16 v[104:107], a[232:235], a[100:103], v[104:107]
    v_pk_mul_f32 v[132:133], v[68:69], v[68:69]
    v_pk_mul_f32 v[134:135], v[70:71], v[70:71]
    v_pk_mul_f32 v[136:137], v[72:73], v[72:73]
    v_pk_mul_f32 v[138:139], v[74:75], v[74:75]
    v_pk_fma_f32 v[132:133], v[132:133], v[50:51], v[50:51] op_sel:[0,1,0] op_sel_hi:[1,1,0]
    v_pk_fma_f32 v[134:135], v[134:135], v[50:51], v[50:51] op_sel:[0,1,0] op_sel_hi:[1,1,0]
    v_pk_fma_f32 v[136:137], v[136:137], v[52:53], v[52:53] op_sel:[0,1,0] op_sel_hi:[1,1,0]
    v_pk_fma_f32 v[138:139], v[138:139], v[52:53], v[52:53] op_sel:[0,1,0] op_sel_hi:[1,1,0]
    v_pk_mul_f32 v[132:133], v[132:133], v[68:69]
    v_pk_mul_f32 v[134:135], v[134:135], v[70:71]
    v_pk_mul_f32 v[136:137], v[136:137], v[72:73]
    v_pk_mul_f32 v[138:139], v[138:139], v[74:75]
    v_mfma_f32_16x16x32_bf16 v[108:111], a[236:239], a[96:99], v[108:111]
    s_add_u32 m0, s66, 40960
    ds_read_b64_tr_b16 a[212:213], v13 offset:34816
    ds_read_b64_tr_b16 a[214:215], v13 offset:38912
    v_mfma_f32_16x16x32_bf16 v[112:115], a[236:239], a[100:103], v[112:115]
    s_waitcnt lgkmcnt(4)
    buffer_load_dwordx4 v62, s[36:39], s23 offen lds
    v_exp_f32 v132, v132
    v_mfma_f32_16x16x32_bf16 v[84:87], a[240:243], a[112:115], v[84:87]
    ds_read_b64_tr_b16 a[216:217], v13 offset:40960
    ds_read_b64_tr_b16 a[218:219], v13 offset:45056
    v_mfma_f32_16x16x32_bf16 v[88:91], a[240:243], a[116:119], v[88:91]
    v_exp_f32 v133, v133
    v_mfma_f32_16x16x32_bf16 v[92:95], a[244:247], a[112:115], v[92:95]
    ds_read_b64_tr_b16 a[220:221], v13 offset:43008
    ds_read_b64_tr_b16 a[222:223], v13 offset:47104
    v_mfma_f32_16x16x32_bf16 v[96:99], a[244:247], a[116:119], v[96:99]
    v_exp_f32 v134, v134
    v_mfma_f32_16x16x32_bf16 v[100:103], a[248:251], a[112:115], v[100:103]
    ds_read_b64_tr_b16 a[224:225], v13 offset:49152
    ds_read_b64_tr_b16 a[226:227], v13 offset:53248
    v_mfma_f32_16x16x32_bf16 v[104:107], a[248:251], a[116:119], v[104:107]
    v_exp_f32 v135, v135
    v_mfma_f32_16x16x32_bf16 v[108:111], a[252:255], a[112:115], v[108:111]
    s_add_u32 m0, s66, 45056
    ds_read_b64_tr_b16 a[228:229], v13 offset:51200
    ds_read_b64_tr_b16 a[230:231], v13 offset:55296
    v_mfma_f32_16x16x32_bf16 v[112:115], a[252:255], a[116:119], v[112:115]
    s_waitcnt lgkmcnt(4)
    buffer_load_dwordx4 v62, s[36:39], s59 offen lds
    v_exp_f32 v136, v136
    s_waitcnt vmcnt(7)
    s_barrier
    v_mfma_f32_16x16x32_bf16 v[84:87], a[208:211], a[8:11], v[84:87]
    ds_read_b64_tr_b16 a[232:233], v13 offset:57344
    ds_read_b64_tr_b16 a[234:235], v13 offset:61440
    v_mfma_f32_16x16x32_bf16 v[88:91], a[208:211], a[12:15], v[88:91]
    v_exp_f32 v137, v137
    v_mfma_f32_16x16x32_bf16 v[92:95], a[212:215], a[8:11], v[92:95]
    ds_read_b64_tr_b16 a[236:237], v13 offset:59392
    ds_read_b64_tr_b16 a[238:239], v13 offset:63488
    v_mfma_f32_16x16x32_bf16 v[96:99], a[212:215], a[12:15], v[96:99]
    v_add_u32 v176, 131072, v7
    v_exp_f32 v138, v138
    v_exp_f32 v139, v139
    v_pk_mul_f32 v[76:77], v[68:69], v[76:77]
    v_pk_mul_f32 v[78:79], v[70:71], v[78:79]
    v_pk_mul_f32 v[80:81], v[72:73], v[80:81]
    v_pk_mul_f32 v[82:83], v[74:75], v[82:83]
    v_pk_fma_f32 v[132:133], v[132:133], v[54:55], v[54:55] op_sel:[0,0,0] op_sel_hi:[1,0,0]
    v_pk_fma_f32 v[134:135], v[134:135], v[54:55], v[54:55] op_sel:[0,0,0] op_sel_hi:[1,0,0]
    v_pk_fma_f32 v[136:137], v[136:137], v[54:55], v[54:55] op_sel:[0,1,1] op_sel_hi:[1,1,1]
    v_pk_fma_f32 v[138:139], v[138:139], v[54:55], v[54:55] op_sel:[0,1,1] op_sel_hi:[1,1,1]
    v_mfma_f32_16x16x32_bf16 v[84:87], a[216:219], a[24:27], v[84:87]
    s_add_u32 m0, s66, 53248
    ds_read_b64_tr_b16 a[240:241], v176 offset:0
    ds_read_b64_tr_b16 a[242:243], v176 offset:4096
    v_mfma_f32_16x16x32_bf16 v[88:91], a[216:219], a[28:31], v[88:91]
    buffer_load_dwordx4 v62, s[36:39], s74 offen lds
    v_rcp_f32 v132, v132
    v_mfma_f32_16x16x32_bf16 v[92:95], a[220:223], a[24:27], v[92:95]
    ds_read_b64_tr_b16 a[244:245], v176 offset:2048
    ds_read_b64_tr_b16 a[246:247], v176 offset:6144
    v_mfma_f32_16x16x32_bf16 v[96:99], a[220:223], a[28:31], v[96:99]
    s_waitcnt lgkmcnt(4)
    v_rcp_f32 v133, v133
    v_mfma_f32_16x16x32_bf16 v[84:87], a[224:227], a[40:43], v[84:87]
    ds_read_b64_tr_b16 a[248:249], v176 offset:8192
    ds_read_b64_tr_b16 a[250:251], v176 offset:12288
    v_mfma_f32_16x16x32_bf16 v[88:91], a[224:227], a[44:47], v[88:91]
    v_rcp_f32 v134, v134
    v_mfma_f32_16x16x32_bf16 v[92:95], a[228:231], a[40:43], v[92:95]
    ds_read_b64_tr_b16 a[252:253], v176 offset:10240
    ds_read_b64_tr_b16 a[254:255], v176 offset:14336
    v_mfma_f32_16x16x32_bf16 v[96:99], a[228:231], a[44:47], v[96:99]
    v_rcp_f32 v135, v135
    v_mfma_f32_16x16x32_bf16 v[84:87], a[232:235], a[56:59], v[84:87]
    ds_read_b64_tr_b16 a[208:209], v176 offset:16384
    ds_read_b64_tr_b16 a[210:211], v176 offset:20480
    v_mfma_f32_16x16x32_bf16 v[88:91], a[232:235], a[60:63], v[88:91]
    v_rcp_f32 v136, v136
    v_mfma_f32_16x16x32_bf16 v[92:95], a[236:239], a[56:59], v[92:95]
    s_add_u32 m0, s66, 57344
    s_add_u32 s52, s53, 0
    v_add_u32 v65, 16384, v64
    v_add_u32 v66, 196608, v64
    v_add_u32 v67, 212992, v64
    ds_read_b64_tr_b16 a[212:213], v176 offset:18432
    ds_read_b64_tr_b16 a[214:215], v176 offset:22528
    v_mfma_f32_16x16x32_bf16 v[96:99], a[236:239], a[60:63], v[96:99]
    s_waitcnt lgkmcnt(4)
    buffer_load_dwordx4 v64, s[40:43], s52 offen lds
    v_rcp_f32 v137, v137
    v_mfma_f32_16x16x32_bf16 v[84:87], a[240:243], a[72:75], v[84:87]
    ds_read_b64_tr_b16 a[216:217], v176 offset:24576
    ds_read_b64_tr_b16 a[218:219], v7 offset:36864
    v_mfma_f32_16x16x32_bf16 v[88:91], a[240:243], a[76:79], v[88:91]
    v_rcp_f32 v138, v138
    v_rcp_f32 v139, v139
    v_pk_mul_f32 v[76:77], v[76:77], v[132:133]
    v_pk_mul_f32 v[78:79], v[78:79], v[134:135]
    v_pk_mul_f32 v[80:81], v[80:81], v[136:137]
    v_pk_mul_f32 v[82:83], v[82:83], v[138:139]
    v_mfma_f32_16x16x32_bf16 v[92:95], a[244:247], a[72:75], v[92:95]
    s_add_u32 m0, s66, 77824
    ds_read_b64_tr_b16 a[220:221], v176 offset:26624
    ds_read_b64_tr_b16 a[222:223], v7 offset:38912
    v_mfma_f32_16x16x32_bf16 v[96:99], a[244:247], a[76:79], v[96:99]
    buffer_load_dwordx4 v65, s[40:43], s52 offen lds
    v_cvt_pk_bf16_f32 v58, v76, v77
    v_cvt_pk_bf16_f32 v59, v78, v79
    v_mfma_f32_16x16x32_bf16 v[84:87], a[248:251], a[88:91], v[84:87]
    s_add_u32 m0, s66, 24576
    ds_read_b64_tr_b16 a[224:225], v23 offset:32768
    ds_read_b64_tr_b16 a[226:227], v23 offset:36864
    v_mfma_f32_16x16x32_bf16 v[88:91], a[248:251], a[92:95], v[88:91]
    buffer_load_dwordx4 v66, s[40:43], s52 offen lds
    v_cvt_pk_bf16_f32 v142, v80, v81
    v_cvt_pk_bf16_f32 v143, v82, v83
    v_mfma_f32_16x16x32_bf16 v[92:95], a[252:255], a[88:91], v[92:95]
    ds_read_b64_tr_b16 a[228:229], v23 offset:34816
    ds_read_b64_tr_b16 a[230:231], v23 offset:38912
    v_mfma_f32_16x16x32_bf16 v[96:99], a[252:255], a[92:95], v[96:99]
    s_waitcnt lgkmcnt(4)
    buffer_store_dwordx4 v[56:59], v17, s[44:47], s11 offen sc1
    buffer_store_dwordx4 v[140:143], v17, s[44:47], s11 offen offset:1024 sc1
    v_lshlrev_b32 v34, 16, v144
    v_mfma_f32_16x16x32_bf16 v[84:87], a[208:211], a[104:107], v[84:87]
    ds_read_b64_tr_b16 a[232:233], v23 offset:40960
    ds_read_b64_tr_b16 a[234:235], v23 offset:45056
    v_mfma_f32_16x16x32_bf16 v[88:91], a[208:211], a[108:111], v[88:91]
    v_and_b32 v35, 0xffff0000, v144
    v_lshlrev_b32 v36, 16, v145
    v_and_b32 v37, 0xffff0000, v145
    v_mfma_f32_16x16x32_bf16 v[92:95], a[212:215], a[104:107], v[92:95]
    ds_read_b64_tr_b16 a[236:237], v23 offset:43008
    ds_read_b64_tr_b16 a[238:239], v23 offset:47104
    v_mfma_f32_16x16x32_bf16 v[96:99], a[212:215], a[108:111], v[96:99]
    v_lshlrev_b32 v38, 16, v146
    v_and_b32 v39, 0xffff0000, v146
    v_lshlrev_b32 v40, 16, v147
    v_mfma_f32_16x16x32_bf16 v[84:87], a[216:219], a[120:123], v[84:87]
    ds_read_b64_tr_b16 a[240:241], v23 offset:49152
    ds_read_b64_tr_b16 a[242:243], v23 offset:53248
    v_mfma_f32_16x16x32_bf16 v[88:91], a[216:219], a[124:127], v[88:91]
    v_and_b32 v41, 0xffff0000, v147
    v_lshlrev_b32 v42, 16, v148
    v_and_b32 v43, 0xffff0000, v148
    v_mfma_f32_16x16x32_bf16 v[92:95], a[220:223], a[120:123], v[92:95]
    ds_read_b64_tr_b16 a[244:245], v23 offset:51200
    ds_read_b64_tr_b16 a[246:247], v23 offset:55296
    v_mfma_f32_16x16x32_bf16 v[96:99], a[220:223], a[124:127], v[96:99]
    s_waitcnt lgkmcnt(4)
    v_lshlrev_b32 v44, 16, v149
    v_and_b32 v45, 0xffff0000, v149
    v_lshlrev_b32 v46, 16, v150
    v_mfma_f32_16x16x32_bf16 v[100:103], a[224:227], a[8:11], v[100:103]
    ds_read_b64_tr_b16 a[248:249], v23 offset:57344
    ds_read_b64_tr_b16 a[250:251], v23 offset:61440
    v_mfma_f32_16x16x32_bf16 v[104:107], a[224:227], a[12:15], v[104:107]
    v_and_b32 v47, 0xffff0000, v150
    v_lshlrev_b32 v48, 16, v151
    v_and_b32 v49, 0xffff0000, v151
    v_mfma_f32_16x16x32_bf16 v[108:111], a[228:231], a[8:11], v[108:111]
    s_add_u32 m0, s66, 4096
    ds_read_b64_tr_b16 a[252:253], v23 offset:59392
    ds_read_b64_tr_b16 a[254:255], v23 offset:63488
    v_mfma_f32_16x16x32_bf16 v[112:115], a[228:231], a[12:15], v[112:115]
    buffer_load_dwordx4 v67, s[40:43], s52 offen lds
    v_add_u32 v177, 131072, v8
    v_pk_mul_f32 v[132:133], v[84:85], v[84:85]
    v_pk_mul_f32 v[134:135], v[86:87], v[86:87]
    v_pk_mul_f32 v[136:137], v[88:89], v[88:89]
    v_pk_mul_f32 v[138:139], v[90:91], v[90:91]
    v_pk_fma_f32 v[132:133], v[132:133], v[50:51], v[50:51] op_sel:[0,1,0] op_sel_hi:[1,1,0]
    v_pk_fma_f32 v[134:135], v[134:135], v[50:51], v[50:51] op_sel:[0,1,0] op_sel_hi:[1,1,0]
    v_pk_fma_f32 v[136:137], v[136:137], v[52:53], v[52:53] op_sel:[0,1,0] op_sel_hi:[1,1,0]
    v_pk_fma_f32 v[138:139], v[138:139], v[52:53], v[52:53] op_sel:[0,1,0] op_sel_hi:[1,1,0]
    v_pk_mul_f32 v[132:133], v[132:133], v[84:85]
    v_pk_mul_f32 v[134:135], v[134:135], v[86:87]
    v_pk_mul_f32 v[136:137], v[136:137], v[88:89]
    v_pk_mul_f32 v[138:139], v[138:139], v[90:91]
    v_mfma_f32_16x16x32_bf16 v[100:103], a[232:235], a[24:27], v[100:103]
    s_add_u32 m0, s66, 94208
    s_add_u32 s52, s53, 393216
    ds_read_b64_tr_b16 a[208:209], v177 offset:0
    ds_read_b64_tr_b16 a[210:211], v177 offset:4096
    v_mfma_f32_16x16x32_bf16 v[104:107], a[232:235], a[28:31], v[104:107]
    buffer_load_dwordx4 v64, s[40:43], s52 offen lds
    v_exp_f32 v132, v132
    v_mfma_f32_16x16x32_bf16 v[108:111], a[236:239], a[24:27], v[108:111]
    ds_read_b64_tr_b16 a[212:213], v177 offset:2048
    ds_read_b64_tr_b16 a[214:215], v177 offset:6144
    v_mfma_f32_16x16x32_bf16 v[112:115], a[236:239], a[28:31], v[112:115]
    s_waitcnt lgkmcnt(4)
    v_exp_f32 v133, v133
    v_mfma_f32_16x16x32_bf16 v[100:103], a[240:243], a[40:43], v[100:103]
    s_add_u32 m0, s66, 16384
    ds_read_b64_tr_b16 a[216:217], v177 offset:8192
    ds_read_b64_tr_b16 a[218:219], v177 offset:12288
    v_mfma_f32_16x16x32_bf16 v[104:107], a[240:243], a[44:47], v[104:107]
    buffer_load_dwordx4 v65, s[40:43], s52 offen lds
    v_exp_f32 v134, v134
    v_mfma_f32_16x16x32_bf16 v[108:111], a[244:247], a[40:43], v[108:111]
    ds_read_b64_tr_b16 a[220:221], v177 offset:10240
    ds_read_b64_tr_b16 a[222:223], v177 offset:14336
    v_mfma_f32_16x16x32_bf16 v[112:115], a[244:247], a[44:47], v[112:115]
    v_exp_f32 v135, v135
    v_mfma_f32_16x16x32_bf16 v[100:103], a[248:251], a[56:59], v[100:103]
    s_add_u32 m0, s66, 20480
    ds_read_b64_tr_b16 a[224:225], v177 offset:16384
    ds_read_b64_tr_b16 a[226:227], v177 offset:20480
    v_mfma_f32_16x16x32_bf16 v[104:107], a[248:251], a[60:63], v[104:107]
    buffer_load_dwordx4 v66, s[40:43], s52 offen lds
    v_exp_f32 v136, v136
    v_mfma_f32_16x16x32_bf16 v[108:111], a[252:255], a[56:59], v[108:111]
    ds_read_b64_tr_b16 a[228:229], v177 offset:18432
    ds_read_b64_tr_b16 a[230:231], v177 offset:22528
    v_mfma_f32_16x16x32_bf16 v[112:115], a[252:255], a[60:63], v[112:115]
    s_waitcnt lgkmcnt(4)
    v_exp_f32 v137, v137
    v_mfma_f32_16x16x32_bf16 v[100:103], a[208:211], a[72:75], v[100:103]
    ds_read_b64_tr_b16 a[232:233], v177 offset:24576
    ds_read_b64_tr_b16 a[234:235], v8 offset:36864
    v_mfma_f32_16x16x32_bf16 v[104:107], a[208:211], a[76:79], v[104:107]
    v_exp_f32 v138, v138
    v_exp_f32 v139, v139
    v_pk_mul_f32 v[92:93], v[84:85], v[92:93]
    v_pk_mul_f32 v[94:95], v[86:87], v[94:95]
    v_pk_mul_f32 v[96:97], v[88:89], v[96:97]
    v_pk_mul_f32 v[98:99], v[90:91], v[98:99]
    v_pk_fma_f32 v[132:133], v[132:133], v[54:55], v[54:55] op_sel:[0,0,0] op_sel_hi:[1,0,0]
    v_pk_fma_f32 v[134:135], v[134:135], v[54:55], v[54:55] op_sel:[0,0,0] op_sel_hi:[1,0,0]
    v_pk_fma_f32 v[136:137], v[136:137], v[54:55], v[54:55] op_sel:[0,1,1] op_sel_hi:[1,1,1]
    v_pk_fma_f32 v[138:139], v[138:139], v[54:55], v[54:55] op_sel:[0,1,1] op_sel_hi:[1,1,1]
    v_mfma_f32_16x16x32_bf16 v[108:111], a[212:215], a[72:75], v[108:111]
    s_add_u32 m0, s66, 69632
    ds_read_b64_tr_b16 a[236:237], v177 offset:26624
    ds_read_b64_tr_b16 a[238:239], v8 offset:38912
    v_mfma_f32_16x16x32_bf16 v[112:115], a[212:215], a[76:79], v[112:115]
    buffer_load_dwordx4 v67, s[40:43], s52 offen lds
    v_rcp_f32 v132, v132
    v_mfma_f32_16x16x32_bf16 v[100:103], a[216:219], a[88:91], v[100:103]
    s_add_u32 m0, s66, 73728
    s_add_u32 s52, s53, 786432
    ds_read_b64_tr_b16 a[240:241], v174 offset:32768
    ds_read_b64_tr_b16 a[242:243], v174 offset:36864
    v_mfma_f32_16x16x32_bf16 v[104:107], a[216:219], a[92:95], v[104:107]
    buffer_load_dwordx4 v64, s[40:43], s52 offen lds
    v_rcp_f32 v133, v133
    v_mfma_f32_16x16x32_bf16 v[108:111], a[220:223], a[88:91], v[108:111]
    ds_read_b64_tr_b16 a[244:245], v174 offset:34816
    ds_read_b64_tr_b16 a[246:247], v174 offset:38912
    v_mfma_f32_16x16x32_bf16 v[112:115], a[220:223], a[92:95], v[112:115]
    s_waitcnt lgkmcnt(4)
    v_rcp_f32 v134, v134
    v_mfma_f32_16x16x32_bf16 v[100:103], a[224:227], a[104:107], v[100:103]
    s_add_u32 m0, s66, 81920
    ds_read_b64_tr_b16 a[248:249], v175 offset:32768
    ds_read_b64_tr_b16 a[250:251], v175 offset:36864
    v_mfma_f32_16x16x32_bf16 v[104:107], a[224:227], a[108:111], v[104:107]
    buffer_load_dwordx4 v65, s[40:43], s52 offen lds
    v_rcp_f32 v135, v135
    v_mfma_f32_16x16x32_bf16 v[108:111], a[228:231], a[104:107], v[108:111]
    ds_read_b64_tr_b16 a[252:253], v175 offset:34816
    ds_read_b64_tr_b16 a[254:255], v175 offset:38912
    v_mfma_f32_16x16x32_bf16 v[112:115], a[228:231], a[108:111], v[112:115]
    v_rcp_f32 v136, v136
    v_mfma_f32_16x16x32_bf16 v[100:103], a[232:235], a[120:123], v[100:103]
    ds_read_b64_tr_b16 a[208:209], v174 offset:40960
    ds_read_b64_tr_b16 a[210:211], v174 offset:45056
    v_mfma_f32_16x16x32_bf16 v[104:107], a[232:235], a[124:127], v[104:107]
    v_rcp_f32 v137, v137
    v_mfma_f32_16x16x32_bf16 v[108:111], a[236:239], a[120:123], v[108:111]
    s_add_u32 m0, s66, 86016
    ds_read_b64_tr_b16 a[212:213], v174 offset:43008
    ds_read_b64_tr_b16 a[214:215], v174 offset:47104
    v_mfma_f32_16x16x32_bf16 v[112:115], a[236:239], a[124:127], v[112:115]
    s_waitcnt lgkmcnt(4)
    buffer_load_dwordx4 v66, s[40:43], s52 offen lds
    v_rcp_f32 v138, v138
    v_rcp_f32 v139, v139
    v_pk_mul_f32 v[92:93], v[92:93], v[132:133]
    v_pk_mul_f32 v[94:95], v[94:95], v[134:135]
    v_pk_mul_f32 v[96:97], v[96:97], v[136:137]
    v_pk_mul_f32 v[98:99], v[98:99], v[138:139]
    v_mfma_f32_16x16x32_bf16 v[116:119], a[240:243], a[8:11], 0
    s_add_u32 m0, s66, 28672
    ds_read_b64_tr_b16 a[216:217], v175 offset:40960
    ds_read_b64_tr_b16 a[218:219], v175 offset:45056
    v_mfma_f32_16x16x32_bf16 v[120:123], a[240:243], a[12:15], 0
    buffer_load_dwordx4 v67, s[40:43], s52 offen lds
    v_cvt_pk_bf16_f32 v56, v92, v93
    v_cvt_pk_bf16_f32 v57, v94, v95
    v_mfma_f32_16x16x32_bf16 v[124:127], a[244:247], a[8:11], 0
    ds_read_b64_tr_b16 a[220:221], v175 offset:43008
    ds_read_b64_tr_b16 a[222:223], v175 offset:47104
    v_mfma_f32_16x16x32_bf16 v[128:131], a[244:247], a[12:15], 0
    v_cvt_pk_bf16_f32 v140, v96, v97
    v_cvt_pk_bf16_f32 v141, v98, v99
    v_mfma_f32_16x16x32_bf16 v[152:155], a[248:251], a[8:11], 0
    ds_read_b64_tr_b16 a[224:225], v174 offset:49152
    ds_read_b64_tr_b16 a[226:227], v174 offset:53248
    v_mfma_f32_16x16x32_bf16 v[156:159], a[248:251], a[12:15], 0
    v_pk_mul_f32 v[132:133], v[100:101], v[100:101]
    v_pk_mul_f32 v[134:135], v[102:103], v[102:103]
    v_pk_mul_f32 v[136:137], v[104:105], v[104:105]
    v_pk_mul_f32 v[138:139], v[106:107], v[106:107]
    v_pk_fma_f32 v[132:133], v[132:133], v[50:51], v[50:51] op_sel:[0,1,0] op_sel_hi:[1,1,0]
    v_pk_fma_f32 v[134:135], v[134:135], v[50:51], v[50:51] op_sel:[0,1,0] op_sel_hi:[1,1,0]
    v_pk_fma_f32 v[136:137], v[136:137], v[52:53], v[52:53] op_sel:[0,1,0] op_sel_hi:[1,1,0]
    v_pk_fma_f32 v[138:139], v[138:139], v[52:53], v[52:53] op_sel:[0,1,0] op_sel_hi:[1,1,0]
    v_pk_mul_f32 v[132:133], v[132:133], v[100:101]
    v_pk_mul_f32 v[134:135], v[134:135], v[102:103]
    v_pk_mul_f32 v[136:137], v[136:137], v[104:105]
    v_pk_mul_f32 v[138:139], v[138:139], v[106:107]
    s_waitcnt vmcnt(9)
    s_barrier
    v_mfma_f32_16x16x32_bf16 v[160:163], a[252:255], a[8:11], 0
    s_add_u32 m0, s66, 0
    s_add_u32 s52, s53, 1179648
    ds_read_b64_tr_b16 a[228:229], v174 offset:51200
    ds_read_b64_tr_b16 a[230:231], v174 offset:55296
    v_mfma_f32_16x16x32_bf16 v[164:167], a[252:255], a[12:15], 0
    s_waitcnt lgkmcnt(4)
    buffer_load_dwordx4 v64, s[40:43], s52 offen lds
    v_exp_f32 v132, v132
    v_mfma_f32_16x16x32_bf16 v[116:119], a[208:211], a[24:27], v[116:119]
    s_add_u32 m0, s66, 8192
    ds_read_b64_tr_b16 a[232:233], v175 offset:49152
    ds_read_b64_tr_b16 a[234:235], v175 offset:53248
    v_mfma_f32_16x16x32_bf16 v[120:123], a[208:211], a[28:31], v[120:123]
    buffer_load_dwordx4 v65, s[40:43], s52 offen lds
    v_exp_f32 v133, v133
    v_mfma_f32_16x16x32_bf16 v[124:127], a[212:215], a[24:27], v[124:127]
    s_add_u32 m0, s66, 12288
    ds_read_b64_tr_b16 a[236:237], v175 offset:51200
    ds_read_b64_tr_b16 a[238:239], v175 offset:55296
    v_mfma_f32_16x16x32_bf16 v[128:131], a[212:215], a[28:31], v[128:131]
    buffer_load_dwordx4 v66, s[40:43], s52 offen lds
    v_exp_f32 v134, v134
    v_mfma_f32_16x16x32_bf16 v[152:155], a[216:219], a[24:27], v[152:155]
    ds_read_b64_tr_b16 a[240:241], v174 offset:57344
    ds_read_b64_tr_b16 a[242:243], v174 offset:61440
    v_mfma_f32_16x16x32_bf16 v[156:159], a[216:219], a[28:31], v[156:159]
    s_mov_b64 exec, s[4:5]
    buffer_store_dword v2, off, s[48:51], s79 offset:256 sc1
    s_mov_b64 exec, -1
    v_exp_f32 v135, v135
    v_mfma_f32_16x16x32_bf16 v[160:163], a[220:223], a[24:27], v[160:163]
    ds_read_b64_tr_b16 a[244:245], v174 offset:59392
    ds_read_b64_tr_b16 a[246:247], v174 offset:63488
    v_mfma_f32_16x16x32_bf16 v[164:167], a[220:223], a[28:31], v[164:167]
    s_waitcnt lgkmcnt(4)
    v_exp_f32 v136, v136
    v_mfma_f32_16x16x32_bf16 v[116:119], a[224:227], a[40:43], v[116:119]
    ds_read_b64_tr_b16 a[248:249], v175 offset:57344
    ds_read_b64_tr_b16 a[250:251], v175 offset:61440
    v_mfma_f32_16x16x32_bf16 v[120:123], a[224:227], a[44:47], v[120:123]
    v_exp_f32 v137, v137
    v_mfma_f32_16x16x32_bf16 v[124:127], a[228:231], a[40:43], v[124:127]
    ds_read_b64_tr_b16 a[252:253], v175 offset:59392
    ds_read_b64_tr_b16 a[254:255], v175 offset:63488
    v_mfma_f32_16x16x32_bf16 v[128:131], a[228:231], a[44:47], v[128:131]
    v_add_u32 v178, 131072, v9
    v_exp_f32 v138, v138
    v_exp_f32 v139, v139
    v_pk_mul_f32 v[108:109], v[100:101], v[108:109]
    v_pk_mul_f32 v[110:111], v[102:103], v[110:111]
    v_pk_mul_f32 v[112:113], v[104:105], v[112:113]
    v_pk_mul_f32 v[114:115], v[106:107], v[114:115]
    v_pk_fma_f32 v[132:133], v[132:133], v[54:55], v[54:55] op_sel:[0,0,0] op_sel_hi:[1,0,0]
    v_pk_fma_f32 v[134:135], v[134:135], v[54:55], v[54:55] op_sel:[0,0,0] op_sel_hi:[1,0,0]
    v_pk_fma_f32 v[136:137], v[136:137], v[54:55], v[54:55] op_sel:[0,1,1] op_sel_hi:[1,1,1]
    v_pk_fma_f32 v[138:139], v[138:139], v[54:55], v[54:55] op_sel:[0,1,1] op_sel_hi:[1,1,1]
    v_mfma_f32_16x16x32_bf16 v[152:155], a[232:235], a[40:43], v[152:155]
    ds_read_b64_tr_b16 a[208:209], v178 offset:0
    ds_read_b64_tr_b16 a[210:211], v178 offset:4096
    v_mfma_f32_16x16x32_bf16 v[156:159], a[232:235], a[44:47], v[156:159]
    v_rcp_f32 v132, v132
    v_mfma_f32_16x16x32_bf16 v[160:163], a[236:239], a[40:43], v[160:163]
    ds_read_b64_tr_b16 a[212:213], v178 offset:2048
    ds_read_b64_tr_b16 a[214:215], v178 offset:6144
    v_mfma_f32_16x16x32_bf16 v[164:167], a[236:239], a[44:47], v[164:167]
    s_waitcnt lgkmcnt(4)
    v_add_u32 v179, 131072, v10
    v_rcp_f32 v133, v133
    s_waitcnt vmcnt(11)
    s_barrier
    v_mfma_f32_16x16x32_bf16 v[116:119], a[240:243], a[56:59], v[116:119]
    s_add_u32 m0, s66, 98304
    ds_read_b64_tr_b16 a[216:217], v179 offset:0
    ds_read_b64_tr_b16 a[218:219], v179 offset:4096
    v_mfma_f32_16x16x32_bf16 v[120:123], a[240:243], a[60:63], v[120:123]
    buffer_load_dwordx4 v67, s[40:43], s52 offen lds
    v_rcp_f32 v134, v134
    v_mfma_f32_16x16x32_bf16 v[124:127], a[244:247], a[56:59], v[124:127]
    s_add_u32 m0, s66, 102400
    s_add_u32 s52, s54, 0
    ds_read_b64_tr_b16 a[220:221], v179 offset:2048
    ds_read_b64_tr_b16 a[222:223], v179 offset:6144
    v_mfma_f32_16x16x32_bf16 v[128:131], a[244:247], a[60:63], v[128:131]
    buffer_load_dwordx4 v64, s[40:43], s52 offen lds
    v_rcp_f32 v135, v135
    v_mfma_f32_16x16x32_bf16 v[152:155], a[248:251], a[56:59], v[152:155]
    s_add_u32 m0, s66, 106496
    ds_read_b64_tr_b16 a[224:225], v178 offset:8192
    ds_read_b64_tr_b16 a[226:227], v178 offset:12288
    v_mfma_f32_16x16x32_bf16 v[156:159], a[248:251], a[60:63], v[156:159]
    buffer_load_dwordx4 v65, s[40:43], s52 offen lds
    v_rcp_f32 v136, v136
    v_mfma_f32_16x16x32_bf16 v[160:163], a[252:255], a[56:59], v[160:163]
    s_add_u32 m0, s66, 110592
    ds_read_b64_tr_b16 a[228:229], v178 offset:10240
    ds_read_b64_tr_b16 a[230:231], v178 offset:14336
    v_mfma_f32_16x16x32_bf16 v[164:167], a[252:255], a[60:63], v[164:167]
    s_waitcnt lgkmcnt(4)
    buffer_load_dwordx4 v66, s[40:43], s52 offen lds
    v_rcp_f32 v137, v137
    v_mfma_f32_16x16x32_bf16 v[116:119], a[208:211], a[72:75], v[116:119]
    s_add_u32 m0, s66, 114688
    ds_read_b64_tr_b16 a[232:233], v179 offset:8192
    ds_read_b64_tr_b16 a[234:235], v179 offset:12288
    v_mfma_f32_16x16x32_bf16 v[120:123], a[208:211], a[76:79], v[120:123]
    buffer_load_dwordx4 v67, s[40:43], s52 offen lds
    v_rcp_f32 v138, v138
    v_rcp_f32 v139, v139
    v_pk_mul_f32 v[108:109], v[108:109], v[132:133]
    v_pk_mul_f32 v[110:111], v[110:111], v[134:135]
    v_pk_mul_f32 v[112:113], v[112:113], v[136:137]
    v_pk_mul_f32 v[114:115], v[114:115], v[138:139]
    v_mfma_f32_16x16x32_bf16 v[124:127], a[212:215], a[72:75], v[124:127]
    s_add_u32 m0, s66, 118784
    s_add_u32 s52, s54, 393216
    ds_read_b64_tr_b16 a[236:237], v179 offset:10240
    ds_read_b64_tr_b16 a[238:239], v179 offset:14336
    v_mfma_f32_16x16x32_bf16 v[128:131], a[212:215], a[76:79], v[128:131]
    buffer_load_dwordx4 v64, s[40:43], s52 offen lds
    v_cvt_pk_bf16_f32 v58, v108, v109
    v_cvt_pk_bf16_f32 v59, v110, v111
    v_mfma_f32_16x16x32_bf16 v[152:155], a[216:219], a[72:75], v[152:155]
    ds_read_b64_tr_b16 a[240:241], v178 offset:16384
    ds_read_b64_tr_b16 a[242:243], v178 offset:20480
    v_mfma_f32_16x16x32_bf16 v[156:159], a[216:219], a[76:79], v[156:159]
    v_cvt_pk_bf16_f32 v142, v112, v113
    v_cvt_pk_bf16_f32 v143, v114, v115
    s_add_u32 s13, s12, 262144
    buffer_store_dwordx4 v[56:59], v17, s[48:51], s13 offen offset:0 sc1
    buffer_store_dwordx4 v[140:143], v17, s[48:51], s13 offen offset:1024 sc1
    v_mfma_f32_16x16x32_bf16 v[160:163], a[220:223], a[72:75], v[160:163]
    ds_read_b64_tr_b16 a[244:245], v178 offset:18432
    ds_read_b64_tr_b16 a[246:247], v178 offset:22528
    v_mfma_f32_16x16x32_bf16 v[164:167], a[220:223], a[76:79], v[164:167]
    s_waitcnt lgkmcnt(4)
    v_mfma_f32_16x16x32_bf16 v[116:119], a[224:227], a[88:91], v[116:119]
    ds_read_b64_tr_b16 a[248:249], v179 offset:16384
    v_mfma_f32_16x16x32_bf16 v[120:123], a[224:227], a[92:95], v[120:123]
    ds_read_b64_tr_b16 a[250:251], v179 offset:20480
    v_mfma_f32_16x16x32_bf16 v[124:127], a[228:231], a[88:91], v[124:127]
    ds_read_b64_tr_b16 a[252:253], v179 offset:18432
    v_mfma_f32_16x16x32_bf16 v[128:131], a[228:231], a[92:95], v[128:131]
    ds_read_b64_tr_b16 a[254:255], v179 offset:22528
    v_mfma_f32_16x16x32_bf16 v[152:155], a[232:235], a[88:91], v[152:155]
    ds_read_b64_tr_b16 a[208:209], v178 offset:24576
    v_mfma_f32_16x16x32_bf16 v[156:159], a[232:235], a[92:95], v[156:159]
    ds_read_b64_tr_b16 a[210:211], v9 offset:36864
    v_mfma_f32_16x16x32_bf16 v[160:163], a[236:239], a[88:91], v[160:163]
    ds_read_b64_tr_b16 a[212:213], v178 offset:26624
    ds_read_b64_tr_b16 a[214:215], v9 offset:38912
    v_mfma_f32_16x16x32_bf16 v[164:167], a[236:239], a[92:95], v[164:167]
    s_waitcnt vmcnt(13) lgkmcnt(4)
    s_barrier
    v_mfma_f32_16x16x32_bf16 v[116:119], a[240:243], a[104:107], v[116:119]
    s_add_u32 m0, s66, 122880
    ds_read_b64_tr_b16 a[216:217], v179 offset:24576
    ds_read_b64_tr_b16 a[218:219], v10 offset:36864
    v_mfma_f32_16x16x32_bf16 v[120:123], a[240:243], a[108:111], v[120:123]
    buffer_load_dwordx4 v65, s[40:43], s52 offen lds
    v_mfma_f32_16x16x32_bf16 v[124:127], a[244:247], a[104:107], v[124:127]
    s_add_u32 m0, s66, 126976
    ds_read_b64_tr_b16 a[220:221], v179 offset:26624
    ds_read_b64_tr_b16 a[222:223], v10 offset:38912
    v_mfma_f32_16x16x32_bf16 v[128:131], a[244:247], a[108:111], v[128:131]
    buffer_load_dwordx4 v66, s[40:43], s52 offen lds
    v_mfma_f32_16x16x32_bf16 v[152:155], a[248:251], a[104:107], v[152:155]
    ds_read_b64_tr_b16 a[224:225], v11 offset:49152
    v_mfma_f32_16x16x32_bf16 v[156:159], a[248:251], a[108:111], v[156:159]
    ds_read_b64_tr_b16 a[226:227], v11 offset:50176
    v_mfma_f32_16x16x32_bf16 v[160:163], a[252:255], a[104:107], v[160:163]
    ds_read_b64_tr_b16 a[228:229], v11 offset:51200
    ds_read_b64_tr_b16 a[230:231], v11 offset:52224
    v_mfma_f32_16x16x32_bf16 v[164:167], a[252:255], a[108:111], v[164:167]
    s_waitcnt lgkmcnt(4)
    v_mfma_f32_16x16x32_bf16 v[116:119], a[208:211], a[120:123], v[116:119]
    s_add_u32 m0, s66, 131072
    ds_read_b64_tr_b16 a[232:233], v14 offset:49152
    ds_read_b64_tr_b16 a[234:235], v14 offset:50176
    v_mfma_f32_16x16x32_bf16 v[120:123], a[208:211], a[124:127], v[120:123]
    buffer_load_dwordx4 v67, s[40:43], s52 offen lds
    v_mfma_f32_16x16x32_bf16 v[124:127], a[212:215], a[120:123], v[124:127]
    ds_read_b64_tr_b16 a[236:237], v14 offset:51200
    ds_read_b64_tr_b16 a[238:239], v14 offset:52224
    v_mfma_f32_16x16x32_bf16 v[128:131], a[212:215], a[124:127], v[128:131]
    s_mov_b64 exec, s[6:7]
    buffer_load_dword v33, v20, s[48:51], s71 offen offset:256 sc1
    s_mov_b64 exec, -1
    v_mfma_f32_16x16x32_bf16 v[152:155], a[216:219], a[120:123], v[152:155]
    ds_read_b64_tr_b16 a[240:241], v11 offset:61440
    v_mfma_f32_16x16x32_bf16 v[156:159], a[216:219], a[124:127], v[156:159]
    ds_read_b64_tr_b16 a[242:243], v11 offset:62464
    v_mfma_f32_16x16x32_bf16 v[160:163], a[220:223], a[120:123], v[160:163]
    s_add_u32 m0, s66, 135168
    s_add_u32 s52, s54, 786432
    ds_read_b64_tr_b16 a[244:245], v11 offset:63488
    ds_read_b64_tr_b16 a[246:247], v11 offset:64512
    v_mfma_f32_16x16x32_bf16 v[164:167], a[220:223], a[124:127], v[164:167]
    s_waitcnt lgkmcnt(4)
    buffer_load_dwordx4 v64, s[40:43], s52 offen lds
    v_mfma_f32_16x16x32_bf16 v[116:119], a[224:227], a[0:3], v[116:119]
    ds_read_b64_tr_b16 a[248:249], v14 offset:61440
    v_mfma_f32_16x16x32_bf16 v[120:123], a[224:227], a[4:7], v[120:123]
    ds_read_b64_tr_b16 a[250:251], v14 offset:62464
    v_mfma_f32_16x16x32_bf16 v[124:127], a[228:231], a[0:3], v[124:127]
    s_add_u32 m0, s66, 139264
    ds_read_b64_tr_b16 a[252:253], v14 offset:63488
    ds_read_b64_tr_b16 a[254:255], v14 offset:64512
    v_mfma_f32_16x16x32_bf16 v[128:131], a[228:231], a[4:7], v[128:131]
    buffer_load_dwordx4 v65, s[40:43], s52 offen lds
    v_mfma_f32_16x16x32_bf16 v[152:155], a[232:235], a[0:3], v[152:155]
    ds_read_b64_tr_b16 a[208:209], v172 offset:0
    v_mfma_f32_16x16x32_bf16 v[156:159], a[232:235], a[4:7], v[156:159]
    ds_read_b64_tr_b16 a[210:211], v172 offset:1024
    v_mfma_f32_16x16x32_bf16 v[160:163], a[236:239], a[0:3], v[160:163]
    ds_read_b64_tr_b16 a[212:213], v172 offset:2048
    ds_read_b64_tr_b16 a[214:215], v172 offset:3072
    v_mfma_f32_16x16x32_bf16 v[164:167], a[236:239], a[4:7], v[164:167]
    s_waitcnt lgkmcnt(4)
    v_mfma_f32_16x16x32_bf16 v[116:119], a[240:243], a[16:19], v[116:119]
    s_add_u32 m0, s66, 143360
    ds_read_b64_tr_b16 a[216:217], v173 offset:0
    ds_read_b64_tr_b16 a[218:219], v173 offset:1024
    v_mfma_f32_16x16x32_bf16 v[120:123], a[240:243], a[20:23], v[120:123]
    buffer_load_dwordx4 v66, s[40:43], s52 offen lds
    v_mfma_f32_16x16x32_bf16 v[124:127], a[244:247], a[16:19], v[124:127]
    ds_read_b64_tr_b16 a[220:221], v173 offset:2048
    v_mfma_f32_16x16x32_bf16 v[128:131], a[244:247], a[20:23], v[128:131]
    ds_read_b64_tr_b16 a[222:223], v173 offset:3072
    v_mfma_f32_16x16x32_bf16 v[152:155], a[248:251], a[16:19], v[152:155]
    ds_read_b64_tr_b16 a[224:225], v172 offset:24576
    v_mfma_f32_16x16x32_bf16 v[156:159], a[248:251], a[20:23], v[156:159]
    ds_read_b64_tr_b16 a[226:227], v172 offset:25600
    v_mfma_f32_16x16x32_bf16 v[160:163], a[252:255], a[16:19], v[160:163]
    ds_read_b64_tr_b16 a[228:229], v172 offset:26624
    ds_read_b64_tr_b16 a[230:231], v172 offset:27648
    v_mfma_f32_16x16x32_bf16 v[164:167], a[252:255], a[20:23], v[164:167]
    s_waitcnt vmcnt(13) lgkmcnt(4)
    s_barrier
    v_mfma_f32_16x16x32_bf16 v[116:119], a[208:211], a[32:35], v[116:119]
    s_add_u32 m0, s66, 147456
    ds_read_b64_tr_b16 a[232:233], v173 offset:24576
    ds_read_b64_tr_b16 a[234:235], v173 offset:25600
    v_mfma_f32_16x16x32_bf16 v[120:123], a[208:211], a[36:39], v[120:123]
    buffer_load_dwordx4 v67, s[40:43], s52 offen lds
    v_mfma_f32_16x16x32_bf16 v[124:127], a[212:215], a[32:35], v[124:127]
    s_add_u32 m0, s66, 151552
    s_add_u32 s52, s54, 1179648
    ds_read_b64_tr_b16 a[236:237], v173 offset:26624
    ds_read_b64_tr_b16 a[238:239], v173 offset:27648
    v_mfma_f32_16x16x32_bf16 v[128:131], a[212:215], a[36:39], v[128:131]
    buffer_load_dwordx4 v64, s[40:43], s52 offen lds
    v_mfma_f32_16x16x32_bf16 v[152:155], a[216:219], a[32:35], v[152:155]
    ds_read_b64_tr_b16 a[240:241], v11 offset:32768
    v_mfma_f32_16x16x32_bf16 v[156:159], a[216:219], a[36:39], v[156:159]
    ds_read_b64_tr_b16 a[242:243], v11 offset:33792
    v_mfma_f32_16x16x32_bf16 v[160:163], a[220:223], a[32:35], v[160:163]
    s_add_u32 m0, s66, 155648
    ds_read_b64_tr_b16 a[244:245], v11 offset:34816
    ds_read_b64_tr_b16 a[246:247], v11 offset:35840
    v_mfma_f32_16x16x32_bf16 v[164:167], a[220:223], a[36:39], v[164:167]
    s_waitcnt lgkmcnt(4)
    buffer_load_dwordx4 v65, s[40:43], s52 offen lds
    v_mfma_f32_16x16x32_bf16 v[116:119], a[224:227], a[48:51], v[116:119]
    ds_read_b64_tr_b16 a[248:249], v14 offset:32768
    v_mfma_f32_16x16x32_bf16 v[120:123], a[224:227], a[52:55], v[120:123]
    ds_read_b64_tr_b16 a[250:251], v14 offset:33792
    v_mfma_f32_16x16x32_bf16 v[124:127], a[228:231], a[48:51], v[124:127]
    s_add_u32 m0, s66, 36864
    s_add_u32 s52, s55, 0
    ds_read_b64_tr_b16 a[252:253], v14 offset:34816
    ds_read_b64_tr_b16 a[254:255], v14 offset:35840
    v_mfma_f32_16x16x32_bf16 v[128:131], a[228:231], a[52:55], v[128:131]
    buffer_load_dwordx4 v64, s[40:43], s52 offen lds
    v_mfma_f32_16x16x32_bf16 v[152:155], a[232:235], a[48:51], v[152:155]
    ds_read_b64_tr_b16 a[208:209], v11 offset:40960
    v_mfma_f32_16x16x32_bf16 v[156:159], a[232:235], a[52:55], v[156:159]
    ds_read_b64_tr_b16 a[210:211], v11 offset:41984
    v_mfma_f32_16x16x32_bf16 v[160:163], a[236:239], a[48:51], v[160:163]
    ds_read_b64_tr_b16 a[212:213], v11 offset:43008
    ds_read_b64_tr_b16 a[214:215], v11 offset:44032
    v_mfma_f32_16x16x32_bf16 v[164:167], a[236:239], a[52:55], v[164:167]
    s_waitcnt vmcnt(11) lgkmcnt(4)
    s_barrier
    v_mfma_f32_16x16x32_bf16 v[116:119], a[240:243], a[64:67], v[116:119]
    s_add_u32 m0, s66, 49152
    ds_read_b64_tr_b16 a[216:217], v14 offset:40960
    ds_read_b64_tr_b16 a[218:219], v14 offset:41984
    v_mfma_f32_16x16x32_bf16 v[120:123], a[240:243], a[68:71], v[120:123]
    buffer_load_dwordx4 v65, s[40:43], s52 offen lds
    s_mov_b64 exec, s[4:5]
    buffer_store_dword v2, off, s[48:51], s79 offset:384 sc1
    s_mov_b64 exec, -1
    v_mfma_f32_16x16x32_bf16 v[124:127], a[244:247], a[64:67], v[124:127]
    ds_read_b64_tr_b16 a[220:221], v14 offset:43008
    v_mfma_f32_16x16x32_bf16 v[128:131], a[244:247], a[68:71], v[128:131]
    ds_read_b64_tr_b16 a[222:223], v14 offset:44032
    v_mfma_f32_16x16x32_bf16 v[152:155], a[248:251], a[64:67], v[152:155]
    s_add_u32 m0, s66, 61440
    ds_read_b64_tr_b16 a[224:225], v11 offset:45056
    ds_read_b64_tr_b16 a[226:227], v11 offset:46080
    v_mfma_f32_16x16x32_bf16 v[156:159], a[248:251], a[68:71], v[156:159]
    buffer_load_dwordx4 v66, s[40:43], s52 offen lds
    v_mfma_f32_16x16x32_bf16 v[160:163], a[252:255], a[64:67], v[160:163]
    ds_read_b64_tr_b16 a[228:229], v11 offset:47104
    ds_read_b64_tr_b16 a[230:231], v11 offset:48128
    v_mfma_f32_16x16x32_bf16 v[164:167], a[252:255], a[68:71], v[164:167]
    s_waitcnt lgkmcnt(4)
    v_mfma_f32_16x16x32_bf16 v[116:119], a[208:211], a[80:83], v[116:119]
    ds_read_b64_tr_b16 a[232:233], v14 offset:45056
    v_mfma_f32_16x16x32_bf16 v[120:123], a[208:211], a[84:87], v[120:123]
    ds_read_b64_tr_b16 a[234:235], v14 offset:46080
    v_mfma_f32_16x16x32_bf16 v[124:127], a[212:215], a[80:83], v[124:127]
    s_add_u32 m0, s66, 65536
    ds_read_b64_tr_b16 a[236:237], v14 offset:47104
    ds_read_b64_tr_b16 a[238:239], v14 offset:48128
    v_mfma_f32_16x16x32_bf16 v[128:131], a[212:215], a[84:87], v[128:131]
    buffer_load_dwordx4 v67, s[40:43], s52 offen lds
    s_waitcnt vmcnt(11)
    v_cmp_eq_u32 vcc, 0, v33
    s_nop 0
    s_and_b64 vcc, vcc, s[6:7]
    s_cbranch_vccnz L_late4_w
L_back4_w:
    v_mfma_f32_16x16x32_bf16 v[152:155], a[216:219], a[80:83], v[152:155]
    ds_read_b64_tr_b16 a[240:241], v11 offset:53248
    v_mfma_f32_16x16x32_bf16 v[156:159], a[216:219], a[84:87], v[156:159]
    ds_read_b64_tr_b16 a[242:243], v11 offset:54272
    v_mfma_f32_16x16x32_bf16 v[160:163], a[220:223], a[80:83], v[160:163]
    s_add_u32 m0, s66, 90112
    s_add_u32 s52, s55, 393216
    ds_read_b64_tr_b16 a[244:245], v11 offset:55296
    ds_read_b64_tr_b16 a[246:247], v11 offset:56320
    v_mfma_f32_16x16x32_bf16 v[164:167], a[220:223], a[84:87], v[164:167]
    s_waitcnt lgkmcnt(4)
    buffer_load_dwordx4 v64, s[40:43], s52 offen lds
    v_mfma_f32_16x16x32_bf16 v[116:119], a[224:227], a[96:99], v[116:119]
    ds_read_b64_tr_b16 a[248:249], v14 offset:53248
    ds_read_b64_tr_b16 a[250:251], v14 offset:54272
    v_mfma_f32_16x16x32_bf16 v[120:123], a[224:227], a[100:103], v[120:123]
    s_barrier
    v_mfma_f32_16x16x32_bf16 v[124:127], a[228:231], a[96:99], v[124:127]
    s_add_u32 s14, s15, 0
    ds_read_b64_tr_b16 a[252:253], v14 offset:55296
    ds_read_b64_tr_b16 a[254:255], v14 offset:56320
    v_mfma_f32_16x16x32_bf16 v[128:131], a[228:231], a[100:103], v[128:131]
    buffer_load_dwordx4 a[128:131], v21, s[44:47], s14 offen sc1
    v_add_u32 v180, 65536, v15
    v_mfma_f32_16x16x32_bf16 v[152:155], a[232:235], a[96:99], v[152:155]
    ds_read_b64_tr_b16 a[208:209], v15 offset:57344
    ds_read_b64_tr_b16 a[210:211], v180 offset:12288
    v_mfma_f32_16x16x32_bf16 v[156:159], a[232:235], a[100:103], v[156:159]
    v_add_u32 v181, 65536, v16
    v_mfma_f32_16x16x32_bf16 v[160:163], a[236:239], a[96:99], v[160:163]
    ds_read_b64_tr_b16 a[212:213], v16 offset:57344
    ds_read_b64_tr_b16 a[214:215], v181 offset:12288
    v_mfma_f32_16x16x32_bf16 v[164:167], a[236:239], a[100:103], v[164:167]
    s_waitcnt lgkmcnt(4)
    buffer_load_dwordx4 a[132:135], v22, s[44:47], s14 offen sc1
    v_add_u32 v182, 65536, v18
    v_mfma_f32_16x16x32_bf16 v[116:119], a[240:243], a[112:115], v[116:119]
    ds_read_b64_tr_b16 a[216:217], v18 offset:57344
    ds_read_b64_tr_b16 a[218:219], v182 offset:12288
    v_mfma_f32_16x16x32_bf16 v[120:123], a[240:243], a[116:119], v[120:123]
    v_add_u32 v183, 65536, v19
    v_mfma_f32_16x16x32_bf16 v[124:127], a[244:247], a[112:115], v[124:127]
    ds_read_b64_tr_b16 a[220:221], v19 offset:57344
    v_mfma_f32_16x16x32_bf16 v[128:131], a[244:247], a[116:119], v[128:131]
    ds_read_b64_tr_b16 a[222:223], v183 offset:12288
    v_mfma_f32_16x16x32_bf16 v[152:155], a[248:251], a[112:115], v[152:155]
    s_add_u32 s14, s15, 4096
    ds_read_b64_tr_b16 a[224:225], v15 offset:24576
    ds_read_b64_tr_b16 a[226:227], v15 offset:4096
    v_mfma_f32_16x16x32_bf16 v[156:159], a[248:251], a[116:119], v[156:159]
    buffer_load_dwordx4 a[136:139], v21, s[44:47], s14 offen sc1
    v_pk_mul_f32 v[132:133], v[116:117], v[116:117]
    v_pk_mul_f32 v[134:135], v[118:119], v[118:119]
    v_pk_mul_f32 v[136:137], v[120:121], v[120:121]
    v_pk_mul_f32 v[138:139], v[122:123], v[122:123]
    v_pk_fma_f32 v[132:133], v[132:133], v[50:51], v[50:51] op_sel:[0,1,0] op_sel_hi:[1,1,0]
    v_pk_fma_f32 v[134:135], v[134:135], v[50:51], v[50:51] op_sel:[0,1,0] op_sel_hi:[1,1,0]
    v_pk_fma_f32 v[136:137], v[136:137], v[52:53], v[52:53] op_sel:[0,1,0] op_sel_hi:[1,1,0]
    v_pk_fma_f32 v[138:139], v[138:139], v[52:53], v[52:53] op_sel:[0,1,0] op_sel_hi:[1,1,0]
    v_pk_mul_f32 v[132:133], v[132:133], v[116:117]
    v_pk_mul_f32 v[134:135], v[134:135], v[118:119]
    v_pk_mul_f32 v[136:137], v[136:137], v[120:121]
    v_pk_mul_f32 v[138:139], v[138:139], v[122:123]
    v_mfma_f32_16x16x32_bf16 v[160:163], a[252:255], a[112:115], v[160:163]
    ds_read_b64_tr_b16 a[228:229], v16 offset:24576
    ds_read_b64_tr_b16 a[230:231], v16 offset:4096
    v_mfma_f32_16x16x32_bf16 v[164:167], a[252:255], a[116:119], v[164:167]
    s_waitcnt lgkmcnt(4)
    buffer_load_dwordx4 a[140:143], v22, s[44:47], s14 offen sc1
    v_exp_f32 v132, v132
    v_exp_f32 v133, v133
    v_exp_f32 v134, v134
    v_exp_f32 v135, v135
    s_add_u32 s14, s15, 8192
    buffer_load_dwordx4 a[144:147], v21, s[44:47], s14 offen sc1
    v_exp_f32 v136, v136
    v_exp_f32 v137, v137
    v_exp_f32 v138, v138
    v_exp_f32 v139, v139
    v_pk_mul_f32 v[124:125], v[116:117], v[124:125]
    v_pk_mul_f32 v[126:127], v[118:119], v[126:127]
    v_pk_mul_f32 v[128:129], v[120:121], v[128:129]
    v_pk_mul_f32 v[130:131], v[122:123], v[130:131]
    v_pk_fma_f32 v[132:133], v[132:133], v[54:55], v[54:55] op_sel:[0,0,0] op_sel_hi:[1,0,0]
    v_pk_fma_f32 v[134:135], v[134:135], v[54:55], v[54:55] op_sel:[0,0,0] op_sel_hi:[1,0,0]
    v_pk_fma_f32 v[136:137], v[136:137], v[54:55], v[54:55] op_sel:[0,1,1] op_sel_hi:[1,1,1]
    v_pk_fma_f32 v[138:139], v[138:139], v[54:55], v[54:55] op_sel:[0,1,1] op_sel_hi:[1,1,1]
    buffer_load_dwordx4 a[148:151], v22, s[44:47], s14 offen sc1
    v_rcp_f32 v132, v132
    v_rcp_f32 v133, v133
    v_rcp_f32 v134, v134
    v_rcp_f32 v135, v135
    v_rcp_f32 v136, v136
    v_rcp_f32 v137, v137
    v_rcp_f32 v138, v138
    v_rcp_f32 v139, v139
    v_pk_mul_f32 v[124:125], v[124:125], v[132:133]
    v_pk_mul_f32 v[126:127], v[126:127], v[134:135]
    v_pk_mul_f32 v[128:129], v[128:129], v[136:137]
    v_pk_mul_f32 v[130:131], v[130:131], v[138:139]
    s_add_u32 s14, s15, 12288
    buffer_load_dwordx4 a[152:155], v21, s[44:47], s14 offen sc1
    v_cvt_pk_bf16_f32 v56, v124, v125
    v_cvt_pk_bf16_f32 v57, v126, v127
    v_cvt_pk_bf16_f32 v140, v128, v129
    v_cvt_pk_bf16_f32 v141, v130, v131
    v_pk_mul_f32 v[132:133], v[152:153], v[152:153]
    v_pk_mul_f32 v[134:135], v[154:155], v[154:155]
    v_pk_mul_f32 v[136:137], v[156:157], v[156:157]
    v_pk_mul_f32 v[138:139], v[158:159], v[158:159]
    v_pk_fma_f32 v[132:133], v[132:133], v[50:51], v[50:51] op_sel:[0,1,0] op_sel_hi:[1,1,0]
    v_pk_fma_f32 v[134:135], v[134:135], v[50:51], v[50:51] op_sel:[0,1,0] op_sel_hi:[1,1,0]
    v_pk_fma_f32 v[136:137], v[136:137], v[52:53], v[52:53] op_sel:[0,1,0] op_sel_hi:[1,1,0]
    v_pk_fma_f32 v[138:139], v[138:139], v[52:53], v[52:53] op_sel:[0,1,0] op_sel_hi:[1,1,0]
    v_pk_mul_f32 v[132:133], v[132:133], v[152:153]
    v_pk_mul_f32 v[134:135], v[134:135], v[154:155]
    v_pk_mul_f32 v[136:137], v[136:137], v[156:157]
    v_pk_mul_f32 v[138:139], v[138:139], v[158:159]
    v_exp_f32 v132, v132
    v_exp_f32 v133, v133
    buffer_load_dwordx4 a[156:159], v22, s[44:47], s14 offen sc1
    v_exp_f32 v134, v134
    v_exp_f32 v135, v135
    v_exp_f32 v136, v136
    v_exp_f32 v137, v137
    s_mov_b64 exec, s[6:7]
    buffer_load_dword v25, v20, s[48:51], s71 offen offset:384 sc1
    s_mov_b64 exec, -1
    v_exp_f32 v138, v138
    v_exp_f32 v139, v139
    v_pk_fma_f32 v[132:133], v[132:133], v[54:55], v[54:55] op_sel:[0,0,0] op_sel_hi:[1,0,0]
    v_pk_fma_f32 v[134:135], v[134:135], v[54:55], v[54:55] op_sel:[0,0,0] op_sel_hi:[1,0,0]
    v_pk_fma_f32 v[136:137], v[136:137], v[54:55], v[54:55] op_sel:[0,1,1] op_sel_hi:[1,1,1]
    v_pk_fma_f32 v[138:139], v[138:139], v[54:55], v[54:55] op_sel:[0,1,1] op_sel_hi:[1,1,1]
    v_rcp_f32 v132, v132
    v_rcp_f32 v133, v133
    v_rcp_f32 v134, v134
    s_add_u32 s14, s15, 16384
    v_rcp_f32 v135, v135
    buffer_load_dwordx4 a[160:163], v21, s[44:47], s14 offen sc1
    v_rcp_f32 v136, v136
    v_rcp_f32 v137, v137
    v_rcp_f32 v138, v138
    v_rcp_f32 v139, v139
    v_pk_mul_f32 v[160:161], v[152:153], v[160:161]
    v_pk_mul_f32 v[162:163], v[154:155], v[162:163]
    v_pk_mul_f32 v[164:165], v[156:157], v[164:165]
    v_pk_mul_f32 v[166:167], v[158:159], v[166:167]
    v_pk_mul_f32 v[160:161], v[160:161], v[132:133]
    v_pk_mul_f32 v[162:163], v[162:163], v[134:135]
    v_pk_mul_f32 v[164:165], v[164:165], v[136:137]
    v_pk_mul_f32 v[166:167], v[166:167], v[138:139]
    buffer_load_dwordx4 a[164:167], v22, s[44:47], s14 offen sc1
    v_cvt_pk_bf16_f32 v58, v160, v161
    v_cvt_pk_bf16_f32 v59, v162, v163
    v_cvt_pk_bf16_f32 v142, v164, v165
    v_cvt_pk_bf16_f32 v143, v166, v167
    s_add_u32 s14, s15, 20480
    buffer_load_dwordx4 a[168:171], v21, s[44:47], s14 offen sc1
    buffer_load_dwordx4 a[172:175], v22, s[44:47], s14 offen sc1
    s_waitcnt vmcnt(11)
    v_mfma_f32_16x16x32_bf16 v[68:71], a[208:211], a[128:131], 0
    s_add_u32 s14, s15, 24576
    ds_read_b64_tr_b16 a[232:233], v18 offset:24576
    ds_read_b64_tr_b16 a[234:235], v18 offset:4096
    v_mfma_f32_16x16x32_bf16 v[34:37], a[208:211], a[132:135], v[34:37]
    buffer_load_dwordx4 a[176:179], v21, s[44:47], s14 offen sc1
    v_mfma_f32_16x16x32_bf16 v[72:75], a[212:215], a[128:131], 0
    ds_read_b64_tr_b16 a[236:237], v19 offset:24576
    v_mfma_f32_16x16x32_bf16 v[38:41], a[212:215], a[132:135], v[38:41]
    ds_read_b64_tr_b16 a[238:239], v19 offset:4096
    v_mfma_f32_16x16x32_bf16 v[76:79], a[216:219], a[128:131], 0
    ds_read_b64_tr_b16 a[240:241], v180 offset:28672
    ds_read_b64_tr_b16 a[242:243], v15 offset:16384
    v_mfma_f32_16x16x32_bf16 v[42:45], a[216:219], a[132:135], v[42:45]
    buffer_load_dwordx4 a[180:183], v22, s[44:47], s14 offen sc1
    v_mfma_f32_16x16x32_bf16 v[80:83], a[220:223], a[128:131], 0
    ds_read_b64_tr_b16 a[244:245], v181 offset:28672
    ds_read_b64_tr_b16 a[246:247], v16 offset:16384
    v_mfma_f32_16x16x32_bf16 v[46:49], a[220:223], a[132:135], v[46:49]
    s_waitcnt vmcnt(11) lgkmcnt(4)
    v_mfma_f32_16x16x32_bf16 v[68:71], a[224:227], a[136:139], v[68:71]
    ds_read_b64_tr_b16 a[248:249], v182 offset:28672
    ds_read_b64_tr_b16 a[250:251], v18 offset:16384
    v_mfma_f32_16x16x32_bf16 v[34:37], a[224:227], a[140:143], v[34:37]
    buffer_load_dwordx4 a[184:187], v21, s[44:47], s57 offen sc1
    v_mfma_f32_16x16x32_bf16 v[72:75], a[228:231], a[136:139], v[72:75]
    ds_read_b64_tr_b16 a[252:253], v183 offset:28672
    v_mfma_f32_16x16x32_bf16 v[38:41], a[228:231], a[140:143], v[38:41]
    ds_read_b64_tr_b16 a[254:255], v19 offset:16384
    v_mfma_f32_16x16x32_bf16 v[76:79], a[232:235], a[136:139], v[76:79]
    ds_read_b64_tr_b16 a[208:209], v15 offset:20480
    ds_read_b64_tr_b16 a[210:211], v180 offset:4096
    v_mfma_f32_16x16x32_bf16 v[42:45], a[232:235], a[140:143], v[42:45]
    buffer_load_dwordx4 a[188:191], v22, s[44:47], s57 offen sc1
    buffer_store_dwordx4 v[56:59], v17, s[48:51], s12 offen sc1
    buffer_store_dwordx4 v[140:143], v17, s[48:51], s12 offen offset:1024 sc1
    v_mfma_f32_16x16x32_bf16 v[80:83], a[236:239], a[136:139], v[80:83]
    ds_read_b64_tr_b16 a[212:213], v16 offset:20480
    ds_read_b64_tr_b16 a[214:215], v181 offset:4096
    v_mfma_f32_16x16x32_bf16 v[46:49], a[236:239], a[140:143], v[46:49]
    s_waitcnt vmcnt(13) lgkmcnt(4)
    v_mfma_f32_16x16x32_bf16 v[68:71], a[240:243], a[144:147], v[68:71]
    ds_read_b64_tr_b16 a[216:217], v18 offset:20480
    v_mfma_f32_16x16x32_bf16 v[34:37], a[240:243], a[148:151], v[34:37]
    ds_read_b64_tr_b16 a[218:219], v182 offset:4096
    v_mfma_f32_16x16x32_bf16 v[72:75], a[244:247], a[144:147], v[72:75]
    ds_read_b64_tr_b16 a[220:221], v19 offset:20480
    v_mfma_f32_16x16x32_bf16 v[38:41], a[244:247], a[148:151], v[38:41]
    ds_read_b64_tr_b16 a[222:223], v183 offset:4096
    v_mfma_f32_16x16x32_bf16 v[76:79], a[248:251], a[144:147], v[76:79]
    ds_read_b64_tr_b16 a[224:225], v180 offset:8192
    v_mfma_f32_16x16x32_bf16 v[42:45], a[248:251], a[148:151], v[42:45]
    ds_read_b64_tr_b16 a[226:227], v180 offset:16384
    v_mfma_f32_16x16x32_bf16 v[80:83], a[252:255], a[144:147], v[80:83]
    ds_read_b64_tr_b16 a[228:229], v181 offset:8192
    ds_read_b64_tr_b16 a[230:231], v181 offset:16384
    v_mfma_f32_16x16x32_bf16 v[46:49], a[252:255], a[148:151], v[46:49]
    s_waitcnt vmcnt(10) lgkmcnt(4)
    v_cmp_eq_u32 vcc, 0, v25
    s_nop 0
    s_and_b64 vcc, vcc, s[6:7]
    s_cbranch_vccnz L_late6_w
L_back6_w:
    s_barrier
    v_mfma_f32_16x16x32_bf16 v[68:71], a[208:211], a[152:155], v[68:71]
    s_add_u32 s14, s16, 262144
    ds_read_b64_tr_b16 a[232:233], v182 offset:8192
    ds_read_b64_tr_b16 a[234:235], v182 offset:16384
    v_mfma_f32_16x16x32_bf16 v[34:37], a[208:211], a[156:159], v[34:37]
    buffer_load_dwordx4 a[192:195], v21, s[48:51], s14 offen sc1
    v_mfma_f32_16x16x32_bf16 v[72:75], a[212:215], a[152:155], v[72:75]
    ds_read_b64_tr_b16 a[236:237], v183 offset:8192
    ds_read_b64_tr_b16 a[238:239], v183 offset:16384
    v_mfma_f32_16x16x32_bf16 v[38:41], a[212:215], a[156:159], v[38:41]
    buffer_load_dwordx4 a[196:199], v22, s[48:51], s14 offen sc1
    v_mfma_f32_16x16x32_bf16 v[76:79], a[216:219], a[152:155], v[76:79]
    ds_read_b64_tr_b16 a[240:241], v180 offset:20480
    v_mfma_f32_16x16x32_bf16 v[42:45], a[216:219], a[156:159], v[42:45]
    ds_read_b64_tr_b16 a[242:243], v15 offset:28672
    v_mfma_f32_16x16x32_bf16 v[80:83], a[220:223], a[152:155], v[80:83]
    ds_read_b64_tr_b16 a[244:245], v181 offset:20480
    ds_read_b64_tr_b16 a[246:247], v16 offset:28672
    v_mfma_f32_16x16x32_bf16 v[46:49], a[220:223], a[156:159], v[46:49]
    s_waitcnt vmcnt(10) lgkmcnt(4)
    v_mfma_f32_16x16x32_bf16 v[68:71], a[224:227], a[160:163], v[68:71]
    s_add_u32 s14, s16, 266240
    ds_read_b64_tr_b16 a[248:249], v182 offset:20480
    ds_read_b64_tr_b16 a[250:251], v18 offset:28672
    v_mfma_f32_16x16x32_bf16 v[34:37], a[224:227], a[164:167], v[34:37]
    buffer_load_dwordx4 a[200:203], v21, s[48:51], s14 offen sc1
    v_mfma_f32_16x16x32_bf16 v[72:75], a[228:231], a[160:163], v[72:75]
    ds_read_b64_tr_b16 a[252:253], v183 offset:20480
    v_mfma_f32_16x16x32_bf16 v[38:41], a[228:231], a[164:167], v[38:41]
    ds_read_b64_tr_b16 a[254:255], v19 offset:28672
    v_mfma_f32_16x16x32_bf16 v[76:79], a[232:235], a[160:163], v[76:79]
    ds_read_b64_tr_b16 a[208:209], v15 offset:0
    ds_read_b64_tr_b16 a[210:211], v15 offset:8192
    v_mfma_f32_16x16x32_bf16 v[42:45], a[232:235], a[164:167], v[42:45]
    buffer_load_dwordx4 a[204:207], v22, s[48:51], s14 offen sc1
    v_mfma_f32_16x16x32_bf16 v[80:83], a[236:239], a[160:163], v[80:83]
    ds_read_b64_tr_b16 a[212:213], v16 offset:0
    ds_read_b64_tr_b16 a[214:215], v16 offset:8192
    v_mfma_f32_16x16x32_bf16 v[46:49], a[236:239], a[164:167], v[46:49]
    s_waitcnt vmcnt(10) lgkmcnt(4)
    v_mfma_f32_16x16x32_bf16 v[68:71], a[240:243], a[168:171], v[68:71]
    s_add_u32 s14, s16, 270336
    ds_read_b64_tr_b16 a[216:217], v18 offset:0
    ds_read_b64_tr_b16 a[218:219], v18 offset:8192
    v_mfma_f32_16x16x32_bf16 v[34:37], a[240:243], a[172:175], v[34:37]
    buffer_load_dwordx4 a[8:11], v21, s[48:51], s14 offen sc1
    v_mfma_f32_16x16x32_bf16 v[72:75], a[244:247], a[168:171], v[72:75]
    ds_read_b64_tr_b16 a[220:221], v19 offset:0
    v_mfma_f32_16x16x32_bf16 v[38:41], a[244:247], a[172:175], v[38:41]
    ds_read_b64_tr_b16 a[222:223], v19 offset:8192
    v_mfma_f32_16x16x32_bf16 v[76:79], a[248:251], a[168:171], v[76:79]
    ds_read_b64_tr_b16 a[224:225], v15 offset:12288
    ds_read_b64_tr_b16 a[226:227], v180 offset:32768
    v_mfma_f32_16x16x32_bf16 v[42:45], a[248:251], a[172:175], v[42:45]
    buffer_load_dwordx4 a[12:15], v22, s[48:51], s14 offen sc1
    v_mfma_f32_16x16x32_bf16 v[80:83], a[252:255], a[168:171], v[80:83]
    ds_read_b64_tr_b16 a[228:229], v16 offset:12288
    ds_read_b64_tr_b16 a[230:231], v181 offset:32768
    v_mfma_f32_16x16x32_bf16 v[46:49], a[252:255], a[172:175], v[46:49]
    s_waitcnt vmcnt(10) lgkmcnt(4)
    v_mfma_f32_16x16x32_bf16 v[68:71], a[208:211], a[176:179], v[68:71]
    s_add_u32 s14, s16, 274432
    ds_read_b64_tr_b16 a[232:233], v18 offset:12288
    ds_read_b64_tr_b16 a[234:235], v182 offset:32768
    v_mfma_f32_16x16x32_bf16 v[34:37], a[208:211], a[180:183], v[34:37]
    buffer_load_dwordx4 a[24:27], v21, s[48:51], s14 offen sc1
    v_mfma_f32_16x16x32_bf16 v[72:75], a[212:215], a[176:179], v[72:75]
    ds_read_b64_tr_b16 a[236:237], v19 offset:12288
    v_mfma_f32_16x16x32_bf16 v[38:41], a[212:215], a[180:183], v[38:41]
    ds_read_b64_tr_b16 a[238:239], v183 offset:32768
    v_mfma_f32_16x16x32_bf16 v[76:79], a[216:219], a[176:179], v[76:79]
    ds_read_b64_tr_b16 a[240:241], v180 offset:36864
    ds_read_b64_tr_b16 a[242:243], v180 offset:40960
    v_mfma_f32_16x16x32_bf16 v[42:45], a[216:219], a[180:183], v[42:45]
    buffer_load_dwordx4 a[28:31], v22, s[48:51], s14 offen sc1
    s_waitcnt vmcnt(8)
    s_barrier
    v_mfma_f32_16x16x32_bf16 v[80:83], a[220:223], a[176:179], v[80:83]
    ds_read_b64_tr_b16 a[244:245], v181 offset:36864
    ds_read_b64_tr_b16 a[246:247], v181 offset:40960
    v_mfma_f32_16x16x32_bf16 v[46:49], a[220:223], a[180:183], v[46:49]
    s_waitcnt lgkmcnt(4)
    s_mov_b64 exec, s[4:5]
    buffer_store_dword v2, off, s[48:51], s79 offset:512 sc1
    s_mov_b64 exec, -1
    v_mfma_f32_16x16x32_bf16 v[68:71], a[224:227], a[184:187], v[68:71]
    s_add_u32 m0, s66, 32768
    ds_read_b64_tr_b16 a[248:249], v182 offset:36864
    ds_read_b64_tr_b16 a[250:251], v182 offset:40960
    v_mfma_f32_16x16x32_bf16 v[34:37], a[224:227], a[188:191], v[34:37]
    buffer_load_dwordx4 v65, s[40:43], s52 offen lds
    v_mfma_f32_16x16x32_bf16 v[72:75], a[228:231], a[184:187], v[72:75]
    ds_read_b64_tr_b16 a[252:253], v183 offset:36864
    v_mfma_f32_16x16x32_bf16 v[38:41], a[228:231], a[188:191], v[38:41]
    ds_read_b64_tr_b16 a[254:255], v183 offset:40960
    v_mfma_f32_16x16x32_bf16 v[76:79], a[232:235], a[184:187], v[76:79]
    s_add_u32 s14, s16, 278528
    ds_read_b64_tr_b16 a[208:209], v180 offset:45056
    ds_read_b64_tr_b16 a[210:211], v180 offset:49152
    v_mfma_f32_16x16x32_bf16 v[42:45], a[232:235], a[188:191], v[42:45]
    buffer_load_dwordx4 a[40:43], v21, s[48:51], s14 offen sc1
    v_mfma_f32_16x16x32_bf16 v[80:83], a[236:239], a[184:187], v[80:83]
    ds_read_b64_tr_b16 a[212:213], v181 offset:45056
    ds_read_b64_tr_b16 a[214:215], v181 offset:49152
    v_mfma_f32_16x16x32_bf16 v[46:49], a[236:239], a[188:191], v[46:49]
    s_waitcnt lgkmcnt(4)
    buffer_load_dwordx4 a[44:47], v22, s[48:51], s14 offen sc1
    s_add_u32 m0, s66, 40960
    s_nop 0
    buffer_load_dwordx4 v66, s[40:43], s52 offen lds
    s_waitcnt vmcnt(11)
    v_mfma_f32_16x16x32_bf16 v[68:71], a[240:243], a[192:195], v[68:71]
    s_add_u32 m0, s66, 45056
    ds_read_b64_tr_b16 a[216:217], v182 offset:45056
    ds_read_b64_tr_b16 a[218:219], v182 offset:49152
    v_mfma_f32_16x16x32_bf16 v[34:37], a[240:243], a[196:199], v[34:37]
    buffer_load_dwordx4 v67, s[40:43], s52 offen lds
    v_mfma_f32_16x16x32_bf16 v[72:75], a[244:247], a[192:195], v[72:75]
    ds_read_b64_tr_b16 a[220:221], v183 offset:45056
    v_mfma_f32_16x16x32_bf16 v[38:41], a[244:247], a[196:199], v[38:41]
    ds_read_b64_tr_b16 a[222:223], v183 offset:49152
    v_mfma_f32_16x16x32_bf16 v[76:79], a[248:251], a[192:195], v[76:79]
    s_add_u32 s14, s16, 282624
    ds_read_b64_tr_b16 a[224:225], v180 offset:53248
    ds_read_b64_tr_b16 a[226:227], v180 offset:57344
    v_mfma_f32_16x16x32_bf16 v[42:45], a[248:251], a[196:199], v[42:45]
    buffer_load_dwordx4 a[56:59], v21, s[48:51], s14 offen sc1
    v_mfma_f32_16x16x32_bf16 v[80:83], a[252:255], a[192:195], v[80:83]
    ds_read_b64_tr_b16 a[228:229], v181 offset:53248
    ds_read_b64_tr_b16 a[230:231], v181 offset:57344
    v_mfma_f32_16x16x32_bf16 v[46:49], a[252:255], a[196:199], v[46:49]
    s_waitcnt vmcnt(11) lgkmcnt(4)
    v_mfma_f32_16x16x32_bf16 v[68:71], a[208:211], a[200:203], v[68:71]
    ds_read_b64_tr_b16 a[232:233], v182 offset:53248
    ds_read_b64_tr_b16 a[234:235], v182 offset:57344
    v_mfma_f32_16x16x32_bf16 v[34:37], a[208:211], a[204:207], v[34:37]
    buffer_load_dwordx4 a[60:63], v22, s[48:51], s14 offen sc1
    v_mfma_f32_16x16x32_bf16 v[72:75], a[212:215], a[200:203], v[72:75]
    ds_read_b64_tr_b16 a[236:237], v183 offset:53248
    ds_read_b64_tr_b16 a[238:239], v183 offset:57344
    v_mfma_f32_16x16x32_bf16 v[38:41], a[212:215], a[204:207], v[38:41]
    v_add_u32 v184, 131072, v15
    v_mfma_f32_16x16x32_bf16 v[76:79], a[216:219], a[200:203], v[76:79]
    s_add_u32 m0, s66, 53248
    s_add_u32 s52, s55, 786432
    ds_read_b64_tr_b16 a[240:241], v180 offset:61440
    ds_read_b64_tr_b16 a[242:243], v184 offset:0
    v_mfma_f32_16x16x32_bf16 v[42:45], a[216:219], a[204:207], v[42:45]
    buffer_load_dwordx4 v64, s[40:43], s52 offen lds
    v_add_u32 v185, 131072, v16
    v_mfma_f32_16x16x32_bf16 v[80:83], a[220:223], a[200:203], v[80:83]
    ds_read_b64_tr_b16 a[244:245], v181 offset:61440
    ds_read_b64_tr_b16 a[246:247], v185 offset:0
    v_mfma_f32_16x16x32_bf16 v[46:49], a[220:223], a[204:207], v[46:49]
    s_waitcnt lgkmcnt(4)
    v_add_u32 v186, 131072, v18
    s_waitcnt vmcnt(11)
    v_mfma_f32_16x16x32_bf16 v[68:71], a[224:227], a[8:11], v[68:71]
    s_add_u32 m0, s66, 57344
    ds_read_b64_tr_b16 a[248:249], v182 offset:61440
    ds_read_b64_tr_b16 a[250:251], v186 offset:0
    v_mfma_f32_16x16x32_bf16 v[34:37], a[224:227], a[12:15], v[34:37]
    buffer_load_dwordx4 v65, s[40:43], s52 offen lds
    v_add_u32 v187, 131072, v19
    v_mfma_f32_16x16x32_bf16 v[72:75], a[228:231], a[8:11], v[72:75]
    ds_read_b64_tr_b16 a[252:253], v183 offset:61440
    v_mfma_f32_16x16x32_bf16 v[38:41], a[228:231], a[12:15], v[38:41]
    ds_read_b64_tr_b16 a[254:255], v187 offset:0
    v_mfma_f32_16x16x32_bf16 v[76:79], a[232:235], a[8:11], v[76:79]
    s_add_u32 s14, s16, 286720
    ds_read_b64_tr_b16 a[208:209], v184 offset:4096
    ds_read_b64_tr_b16 a[210:211], v184 offset:8192
    v_mfma_f32_16x16x32_bf16 v[42:45], a[232:235], a[12:15], v[42:45]
    buffer_load_dwordx4 a[72:75], v21, s[48:51], s14 offen sc1
    v_mfma_f32_16x16x32_bf16 v[80:83], a[236:239], a[8:11], v[80:83]
    ds_read_b64_tr_b16 a[212:213], v185 offset:4096
    ds_read_b64_tr_b16 a[214:215], v185 offset:8192
    v_mfma_f32_16x16x32_bf16 v[46:49], a[236:239], a[12:15], v[46:49]
    s_waitcnt lgkmcnt(4)
    s_mov_b64 exec, s[6:7]
    buffer_load_dword v3, v20, s[48:51], s71 offen offset:512 sc1
    s_mov_b64 exec, -1
    s_waitcnt vmcnt(12)
    v_mfma_f32_16x16x32_bf16 v[68:71], a[240:243], a[24:27], v[68:71]
    ds_read_b64_tr_b16 a[216:217], v186 offset:4096
    ds_read_b64_tr_b16 a[218:219], v186 offset:8192
    v_mfma_f32_16x16x32_bf16 v[34:37], a[240:243], a[28:31], v[34:37]
    buffer_load_dwordx4 a[76:79], v22, s[48:51], s14 offen sc1
    v_mfma_f32_16x16x32_bf16 v[72:75], a[244:247], a[24:27], v[72:75]
    ds_read_b64_tr_b16 a[220:221], v187 offset:4096
    v_mfma_f32_16x16x32_bf16 v[38:41], a[244:247], a[28:31], v[38:41]
    ds_read_b64_tr_b16 a[222:223], v187 offset:8192
    v_mfma_f32_16x16x32_bf16 v[76:79], a[248:251], a[24:27], v[76:79]
    ds_read_b64_tr_b16 a[224:225], v184 offset:12288
    v_mfma_f32_16x16x32_bf16 v[42:45], a[248:251], a[28:31], v[42:45]
    ds_read_b64_tr_b16 a[226:227], v184 offset:16384
    v_mfma_f32_16x16x32_bf16 v[80:83], a[252:255], a[24:27], v[80:83]
    s_add_u32 m0, s66, 77824
    ds_read_b64_tr_b16 a[228:229], v185 offset:12288
    ds_read_b64_tr_b16 a[230:231], v185 offset:16384
    v_mfma_f32_16x16x32_bf16 v[46:49], a[252:255], a[28:31], v[46:49]
    s_waitcnt lgkmcnt(4)
    buffer_load_dwordx4 v66, s[40:43], s52 offen lds
    s_add_u32 m0, s66, 24576
    s_nop 0
    buffer_load_dwordx4 v67, s[40:43], s52 offen lds
    s_waitcnt vmcnt(11)
    v_mfma_f32_16x16x32_bf16 v[68:71], a[208:211], a[40:43], v[68:71]
    s_add_u32 m0, s66, 4096
    s_add_u32 s52, s55, 1179648
    ds_read_b64_tr_b16 a[232:233], v186 offset:12288
    ds_read_b64_tr_b16 a[234:235], v186 offset:16384
    v_mfma_f32_16x16x32_bf16 v[34:37], a[208:211], a[44:47], v[34:37]
    buffer_load_dwordx4 v64, s[40:43], s52 offen lds
    v_mfma_f32_16x16x32_bf16 v[72:75], a[212:215], a[40:43], v[72:75]
    ds_read_b64_tr_b16 a[236:237], v187 offset:12288
    v_mfma_f32_16x16x32_bf16 v[38:41], a[212:215], a[44:47], v[38:41]
    ds_read_b64_tr_b16 a[238:239], v187 offset:16384
    v_mfma_f32_16x16x32_bf16 v[76:79], a[216:219], a[40:43], v[76:79]
    s_add_u32 m0, s66, 94208
    ds_read_b64_tr_b16 a[240:241], v184 offset:20480
    ds_read_b64_tr_b16 a[242:243], v184 offset:24576
    v_mfma_f32_16x16x32_bf16 v[42:45], a[216:219], a[44:47], v[42:45]
    buffer_load_dwordx4 v65, s[40:43], s52 offen lds
    v_mfma_f32_16x16x32_bf16 v[80:83], a[220:223], a[40:43], v[80:83]
    ds_read_b64_tr_b16 a[244:245], v185 offset:20480
    ds_read_b64_tr_b16 a[246:247], v185 offset:24576
    v_mfma_f32_16x16x32_bf16 v[46:49], a[220:223], a[44:47], v[46:49]
    s_waitcnt vmcnt(9) lgkmcnt(4)
    v_mfma_f32_16x16x32_bf16 v[68:71], a[224:227], a[56:59], v[68:71]
    ds_read_b64_tr_b16 a[248:249], v186 offset:20480
    v_mfma_f32_16x16x32_bf16 v[34:37], a[224:227], a[60:63], v[34:37]
    ds_read_b64_tr_b16 a[250:251], v186 offset:24576
    v_mfma_f32_16x16x32_bf16 v[72:75], a[228:231], a[56:59], v[72:75]
    ds_read_b64_tr_b16 a[252:253], v187 offset:20480
    v_mfma_f32_16x16x32_bf16 v[38:41], a[228:231], a[60:63], v[38:41]
    ds_read_b64_tr_b16 a[254:255], v187 offset:24576
    v_mfma_f32_16x16x32_bf16 v[76:79], a[232:235], a[56:59], v[76:79]
    ds_read_b64_tr_b16 a[208:209], v15 offset:36864
    v_mfma_f32_16x16x32_bf16 v[42:45], a[232:235], a[60:63], v[42:45]
    ds_read_b64_tr_b16 a[210:211], v15 offset:49152
    v_mfma_f32_16x16x32_bf16 v[80:83], a[236:239], a[56:59], v[80:83]
    ds_read_b64_tr_b16 a[212:213], v16 offset:36864
    ds_read_b64_tr_b16 a[214:215], v16 offset:49152
    v_mfma_f32_16x16x32_bf16 v[46:49], a[236:239], a[60:63], v[46:49]
    s_waitcnt vmcnt(5) lgkmcnt(4)
    v_cmp_eq_u32 vcc, 0, v3
    s_nop 0
    s_and_b64 vcc, vcc, s[6:7]
    s_cbranch_vccnz L_late8_w
L_back8_w:
    s_barrier
    s_add_u32 s14, s16, 0
    buffer_load_dwordx4 a[88:91], v21, s[48:51], s14 offen sc1
    buffer_load_dwordx4 a[92:95], v22, s[48:51], s14 offen sc1
    s_add_u32 s14, s16, 4096
    buffer_load_dwordx4 a[104:107], v21, s[48:51], s14 offen sc1
    buffer_load_dwordx4 a[108:111], v22, s[48:51], s14 offen sc1
    s_lshl2_add_u32 s67, s66, 98304
    v_add_u32 v4, s67, v17
    s_xor_b32 s68, s66, 1024
    s_lshl2_add_u32 s68, s68, 98304
    v_add_u32 v5, s68, v17
    s_add_u32 s67, s76, 114688
    v_add_u32 v171, s67, v17
    v_lshrrev_b32 v63, 1, v32
    v_and_b32 v168, 7, v1
    v_xor_b32 v63, v63, v168
    v_lshlrev_b32 v63, 4, v63
    v_lshl_add_u32 v63, v31, 7, v63
    v_lshrrev_b32 v6, 3, v1
    v_xor_b32 v168, v168, v6
    v_lshlrev_b32 v168, 4, v168
    v_lshl_add_u32 v6, v6, 10, v168
    v_and_b32 v168, 1, v32
    v_lshlrev_b32 v168, 3, v168
    s_waitcnt vmcnt(8)
    v_mfma_f32_16x16x32_bf16 v[68:71], a[240:243], a[72:75], v[68:71]
    s_add_u32 s14, s16, 8192
    ds_read_b64_tr_b16 a[216:217], v18 offset:36864
    ds_read_b64_tr_b16 a[218:219], v18 offset:49152
    v_mfma_f32_16x16x32_bf16 v[34:37], a[240:243], a[76:79], v[34:37]
    buffer_load_dwordx4 a[120:123], v21, s[48:51], s14 offen sc1
    v_add3_u32 v63, v63, v168, s67
    v_mfma_f32_16x16x32_bf16 v[72:75], a[244:247], a[72:75], v[72:75]
    ds_read_b64_tr_b16 a[220:221], v19 offset:36864
    ds_read_b64_tr_b16 a[222:223], v19 offset:49152
    v_mfma_f32_16x16x32_bf16 v[38:41], a[244:247], a[76:79], v[38:41]
    v_xor_b32 v168, 32, v63
    v_xor_b32 v169, 64, v63
    v_mfma_f32_16x16x32_bf16 v[76:79], a[248:251], a[72:75], v[76:79]
    ds_read_b64_tr_b16 a[224:225], v15 offset:61440
    ds_read_b64_tr_b16 a[226:227], v180 offset:0
    v_mfma_f32_16x16x32_bf16 v[42:45], a[248:251], a[76:79], v[42:45]
    buffer_load_dwordx4 a[124:127], v22, s[48:51], s14 offen sc1
    v_xor_b32 v170, 96, v63
    v_mfma_f32_16x16x32_bf16 v[80:83], a[252:255], a[72:75], v[80:83]
    ds_read_b64_tr_b16 a[228:229], v16 offset:61440
    ds_read_b64_tr_b16 a[230:231], v181 offset:0
    v_mfma_f32_16x16x32_bf16 v[46:49], a[252:255], a[76:79], v[46:49]
    s_waitcnt lgkmcnt(4)
    s_lshl2_add_u32 s67, s65, s60
    s_lshl_b32 s67, s67, 14
    s_add_u32 s67, s67, s78
    s_add_u32 s68, s67, 8192
    s_add_u32 s14, s16, 12288
    buffer_load_dwordx4 a[0:3], v21, s[48:51], s14 offen sc1
    buffer_load_dwordx4 a[4:7], v22, s[48:51], s14 offen sc1
    s_add_u32 s14, s16, 16384
    buffer_load_dwordx4 a[16:19], v21, s[48:51], s14 offen sc1
    buffer_load_dwordx4 a[20:23], v22, s[48:51], s14 offen sc1
    s_waitcnt vmcnt(8)
    v_mfma_f32_16x16x32_bf16 v[68:71], a[208:211], a[88:91], v[68:71]
    s_add_u32 s14, s16, 20480
    ds_read_b64_tr_b16 a[232:233], v18 offset:61440
    ds_read_b64_tr_b16 a[234:235], v182 offset:0
    v_mfma_f32_16x16x32_bf16 v[34:37], a[208:211], a[92:95], v[34:37]
    buffer_load_dwordx4 a[32:35], v21, s[48:51], s14 offen sc1
    v_mfma_f32_16x16x32_bf16 v[72:75], a[212:215], a[88:91], v[72:75]
    ds_read_b64_tr_b16 a[236:237], v19 offset:61440
    v_mfma_f32_16x16x32_bf16 v[38:41], a[212:215], a[92:95], v[38:41]
    ds_read_b64_tr_b16 a[238:239], v183 offset:0
    v_mfma_f32_16x16x32_bf16 v[76:79], a[216:219], a[88:91], v[76:79]
    ds_read_b64_tr_b16 a[240:241], v180 offset:24576
    ds_read_b64_tr_b16 a[242:243], v15 offset:32768
    v_mfma_f32_16x16x32_bf16 v[42:45], a[216:219], a[92:95], v[42:45]
    buffer_load_dwordx4 a[36:39], v22, s[48:51], s14 offen sc1
    v_mfma_f32_16x16x32_bf16 v[80:83], a[220:223], a[88:91], v[80:83]
    ds_read_b64_tr_b16 a[244:245], v181 offset:24576
    ds_read_b64_tr_b16 a[246:247], v16 offset:32768
    v_mfma_f32_16x16x32_bf16 v[46:49], a[220:223], a[92:95], v[46:49]
    s_waitcnt vmcnt(8) lgkmcnt(4)
    v_mfma_f32_16x16x32_bf16 v[68:71], a[224:227], a[104:107], v[68:71]
    s_add_u32 s14, s16, 24576
    ds_read_b64_tr_b16 a[248:249], v182 offset:24576
    ds_read_b64_tr_b16 a[250:251], v18 offset:32768
    v_mfma_f32_16x16x32_bf16 v[34:37], a[224:227], a[108:111], v[34:37]
    buffer_load_dwordx4 a[48:51], v21, s[48:51], s14 offen sc1
    v_mfma_f32_16x16x32_bf16 v[72:75], a[228:231], a[104:107], v[72:75]
    ds_read_b64_tr_b16 a[252:253], v183 offset:24576
    v_mfma_f32_16x16x32_bf16 v[38:41], a[228:231], a[108:111], v[38:41]
    ds_read_b64_tr_b16 a[254:255], v19 offset:32768
    v_mfma_f32_16x16x32_bf16 v[76:79], a[232:235], a[104:107], v[76:79]
    ds_read_b64_tr_b16 a[208:209], v15 offset:40960
    ds_read_b64_tr_b16 a[210:211], v15 offset:45056
    v_mfma_f32_16x16x32_bf16 v[42:45], a[232:235], a[108:111], v[42:45]
    buffer_load_dwordx4 a[52:55], v22, s[48:51], s14 offen sc1
    v_mfma_f32_16x16x32_bf16 v[80:83], a[236:239], a[104:107], v[80:83]
    ds_read_b64_tr_b16 a[212:213], v16 offset:40960
    ds_read_b64_tr_b16 a[214:215], v16 offset:45056
    v_mfma_f32_16x16x32_bf16 v[46:49], a[236:239], a[108:111], v[46:49]
    s_waitcnt vmcnt(8) lgkmcnt(4)
    v_mfma_f32_16x16x32_bf16 v[68:71], a[240:243], a[120:123], v[68:71]
    ds_read_b64_tr_b16 a[216:217], v18 offset:40960
    v_mfma_f32_16x16x32_bf16 v[34:37], a[240:243], a[124:127], v[34:37]
    ds_read_b64_tr_b16 a[218:219], v18 offset:45056
    v_mfma_f32_16x16x32_bf16 v[72:75], a[244:247], a[120:123], v[72:75]
    ds_read_b64_tr_b16 a[220:221], v19 offset:40960
    ds_read_b64_tr_b16 a[222:223], v19 offset:45056
    v_mfma_f32_16x16x32_bf16 v[38:41], a[244:247], a[124:127], v[38:41]
    s_barrier
    v_mfma_f32_16x16x32_bf16 v[76:79], a[248:251], a[120:123], v[76:79]
    ds_read_b64_tr_b16 a[224:225], v15 offset:53248
    v_mfma_f32_16x16x32_bf16 v[42:45], a[248:251], a[124:127], v[42:45]
    ds_read_b64_tr_b16 a[226:227], v15 offset:57344
    v_mfma_f32_16x16x32_bf16 v[80:83], a[252:255], a[120:123], v[80:83]
    ds_read_b64_tr_b16 a[228:229], v16 offset:53248
    ds_read_b64_tr_b16 a[230:231], v16 offset:57344
    v_mfma_f32_16x16x32_bf16 v[46:49], a[252:255], a[124:127], v[46:49]
    s_waitcnt vmcnt(6) lgkmcnt(4)
    v_mfma_f32_16x16x32_bf16 v[68:71], a[208:211], a[0:3], v[68:71]
    ds_read_b64_tr_b16 a[232:233], v18 offset:53248
    v_mfma_f32_16x16x32_bf16 v[34:37], a[208:211], a[4:7], v[34:37]
    ds_read_b64_tr_b16 a[234:235], v18 offset:57344
    v_mfma_f32_16x16x32_bf16 v[72:75], a[212:215], a[0:3], v[72:75]
    ds_read_b64_tr_b16 a[236:237], v19 offset:53248
    v_mfma_f32_16x16x32_bf16 v[38:41], a[212:215], a[4:7], v[38:41]
    ds_read_b64_tr_b16 a[238:239], v19 offset:57344
    v_mfma_f32_16x16x32_bf16 v[76:79], a[216:219], a[0:3], v[76:79]
    ds_read_b64_tr_b16 a[240:241], v180 offset:12288
    v_mfma_f32_16x16x32_bf16 v[42:45], a[216:219], a[4:7], v[42:45]
    ds_read_b64_tr_b16 a[242:243], v15 offset:24576
    v_mfma_f32_16x16x32_bf16 v[80:83], a[220:223], a[0:3], v[80:83]
    ds_read_b64_tr_b16 a[244:245], v181 offset:12288
    ds_read_b64_tr_b16 a[246:247], v16 offset:24576
    v_mfma_f32_16x16x32_bf16 v[46:49], a[220:223], a[4:7], v[46:49]
    s_waitcnt vmcnt(4) lgkmcnt(4)
    v_mfma_f32_16x16x32_bf16 v[68:71], a[224:227], a[16:19], v[68:71]
    ds_read_b64_tr_b16 a[248:249], v182 offset:12288
    v_mfma_f32_16x16x32_bf16 v[34:37], a[224:227], a[20:23], v[34:37]
    ds_read_b64_tr_b16 a[250:251], v18 offset:24576
    v_mfma_f32_16x16x32_bf16 v[72:75], a[228:231], a[16:19], v[72:75]
    ds_read_b64_tr_b16 a[252:253], v183 offset:12288
    v_mfma_f32_16x16x32_bf16 v[38:41], a[228:231], a[20:23], v[38:41]
    ds_read_b64_tr_b16 a[254:255], v19 offset:24576
    v_mfma_f32_16x16x32_bf16 v[76:79], a[232:235], a[16:19], v[76:79]
    ds_read_b64_tr_b16 a[208:209], v15 offset:4096
    v_mfma_f32_16x16x32_bf16 v[42:45], a[232:235], a[20:23], v[42:45]
    ds_read_b64_tr_b16 a[210:211], v180 offset:28672
    v_mfma_f32_16x16x32_bf16 v[80:83], a[236:239], a[16:19], v[80:83]
    ds_read_b64_tr_b16 a[212:213], v16 offset:4096
    ds_read_b64_tr_b16 a[214:215], v181 offset:28672
    v_mfma_f32_16x16x32_bf16 v[46:49], a[236:239], a[20:23], v[46:49]
    s_waitcnt vmcnt(3) lgkmcnt(4)
    v_mfma_f32_16x16x32_bf16 v[68:71], a[240:243], a[32:35], v[68:71]
    ds_read_b64_tr_b16 a[216:217], v18 offset:4096
    v_mfma_f32_16x16x32_bf16 v[72:75], a[244:247], a[32:35], v[72:75]
    ds_read_b64_tr_b16 a[218:219], v182 offset:28672
    v_mfma_f32_16x16x32_bf16 v[76:79], a[248:251], a[32:35], v[76:79]
    ds_read_b64_tr_b16 a[220:221], v19 offset:4096
    ds_read_b64_tr_b16 a[222:223], v183 offset:28672
    v_mfma_f32_16x16x32_bf16 v[80:83], a[252:255], a[32:35], v[80:83]
    s_waitcnt vmcnt(1) lgkmcnt(6)
    v_mfma_f32_16x16x32_bf16 v[68:71], a[208:211], a[48:51], v[68:71]
    s_waitcnt lgkmcnt(4)
    v_mfma_f32_16x16x32_bf16 v[72:75], a[212:215], a[48:51], v[72:75]
    s_waitcnt lgkmcnt(2)
    v_mfma_f32_16x16x32_bf16 v[76:79], a[216:219], a[48:51], v[76:79]
    s_waitcnt lgkmcnt(0)
    v_mfma_f32_16x16x32_bf16 v[80:83], a[220:223], a[48:51], v[80:83]
    v_mfma_f32_16x16x32_bf16 v[34:37], a[240:243], a[36:39], v[34:37]
    v_mfma_f32_16x16x32_bf16 v[38:41], a[244:247], a[36:39], v[38:41]
    ds_write_b128 v4, v[68:71] offset:0
    v_mfma_f32_16x16x32_bf16 v[42:45], a[248:251], a[36:39], v[42:45]
    ds_write_b128 v4, v[72:75] offset:1024
    v_mfma_f32_16x16x32_bf16 v[46:49], a[252:255], a[36:39], v[46:49]
    ds_write_b128 v4, v[76:79] offset:2048
    s_waitcnt vmcnt(0)
    v_mfma_f32_16x16x32_bf16 v[34:37], a[208:211], a[52:55], v[34:37]
    ds_write_b128 v4, v[80:83] offset:3072
    v_mfma_f32_16x16x32_bf16 v[38:41], a[212:215], a[52:55], v[38:41]
    v_mfma_f32_16x16x32_bf16 v[42:45], a[216:219], a[52:55], v[42:45]
    v_mfma_f32_16x16x32_bf16 v[46:49], a[220:223], a[52:55], v[46:49]
    s_waitcnt lgkmcnt(0)
    s_barrier
    ds_read_b128 v[84:87], v5 offset:0
    ds_read_b128 v[88:91], v5 offset:1024
    ds_read_b128 v[92:95], v5 offset:2048
    ds_read_b128 v[96:99], v5 offset:3072
    s_waitcnt lgkmcnt(3)
    v_pk_add_f32 v[34:35], v[34:35], v[84:85]
    v_pk_add_f32 v[36:37], v[36:37], v[86:87]
    v_cvt_pk_bf16_f32 v132, v34, v35
    v_cvt_pk_bf16_f32 v133, v36, v37
    ds_write_b64 v63, v[132:133]
    s_waitcnt lgkmcnt(3)
    v_pk_add_f32 v[38:39], v[38:39], v[88:89]
    v_pk_add_f32 v[40:41], v[40:41], v[90:91]
    v_cvt_pk_bf16_f32 v134, v38, v39
    v_cvt_pk_bf16_f32 v135, v40, v41
    ds_write_b64 v168, v[134:135]
    s_waitcnt lgkmcnt(3)
    v_pk_add_f32 v[42:43], v[42:43], v[92:93]
    v_pk_add_f32 v[44:45], v[44:45], v[94:95]
    v_cvt_pk_bf16_f32 v136, v42, v43
    v_cvt_pk_bf16_f32 v137, v44, v45
    ds_write_b64 v169, v[136:137]
    s_waitcnt lgkmcnt(3)
    v_pk_add_f32 v[46:47], v[46:47], v[96:97]
    v_pk_add_f32 v[48:49], v[48:49], v[98:99]
    v_cvt_pk_bf16_f32 v138, v46, v47
    v_cvt_pk_bf16_f32 v139, v48, v49
    ds_write_b64 v170, v[138:139]
    ds_read_b128 v[56:59], v171 offset:0
    ds_read_b128 v[140:143], v171 offset:1024
    s_waitcnt lgkmcnt(1)
    buffer_store_dwordx4 v[56:59], v6, s[44:47], s67 offen nt
    s_waitcnt lgkmcnt(0)
    buffer_store_dwordx4 v[140:143], v6, s[44:47], s68 offen nt
L_main_end_w:
    s_endpgm
L_late0_w:
    s_mov_b64 exec, s[6:7]
    s_mov_b32 s70, 0x20000
L_poll1_w:
    buffer_load_dword v3, v18, s[48:51], s71 offen offset:0 sc1
    s_waitcnt vmcnt(0)
    v_cmp_eq_u32 vcc, 0, v3
    s_sub_u32 s70, s70, 1
    s_cbranch_scc1 L_pd1_w
    s_cbranch_vccnz L_poll1_w
L_pd1_w:
    s_mov_b64 exec, -1
    s_branch L_back0_w
L_late2_w:
    s_mov_b64 exec, s[6:7]
    s_mov_b32 s70, 0x20000
L_poll3_w:
    buffer_load_dword v3, v20, s[48:51], s71 offen offset:128 sc1
    s_waitcnt vmcnt(0)
    v_cmp_eq_u32 vcc, 0, v3
    s_sub_u32 s70, s70, 1
    s_cbranch_scc1 L_pd3_w
    s_cbranch_vccnz L_poll3_w
L_pd3_w:
    s_mov_b64 exec, -1
    s_branch L_back2_w
L_late4_w:
    s_mov_b64 exec, s[6:7]
    s_mov_b32 s70, 0x20000
L_poll5_w:
    buffer_load_dword v33, v20, s[48:51], s71 offen offset:256 sc1
    s_waitcnt vmcnt(0)
    v_cmp_eq_u32 vcc, 0, v33
    s_sub_u32 s70, s70, 1
    s_cbranch_scc1 L_pd5_w
    s_cbranch_vccnz L_poll5_w
L_pd5_w:
    s_mov_b64 exec, -1
    s_branch L_back4_w
L_late6_w:
    s_mov_b64 exec, s[6:7]
    s_mov_b32 s70, 0x20000
L_poll7_w:
    buffer_load_dword v25, v20, s[48:51], s71 offen offset:384 sc1
    s_waitcnt vmcnt(0)
    v_cmp_eq_u32 vcc, 0, v25
    s_sub_u32 s70, s70, 1
    s_cbranch_scc1 L_pd7_w
    s_cbranch_vccnz L_poll7_w
L_pd7_w:
    s_mov_b64 exec, -1
    s_branch L_back6_w
L_late8_w:
    s_mov_b64 exec, s[6:7]
    s_mov_b32 s70, 0x20000
L_poll9_w:
    buffer_load_dword v3, v20, s[48:51], s71 offen offset:512 sc1
    s_waitcnt vmcnt(0)
    v_cmp_eq_u32 vcc, 0, v3
    s_sub_u32 s70, s70, 1
    s_cbranch_scc1 L_pd9_w
    s_cbranch_vccnz L_poll9_w
L_pd9_w:
    s_mov_b64 exec, -1
    s_branch L_back8_w
    s_endpgm
.section .rodata,"a"
.p2align 6
.amdhsa_kernel sequential_preLN__sliding_local_dilated__geglu_ffn__prompt_kernel
  .amdhsa_next_free_vgpr 512
  .amdhsa_next_free_sgpr 102
  .amdhsa_accum_offset 256
  .amdhsa_group_segment_fixed_size 0
  .amdhsa_kernarg_size 80
  .amdhsa_user_sgpr_count 2
  .amdhsa_user_sgpr_kernarg_segment_ptr 1
  .amdhsa_system_sgpr_workgroup_id_x 1
  .amdhsa_float_denorm_mode_32 3
.end_amdhsa_kernel
```
